```python
import torch

def _softmax(x, axis=-1):
    return torch.softmax(x, dim=axis)
def _gelu(x):
    return torch.nn.functional.gelu(x, approximate="tanh")
def _silu(x):
    return torch.nn.functional.silu(x)
def _sigmoid(x):
    return torch.sigmoid(x)
def _layernorm(x, axis=-1, eps=1e-5):
    m = x.mean(dim=axis, keepdim=True)
    v = x.var(dim=axis, keepdim=True, unbiased=False)
    return (x - m) / torch.sqrt(v + eps)
def _scatter_add(tgt, idx, src, axis=0):
    return tgt.clone().index_add_(axis, idx, src)
def _segment_sum(src, seg, n):
    out = torch.zeros((n,) + src.shape[1:], dtype=src.dtype)
    return out.index_add_(0, seg, src)
def _pad(x, pw):
    flat = tuple(v for pair in reversed(pw) for v in pair)
    return torch.nn.functional.pad(x, flat)

kernel_name = 'recurrent_scan__ssm_conv_s5__dense_activation_relu__prompt'

def setup_inputs():

    _w = (lambda a: (lambda t: t.to(torch.bfloat16) if t.is_floating_point() else t)(torch.as_tensor(a)))
    def _A_setup():
        B, S, D = 1, 2048, 640
        P = D
        Lambda_re = -0.5 * (lambda _x: torch.exp(torch.as_tensor(_x)))((lambda *s: torch.randn(*s, dtype=torch.bfloat16) * 0.2)(P))
        Lambda_im = (lambda *s: torch.randn(*s, dtype=torch.bfloat16) * 0.4)(P) * 1.0
        B_re = (lambda *s: torch.randn(*s, dtype=torch.bfloat16) * 0.2)(P, D) * (D ** -0.5)
        B_im = (lambda *s: torch.randn(*s, dtype=torch.bfloat16) * 0.2)(P, D) * (D ** -0.5)
        C_re = (lambda *s: torch.randn(*s, dtype=torch.bfloat16) * 0.2)(D, P) * (P ** -0.5)
        C_im = (lambda *s: torch.randn(*s, dtype=torch.bfloat16) * 0.2)(D, P) * (P ** -0.5)
        log_dt = (lambda *s: torch.randn(*s, dtype=torch.bfloat16) * 0.2)(P) * 0.3 - 2.0
        Dskip = (lambda *s: torch.randn(*s, dtype=torch.bfloat16) * 0.05)(D)
        return {
            "x": _w((lambda *s: torch.randn(*s, dtype=torch.bfloat16) * 0.05)(B, S, D)),
            "Lambda_re": _w(Lambda_re),
            "Lambda_im": _w(Lambda_im),
            "B_re": _w(B_re),
            "B_im": _w(B_im),
            "C_re": _w(C_re),
            "C_im": _w(C_im),
            "log_dt": _w(log_dt),
            "Dskip": _w(Dskip),
        }
    _A_in = _A_setup()

    def _B_setup():
        B, S, D, Dff = 1, 2048, 640, 1728
        return {
            "x": _w((lambda *s: torch.randn(*s, dtype=torch.bfloat16) * 0.05)(B, S, D)),
            "w1": _w((lambda *s: torch.randn(*s, dtype=torch.bfloat16) * 0.05)(D, Dff)),
            "w2": _w((lambda *s: torch.randn(*s, dtype=torch.bfloat16) * 0.05)(Dff, D)),
        }
    _B_in = _B_setup()

    return {
        "A_x": _A_in["x"],
        "A_Lambda_re": _A_in["Lambda_re"],
        "A_Lambda_im": _A_in["Lambda_im"],
        "A_B_re": _A_in["B_re"],
        "A_B_im": _A_in["B_im"],
        "A_C_re": _A_in["C_re"],
        "A_C_im": _A_in["C_im"],
        "A_log_dt": _A_in["log_dt"],
        "A_Dskip": _A_in["Dskip"],
        "B_x": _B_in["x"],
        "B_w1": _B_in["w1"],
        "B_w2": _B_in["w2"],
    }

def reference(A_x, A_Lambda_re, A_Lambda_im, A_B_re, A_B_im, A_C_re, A_C_im, A_log_dt, A_Dskip, B_x, B_w1, B_w2):
    def _A_ref(x, Lambda_re, Lambda_im, B_re, B_im, C_re, C_im, log_dt, Dskip):
        Bsz, L, H = x.shape
        Lam = Lambda_re + 1j * Lambda_im
        Bmat = B_re + 1j * B_im
        Cmat = C_re + 1j * C_im
        dt = torch.exp(log_dt)
        Lam_bar = torch.exp(dt * Lam)
        B_bar = ((Lam_bar - 1.0) / Lam)[:, None] * Bmat
        Bu = torch.einsum("bld,pd->blp", x + 0j, B_bar)
        h = torch.zeros_like(Bu[:, 0, :])
        hs = []
        for t in range(L):
            h = Lam_bar[None, :] * h + Bu[:, t, :]
            hs.append(h)
        hseq = torch.stack(hs, 1)
        y = 2.0 * torch.einsum("blp,dp->bld", hseq, Cmat).real + x * Dskip[None, None, :]
        return y

    def _B_ref(x, w1, w2):
        h = torch.einsum("bsd,df->bsf", x, w1)
        zero = torch.zeros_like(h)
        h = torch.maximum(h, zero)
        return torch.einsum("bsf,fd->bsd", h, w2)

    x = A_x
    xn = _layernorm(x, axis=-1)
    s = _A_ref(xn, A_Lambda_re, A_Lambda_im, A_B_re, A_B_im, A_C_re, A_C_im, A_log_dt, A_Dskip)
    g = _silu(_B_ref(xn, B_w1, B_w2))
    return x + s * g
```

```asm
; @launch grid=(256,1,1) block=(512,1,1) lds=163840
.amdgcn_target "amdgcn-amd-amdhsa--gfx950"
.text
.globl recurrent_scan__ssm_conv_s5__dense_activation_relu__prompt_kernel
.p2align 8
.type recurrent_scan__ssm_conv_s5__dense_activation_relu__prompt_kernel,@function
recurrent_scan__ssm_conv_s5__dense_activation_relu__prompt_kernel:
    s_cmp_ge_u32 s2, 256
    s_cbranch_scc1 k1_end
    s_load_dwordx16 s[4:19], s[0:1], 0
    s_load_dwordx8 s[20:27], s[0:1], 64
    s_load_dwordx4 s[28:31], s[0:1], 96
    s_load_dwordx2 s[32:33], s[0:1], 112
    v_lshrrev_b32 v2, 6, v0
    v_and_b32 v1, 255, v0
    v_and_b32 v0, 63, v0
    v_readfirstlane_b32 s34, v2
    s_lshr_b32 s35, s2, 3
    s_and_b32 s57, s2, 3
    s_lshl_b32 s57, s57, 2
    s_lshr_b32 s50, s35, 3
    s_add_u32 s50, s50, s57
    s_bfe_u32 s49, s2, 0x10002
    s_and_b32 s51, s35, 7
    s_and_b32 s48, s34, 3
    s_lshr_b32 s52, s48, 1
    s_and_b32 s53, s48, 1
    v_lshrrev_b32 v3, 3, v0
    v_and_b32 v4, 7, v0
    v_lshrrev_b32 v5, 4, v0
    v_and_b32 v6, 15, v0
    s_cmp_ge_u32 s34, 4
    s_cbranch_scc1 nopf_1
    s_getpc_b64 s[66:67]
pc_2:
    s_sub_u32 s66, s66, pc_2-recurrent_scan__ssm_conv_s5__dense_activation_relu__prompt_kernel
    s_subb_u32 s67, s67, 0
    s_lshl_b32 s57, s35, 2
    s_add_u32 s57, s57, s48
    s_lshl_b32 s57, s57, 10
    s_min_u32 s57, s57, k1_codeend-recurrent_scan__ssm_conv_s5__dense_activation_relu__prompt_kernel-1024
    v_lshlrev_b32 v7, 4, v0
    v_add_u32 v7, s57, v7
    global_load_dwordx4 v[120:123], v7, s[66:67]
nopf_1:
    s_mul_i32 s54, s51, 14
    s_cmp_eq_u32 s51, 7
    s_cselect_b32 s54, 96, s54
    s_waitcnt lgkmcnt(0)
    s_mov_b32 s36, s4
    s_and_b32 s37, s5, 0xffff
    s_mov_b32 s38, 2621440
    s_mov_b32 s39, 0x20000
    s_mov_b32 s44, s32
    s_and_b32 s45, s33, 0xffff
    s_mov_b32 s46, 28311552
    s_mov_b32 s47, 0x20000
    s_cmp_ge_u32 s34, 4
    s_cbranch_scc1 k1_ld
    s_cmp_lg_u32 s49, 0
    s_cbranch_scc1 k1_cF
    v_mul_u32_u24 v9, 820, v1
    v_lshrrev_b32 v9, 16, v9
    v_mul_u32_u24 v10, 80, v9
    v_sub_u32 v10, v1, v10
    s_mul_i32 s57, s51, 80
    v_add_u32 v11, s57, v10
    v_lshlrev_b32 v11, 1, v11
    global_load_ushort v92, v11, s[6:7]
    global_load_ushort v93, v11, s[8:9]
    global_load_ushort v94, v11, s[18:19]
    v_and_b32 v17, 1, v6
    v_lshrrev_b32 v18, 1, v6
    v_lshl_add_u32 v19, v17, 3, v18
    v_xor_b32 v17, v17, v18
    v_xor_b32 v17, v17, v5
    v_lshlrev_b32 v19, 7, v19
    v_lshl_add_u32 v19, v17, 4, v19
    s_mul_i32 s57, s52, 10240
    s_add_u32 s57, s57, 26112
    v_add_u32 v240, s57, v19
    v_xor_b32 v241, 64, v240
    v_and_b32 v18, 7, v0
    v_xor_b32 v18, v18, v5
    v_lshlrev_b32 v17, 7, v6
    s_lshl_b32 s57, s53, 13
    s_add_u32 s57, s57, 46592
    v_add_u32 v17, s57, v17
    v_lshl_add_u32 v246, v18, 4, v17
    v_xor_b32 v247, 64, v246
    v_add_u32 v242, 36864, v240
    v_add_u32 v248, 36864, v246
    v_add_u32 v243, 36864, v241
    v_add_u32 v249, 36864, v247
    v_add_u32 v244, 73728, v240
    v_add_u32 v250, 73728, v246
    v_add_u32 v245, 73728, v241
    v_add_u32 v251, 73728, v247
    v_mov_b32 v128, 0
    v_mov_b32 v129, 0
    v_mov_b32 v130, 0
    v_mov_b32 v131, 0
    v_mov_b32 v132, 0
    v_mov_b32 v133, 0
    v_mov_b32 v134, 0
    v_mov_b32 v135, 0
    v_mov_b32 v136, 0
    v_mov_b32 v137, 0
    v_mov_b32 v138, 0
    v_mov_b32 v139, 0
    v_mov_b32 v140, 0
    v_mov_b32 v141, 0
    v_mov_b32 v142, 0
    v_mov_b32 v143, 0
    v_mov_b32 v144, 0
    v_mov_b32 v145, 0
    v_mov_b32 v146, 0
    v_mov_b32 v147, 0
    v_mov_b32 v148, 0
    v_mov_b32 v149, 0
    v_mov_b32 v150, 0
    v_mov_b32 v151, 0
    v_mov_b32 v152, 0
    v_mov_b32 v153, 0
    v_mov_b32 v154, 0
    v_mov_b32 v155, 0
    v_mov_b32 v156, 0
    v_mov_b32 v157, 0
    v_mov_b32 v158, 0
    v_mov_b32 v159, 0
    v_mov_b32 v160, 0
    v_mov_b32 v161, 0
    v_mov_b32 v162, 0
    v_mov_b32 v163, 0
    v_mov_b32 v164, 0
    v_mov_b32 v165, 0
    v_mov_b32 v166, 0
    v_mov_b32 v167, 0
    v_mov_b32 v168, 0
    v_mov_b32 v169, 0
    v_mov_b32 v170, 0
    v_mov_b32 v171, 0
    v_mov_b32 v172, 0
    v_mov_b32 v173, 0
    v_mov_b32 v174, 0
    v_mov_b32 v175, 0
    v_mov_b32 v176, 0
    v_mov_b32 v177, 0
    v_mov_b32 v178, 0
    v_mov_b32 v179, 0
    v_mov_b32 v180, 0
    v_mov_b32 v181, 0
    v_mov_b32 v182, 0
    v_mov_b32 v183, 0
    v_mov_b32 v184, 0
    v_mov_b32 v185, 0
    v_mov_b32 v186, 0
    v_mov_b32 v187, 0
    v_mov_b32 v188, 0
    v_mov_b32 v189, 0
    v_mov_b32 v190, 0
    v_mov_b32 v191, 0
    v_mov_b32 v192, 0
    v_mov_b32 v193, 0
    v_mov_b32 v194, 0
    v_mov_b32 v195, 0
    v_mov_b32 v196, 0
    v_mov_b32 v197, 0
    v_mov_b32 v198, 0
    v_mov_b32 v199, 0
    v_mov_b32 v200, 0
    v_mov_b32 v201, 0
    v_mov_b32 v202, 0
    v_mov_b32 v203, 0
    v_mov_b32 v204, 0
    v_mov_b32 v205, 0
    v_mov_b32 v206, 0
    v_mov_b32 v207, 0
    s_setprio 2
    v_mov_b32 v15, 2147483632
    v_mov_b32 v26, 0
    v_lshlrev_b32 v2, 2, v0
    s_cmp_lt_u32 s48, 2
    s_cselect_b32 s64, s10, s12
    s_cselect_b32 s65, s11, s13
    s_mov_b32 s40, s64
    s_and_b32 s41, s65, 0xffff
    s_mov_b32 s42, 819200
    s_mov_b32 s43, 0x20000
    s_mul_i32 s57, s51, 80
    s_mul_i32 s58, s50, 5
    s_add_u32 s57, s57, s58
    s_mul_i32 s58, s53, 3
    s_add_u32 s72, s57, s58
    s_barrier
    s_mul_i32 s57, s72, 1280
    buffer_load_dword v72, v2, s[40:43], s57 offen offset:0
    buffer_load_dword v73, v2, s[40:43], s57 offen offset:256
    buffer_load_dword v74, v2, s[40:43], s57 offen offset:512
    buffer_load_dword v75, v2, s[40:43], s57 offen offset:768
    buffer_load_dword v76, v2, s[40:43], s57 offen offset:1024
    s_add_u32 s57, s57, 1280
    buffer_load_dword v77, v2, s[40:43], s57 offen offset:0
    buffer_load_dword v78, v2, s[40:43], s57 offen offset:256
    buffer_load_dword v79, v2, s[40:43], s57 offen offset:512
    buffer_load_dword v80, v2, s[40:43], s57 offen offset:768
    buffer_load_dword v81, v2, s[40:43], s57 offen offset:1024
    s_add_u32 s57, s57, 1280
    buffer_load_dword v82, v2, s[40:43], s57 offen offset:0
    buffer_load_dword v83, v2, s[40:43], s57 offen offset:256
    buffer_load_dword v84, v2, s[40:43], s57 offen offset:512
    buffer_load_dword v85, v2, s[40:43], s57 offen offset:768
    buffer_load_dword v86, v2, s[40:43], s57 offen offset:1024
    s_add_u32 s57, s57, 1280
    global_load_dwordx2 v[28:29], v26, s[30:31] sc1
    s_waitcnt vmcnt(16)
    v_lshlrev_b32 v92, 16, v92
    v_lshlrev_b32 v93, 16, v93
    v_lshlrev_b32 v94, 16, v94
    v_mul_f32 v94, 0x3fb8aa3b, v94
    v_exp_f32 v94, v94
    s_nop 0
    v_cvt_pk_bf16_f32 v94, v94, v94
    v_lshlrev_b32 v94, 16, v94
    v_mul_f32 v95, v94, v92
    v_mul_f32 v96, v94, v93
    v_mul_f32 v95, 0x3fb8aa3b, v95
    v_mul_f32 v96, 0x3e22f983, v96
    v_mul_u32_u24 v97, 288, v10
    v_lshl_add_u32 v97, v9, 3, v97
    v_cmp_gt_u32 vcc, 240, v1
    s_nop 0
    s_and_saveexec_b64 s[66:67], vcc
    v_add_u32 v98, 0, v9
    v_lshlrev_b32 v99, 2, v98
    v_lshlrev_b32 v100, 6, v98
    v_subrev_u32 v100, 1024, v100
    v_cmp_gt_u32 vcc, 16, v98
    s_nop 1
    v_cndmask_b32 v99, v100, v99, vcc
    v_cvt_f32_u32 v99, v99
    v_mul_f32 v100, v99, v95
    v_mul_f32 v101, v99, v96
    v_exp_f32 v100, v100
    v_fract_f32 v101, v101
    v_cos_f32 v102, v101
    v_sin_f32 v103, v101
    v_mul_f32 v102, v100, v102
    v_mul_f32 v103, v100, v103
    ds_write_b64 v97, v[102:103] offset:3072
    v_add_u32 v98, 3, v9
    v_lshlrev_b32 v99, 2, v98
    v_lshlrev_b32 v100, 6, v98
    v_subrev_u32 v100, 1024, v100
    v_cmp_gt_u32 vcc, 16, v98
    s_nop 1
    v_cndmask_b32 v99, v100, v99, vcc
    v_cvt_f32_u32 v99, v99
    v_mul_f32 v100, v99, v95
    v_mul_f32 v101, v99, v96
    v_exp_f32 v100, v100
    v_fract_f32 v101, v101
    v_cos_f32 v102, v101
    v_sin_f32 v103, v101
    v_mul_f32 v102, v100, v102
    v_mul_f32 v103, v100, v103
    ds_write_b64 v97, v[102:103] offset:3096
    v_add_u32 v98, 6, v9
    v_lshlrev_b32 v99, 2, v98
    v_lshlrev_b32 v100, 6, v98
    v_subrev_u32 v100, 1024, v100
    v_cmp_gt_u32 vcc, 16, v98
    s_nop 1
    v_cndmask_b32 v99, v100, v99, vcc
    v_cvt_f32_u32 v99, v99
    v_mul_f32 v100, v99, v95
    v_mul_f32 v101, v99, v96
    v_exp_f32 v100, v100
    v_fract_f32 v101, v101
    v_cos_f32 v102, v101
    v_sin_f32 v103, v101
    v_mul_f32 v102, v100, v102
    v_mul_f32 v103, v100, v103
    ds_write_b64 v97, v[102:103] offset:3120
    v_add_u32 v98, 9, v9
    v_lshlrev_b32 v99, 2, v98
    v_lshlrev_b32 v100, 6, v98
    v_subrev_u32 v100, 1024, v100
    v_cmp_gt_u32 vcc, 16, v98
    s_nop 1
    v_cndmask_b32 v99, v100, v99, vcc
    v_cvt_f32_u32 v99, v99
    v_mul_f32 v100, v99, v95
    v_mul_f32 v101, v99, v96
    v_exp_f32 v100, v100
    v_fract_f32 v101, v101
    v_cos_f32 v102, v101
    v_sin_f32 v103, v101
    v_mul_f32 v102, v100, v102
    v_mul_f32 v103, v100, v103
    ds_write_b64 v97, v[102:103] offset:3144
    v_add_u32 v98, 12, v9
    v_lshlrev_b32 v99, 2, v98
    v_lshlrev_b32 v100, 6, v98
    v_subrev_u32 v100, 1024, v100
    v_cmp_gt_u32 vcc, 16, v98
    s_nop 1
    v_cndmask_b32 v99, v100, v99, vcc
    v_cvt_f32_u32 v99, v99
    v_mul_f32 v100, v99, v95
    v_mul_f32 v101, v99, v96
    v_exp_f32 v100, v100
    v_fract_f32 v101, v101
    v_cos_f32 v102, v101
    v_sin_f32 v103, v101
    v_mul_f32 v102, v100, v102
    v_mul_f32 v103, v100, v103
    ds_write_b64 v97, v[102:103] offset:3168
    v_add_u32 v98, 15, v9
    v_lshlrev_b32 v99, 2, v98
    v_lshlrev_b32 v100, 6, v98
    v_subrev_u32 v100, 1024, v100
    v_cmp_gt_u32 vcc, 16, v98
    s_nop 1
    v_cndmask_b32 v99, v100, v99, vcc
    v_cvt_f32_u32 v99, v99
    v_mul_f32 v100, v99, v95
    v_mul_f32 v101, v99, v96
    v_exp_f32 v100, v100
    v_fract_f32 v101, v101
    v_cos_f32 v102, v101
    v_sin_f32 v103, v101
    v_mul_f32 v102, v100, v102
    v_mul_f32 v103, v100, v103
    ds_write_b64 v97, v[102:103] offset:3192
    v_add_u32 v98, 18, v9
    v_lshlrev_b32 v99, 2, v98
    v_lshlrev_b32 v100, 6, v98
    v_subrev_u32 v100, 1024, v100
    v_cmp_gt_u32 vcc, 16, v98
    s_nop 1
    v_cndmask_b32 v99, v100, v99, vcc
    v_cvt_f32_u32 v99, v99
    v_mul_f32 v100, v99, v95
    v_mul_f32 v101, v99, v96
    v_exp_f32 v100, v100
    v_fract_f32 v101, v101
    v_cos_f32 v102, v101
    v_sin_f32 v103, v101
    v_mul_f32 v102, v100, v102
    v_mul_f32 v103, v100, v103
    ds_write_b64 v97, v[102:103] offset:3216
    v_add_u32 v98, 21, v9
    v_lshlrev_b32 v99, 2, v98
    v_lshlrev_b32 v100, 6, v98
    v_subrev_u32 v100, 1024, v100
    v_cmp_gt_u32 vcc, 16, v98
    s_nop 1
    v_cndmask_b32 v99, v100, v99, vcc
    v_cvt_f32_u32 v99, v99
    v_mul_f32 v100, v99, v95
    v_mul_f32 v101, v99, v96
    v_exp_f32 v100, v100
    v_fract_f32 v101, v101
    v_cos_f32 v102, v101
    v_sin_f32 v103, v101
    v_mul_f32 v102, v100, v102
    v_mul_f32 v103, v100, v103
    ds_write_b64 v97, v[102:103] offset:3240
    v_add_u32 v98, 24, v9
    v_lshlrev_b32 v99, 2, v98
    v_lshlrev_b32 v100, 6, v98
    v_subrev_u32 v100, 1024, v100
    v_cmp_gt_u32 vcc, 16, v98
    s_nop 1
    v_cndmask_b32 v99, v100, v99, vcc
    v_cvt_f32_u32 v99, v99
    v_mul_f32 v100, v99, v95
    v_mul_f32 v101, v99, v96
    v_exp_f32 v100, v100
    v_fract_f32 v101, v101
    v_cos_f32 v102, v101
    v_sin_f32 v103, v101
    v_mul_f32 v102, v100, v102
    v_mul_f32 v103, v100, v103
    ds_write_b64 v97, v[102:103] offset:3264
    v_add_u32 v98, 27, v9
    v_lshlrev_b32 v99, 2, v98
    v_lshlrev_b32 v100, 6, v98
    v_subrev_u32 v100, 1024, v100
    v_cmp_gt_u32 vcc, 16, v98
    s_nop 1
    v_cndmask_b32 v99, v100, v99, vcc
    v_cvt_f32_u32 v99, v99
    v_mul_f32 v100, v99, v95
    v_mul_f32 v101, v99, v96
    v_exp_f32 v100, v100
    v_fract_f32 v101, v101
    v_cos_f32 v102, v101
    v_sin_f32 v103, v101
    v_mul_f32 v102, v100, v102
    v_mul_f32 v103, v100, v103
    ds_write_b64 v97, v[102:103] offset:3288
    v_add_u32 v98, 30, v9
    v_lshlrev_b32 v99, 2, v98
    v_lshlrev_b32 v100, 6, v98
    v_subrev_u32 v100, 1024, v100
    v_cmp_gt_u32 vcc, 16, v98
    s_nop 1
    v_cndmask_b32 v99, v100, v99, vcc
    v_cvt_f32_u32 v99, v99
    v_mul_f32 v100, v99, v95
    v_mul_f32 v101, v99, v96
    v_exp_f32 v100, v100
    v_fract_f32 v101, v101
    v_cos_f32 v102, v101
    v_sin_f32 v103, v101
    v_mul_f32 v102, v100, v102
    v_mul_f32 v103, v100, v103
    ds_write_b64 v97, v[102:103] offset:3312
    s_mov_b64 exec, s[66:67]
    v_exp_f32 v100, v95
    v_fract_f32 v101, v96
    v_cos_f32 v102, v101
    v_sin_f32 v103, v101
    v_mul_f32 v102, v100, v102
    v_mul_f32 v103, v100, v103
    v_add_f32 v98, -1.0, v102
    v_mul_f32 v99, v92, v92
    v_fmac_f32 v99, v93, v93
    v_rcp_f32 v100, v99
    s_nop 0
    v_fma_f32 v101, -v99, v100, 1.0
    v_fma_f32 v100, v101, v100, v100
    v_add_f32 v100, v100, v100
    v_mul_f32 v104, v98, v92
    v_fmac_f32 v104, v103, v93
    v_mul_f32 v105, v103, v92
    v_fma_f32 v105, -v98, v93, v105
    v_mul_f32 v104, v104, v100
    v_mul_f32 v105, v105, v100
    v_cmp_gt_u32 vcc, 80, v1
    s_nop 0
    s_and_saveexec_b64 s[66:67], vcc
    ds_write_b128 v97, v[102:105] offset:3344
    s_mov_b64 exec, s[66:67]
    s_waitcnt lgkmcnt(0)
    s_waitcnt vmcnt(0)
    s_mov_b32 s57, 0x3f803f80
    v_mov_b32 v108, 0
    v_mov_b32 v109, 0
    v_mov_b32 v110, 0
    v_dot2_f32_bf16 v108, v72, s57, v108
    v_dot2_f32_bf16 v109, v77, s57, v109
    v_dot2_f32_bf16 v110, v82, s57, v110
    v_dot2_f32_bf16 v108, v73, s57, v108
    v_dot2_f32_bf16 v109, v78, s57, v109
    v_dot2_f32_bf16 v110, v83, s57, v110
    v_dot2_f32_bf16 v108, v74, s57, v108
    v_dot2_f32_bf16 v109, v79, s57, v109
    v_dot2_f32_bf16 v110, v84, s57, v110
    v_dot2_f32_bf16 v108, v75, s57, v108
    v_dot2_f32_bf16 v109, v80, s57, v109
    v_dot2_f32_bf16 v110, v85, s57, v110
    v_dot2_f32_bf16 v108, v76, s57, v108
    v_dot2_f32_bf16 v109, v81, s57, v109
    v_dot2_f32_bf16 v110, v86, s57, v110
    s_nop 3
    v_add_f32_dpp v108, v108, v108 row_shr:1 row_mask:0xf bank_mask:0xf bound_ctrl:0
    v_add_f32_dpp v109, v109, v109 row_shr:1 row_mask:0xf bank_mask:0xf bound_ctrl:0
    v_add_f32_dpp v110, v110, v110 row_shr:1 row_mask:0xf bank_mask:0xf bound_ctrl:0
    v_add_f32_dpp v108, v108, v108 row_shr:2 row_mask:0xf bank_mask:0xf bound_ctrl:0
    v_add_f32_dpp v109, v109, v109 row_shr:2 row_mask:0xf bank_mask:0xf bound_ctrl:0
    v_add_f32_dpp v110, v110, v110 row_shr:2 row_mask:0xf bank_mask:0xf bound_ctrl:0
    v_add_f32_dpp v108, v108, v108 row_shr:4 row_mask:0xf bank_mask:0xf bound_ctrl:0
    v_add_f32_dpp v109, v109, v109 row_shr:4 row_mask:0xf bank_mask:0xf bound_ctrl:0
    v_add_f32_dpp v110, v110, v110 row_shr:4 row_mask:0xf bank_mask:0xf bound_ctrl:0
    v_add_f32_dpp v108, v108, v108 row_shr:8 row_mask:0xf bank_mask:0xf bound_ctrl:0
    v_add_f32_dpp v109, v109, v109 row_shr:8 row_mask:0xf bank_mask:0xf bound_ctrl:0
    v_add_f32_dpp v110, v110, v110 row_shr:8 row_mask:0xf bank_mask:0xf bound_ctrl:0
    v_add_f32_dpp v108, v108, v108 row_bcast:15 row_mask:0xa bank_mask:0xf
    v_add_f32_dpp v109, v109, v109 row_bcast:15 row_mask:0xa bank_mask:0xf
    v_add_f32_dpp v110, v110, v110 row_bcast:15 row_mask:0xa bank_mask:0xf
    v_add_f32_dpp v108, v108, v108 row_bcast:31 row_mask:0xc bank_mask:0xf
    v_add_f32_dpp v109, v109, v109 row_bcast:31 row_mask:0xc bank_mask:0xf
    v_add_f32_dpp v110, v110, v110 row_bcast:31 row_mask:0xc bank_mask:0xf
    v_cmp_eq_u32 vcc, 63, v0
    s_nop 1
    v_cndmask_b32 v12, v15, v26, vcc
    s_lshl_b32 s57, s72, 1
    s_add_u32 s57, s57, s52
    s_lshl_b32 s57, s57, 2
    s_add_u32 s57, s57, 917504
    buffer_store_dword v108, v12, s[44:47], s57 offen sc1
    buffer_store_dword v109, v12, s[44:47], s57 offen offset:8 sc1
    s_cmp_eq_u32 s53, 0
    s_cselect_b32 s57, s57, 2147483632
    buffer_store_dword v110, v12, s[44:47], s57 offen offset:16 sc1
    v_cmp_eq_u32 vcc, 0, v0
    s_nop 1
    v_cndmask_b32 v16, v15, v26, vcc
    s_lshl_b32 s57, s49, 7
    s_lshl_b32 s58, s50, 3
    s_add_u32 s57, s57, s58
    s_add_u32 s57, s57, s51
    s_lshl_b32 s57, s57, 7
    s_lshl_b32 s58, s48, 3
    s_add_u32 s57, s57, s58
    s_add_u32 s76, s57, 950272
    s_barrier
    ds_read_b128 v[52:55], v246 offset:0
    ds_read_b128 v[56:59], v246 offset:2048
    ds_read_b128 v[60:63], v246 offset:4096
    ds_read_b128 v[64:67], v246 offset:6144
    ds_read_b128 v[32:35], v240 offset:0
    ds_read_b128 v[36:39], v240 offset:2048
    ds_read_b128 v[40:43], v240 offset:4096
    ds_read_b128 v[44:47], v240 offset:6144
    ds_read_b128 v[48:51], v240 offset:8192
    s_waitcnt lgkmcnt(0)
    v_mfma_f32_16x16x32_bf16 v[128:131], v[32:35], v[52:55], v[128:131]
    ds_read_b128 v[88:91], v247 offset:0
    v_mfma_f32_16x16x32_bf16 v[132:135], v[32:35], v[56:59], v[132:135]
    ds_read_b128 v[92:95], v247 offset:2048
    v_mfma_f32_16x16x32_bf16 v[136:139], v[32:35], v[60:63], v[136:139]
    ds_read_b128 v[96:99], v247 offset:4096
    v_mfma_f32_16x16x32_bf16 v[140:143], v[32:35], v[64:67], v[140:143]
    ds_read_b128 v[100:103], v247 offset:6144
    v_mfma_f32_16x16x32_bf16 v[144:147], v[36:39], v[52:55], v[144:147]
    ds_read_b128 v[68:71], v241 offset:0
    v_mfma_f32_16x16x32_bf16 v[148:151], v[36:39], v[56:59], v[148:151]
    ds_read_b128 v[72:75], v241 offset:2048
    v_mfma_f32_16x16x32_bf16 v[152:155], v[36:39], v[60:63], v[152:155]
    ds_read_b128 v[76:79], v241 offset:4096
    v_mfma_f32_16x16x32_bf16 v[156:159], v[36:39], v[64:67], v[156:159]
    ds_read_b128 v[80:83], v241 offset:6144
    v_mfma_f32_16x16x32_bf16 v[160:163], v[40:43], v[52:55], v[160:163]
    ds_read_b128 v[84:87], v241 offset:8192
    v_mfma_f32_16x16x32_bf16 v[164:167], v[40:43], v[56:59], v[164:167]
    v_mfma_f32_16x16x32_bf16 v[168:171], v[40:43], v[60:63], v[168:171]
    v_mfma_f32_16x16x32_bf16 v[172:175], v[40:43], v[64:67], v[172:175]
    v_mfma_f32_16x16x32_bf16 v[176:179], v[44:47], v[52:55], v[176:179]
    v_mfma_f32_16x16x32_bf16 v[180:183], v[44:47], v[56:59], v[180:183]
    v_mfma_f32_16x16x32_bf16 v[184:187], v[44:47], v[60:63], v[184:187]
    v_mfma_f32_16x16x32_bf16 v[188:191], v[44:47], v[64:67], v[188:191]
    v_mfma_f32_16x16x32_bf16 v[192:195], v[48:51], v[52:55], v[192:195]
    v_mfma_f32_16x16x32_bf16 v[196:199], v[48:51], v[56:59], v[196:199]
    v_mfma_f32_16x16x32_bf16 v[200:203], v[48:51], v[60:63], v[200:203]
    v_mfma_f32_16x16x32_bf16 v[204:207], v[48:51], v[64:67], v[204:207]
    s_waitcnt lgkmcnt(0)
    v_mfma_f32_16x16x32_bf16 v[128:131], v[68:71], v[88:91], v[128:131]
    v_mfma_f32_16x16x32_bf16 v[132:135], v[68:71], v[92:95], v[132:135]
    v_mfma_f32_16x16x32_bf16 v[136:139], v[68:71], v[96:99], v[136:139]
    s_barrier
    ds_read_b128 v[52:55], v248 offset:0
    v_mfma_f32_16x16x32_bf16 v[140:143], v[68:71], v[100:103], v[140:143]
    ds_read_b128 v[56:59], v248 offset:2048
    v_mfma_f32_16x16x32_bf16 v[144:147], v[72:75], v[88:91], v[144:147]
    ds_read_b128 v[60:63], v248 offset:4096
    v_mfma_f32_16x16x32_bf16 v[148:151], v[72:75], v[92:95], v[148:151]
    ds_read_b128 v[64:67], v248 offset:6144
    v_mfma_f32_16x16x32_bf16 v[152:155], v[72:75], v[96:99], v[152:155]
    ds_read_b128 v[32:35], v242 offset:0
    v_mfma_f32_16x16x32_bf16 v[156:159], v[72:75], v[100:103], v[156:159]
    ds_read_b128 v[36:39], v242 offset:2048
    v_mfma_f32_16x16x32_bf16 v[160:163], v[76:79], v[88:91], v[160:163]
    ds_read_b128 v[40:43], v242 offset:4096
    v_mfma_f32_16x16x32_bf16 v[164:167], v[76:79], v[92:95], v[164:167]
    ds_read_b128 v[44:47], v242 offset:6144
    v_mfma_f32_16x16x32_bf16 v[168:171], v[76:79], v[96:99], v[168:171]
    ds_read_b128 v[48:51], v242 offset:8192
    v_mfma_f32_16x16x32_bf16 v[172:175], v[76:79], v[100:103], v[172:175]
    v_mfma_f32_16x16x32_bf16 v[176:179], v[80:83], v[88:91], v[176:179]
    v_mfma_f32_16x16x32_bf16 v[180:183], v[80:83], v[92:95], v[180:183]
    v_mfma_f32_16x16x32_bf16 v[184:187], v[80:83], v[96:99], v[184:187]
    v_mfma_f32_16x16x32_bf16 v[188:191], v[80:83], v[100:103], v[188:191]
    v_mfma_f32_16x16x32_bf16 v[192:195], v[84:87], v[88:91], v[192:195]
    v_mfma_f32_16x16x32_bf16 v[196:199], v[84:87], v[92:95], v[196:199]
    v_mfma_f32_16x16x32_bf16 v[200:203], v[84:87], v[96:99], v[200:203]
    v_mfma_f32_16x16x32_bf16 v[204:207], v[84:87], v[100:103], v[204:207]
    s_waitcnt lgkmcnt(0)
    v_mfma_f32_16x16x32_bf16 v[128:131], v[32:35], v[52:55], v[128:131]
    ds_read_b128 v[88:91], v249 offset:0
    v_mfma_f32_16x16x32_bf16 v[132:135], v[32:35], v[56:59], v[132:135]
    ds_read_b128 v[92:95], v249 offset:2048
    v_mfma_f32_16x16x32_bf16 v[136:139], v[32:35], v[60:63], v[136:139]
    ds_read_b128 v[96:99], v249 offset:4096
    v_mfma_f32_16x16x32_bf16 v[140:143], v[32:35], v[64:67], v[140:143]
    ds_read_b128 v[100:103], v249 offset:6144
    v_mfma_f32_16x16x32_bf16 v[144:147], v[36:39], v[52:55], v[144:147]
    ds_read_b128 v[68:71], v243 offset:0
    v_mfma_f32_16x16x32_bf16 v[148:151], v[36:39], v[56:59], v[148:151]
    ds_read_b128 v[72:75], v243 offset:2048
    v_mfma_f32_16x16x32_bf16 v[152:155], v[36:39], v[60:63], v[152:155]
    ds_read_b128 v[76:79], v243 offset:4096
    v_mfma_f32_16x16x32_bf16 v[156:159], v[36:39], v[64:67], v[156:159]
    ds_read_b128 v[80:83], v243 offset:6144
    v_mfma_f32_16x16x32_bf16 v[160:163], v[40:43], v[52:55], v[160:163]
    ds_read_b128 v[84:87], v243 offset:8192
    v_mfma_f32_16x16x32_bf16 v[164:167], v[40:43], v[56:59], v[164:167]
    v_mfma_f32_16x16x32_bf16 v[168:171], v[40:43], v[60:63], v[168:171]
    v_mfma_f32_16x16x32_bf16 v[172:175], v[40:43], v[64:67], v[172:175]
    v_mfma_f32_16x16x32_bf16 v[176:179], v[44:47], v[52:55], v[176:179]
    v_mfma_f32_16x16x32_bf16 v[180:183], v[44:47], v[56:59], v[180:183]
    v_mfma_f32_16x16x32_bf16 v[184:187], v[44:47], v[60:63], v[184:187]
    v_mfma_f32_16x16x32_bf16 v[188:191], v[44:47], v[64:67], v[188:191]
    v_mfma_f32_16x16x32_bf16 v[192:195], v[48:51], v[52:55], v[192:195]
    v_mfma_f32_16x16x32_bf16 v[196:199], v[48:51], v[56:59], v[196:199]
    v_mfma_f32_16x16x32_bf16 v[200:203], v[48:51], v[60:63], v[200:203]
    v_mfma_f32_16x16x32_bf16 v[204:207], v[48:51], v[64:67], v[204:207]
    s_waitcnt lgkmcnt(0)
    v_mfma_f32_16x16x32_bf16 v[128:131], v[68:71], v[88:91], v[128:131]
    v_mfma_f32_16x16x32_bf16 v[132:135], v[68:71], v[92:95], v[132:135]
    v_mfma_f32_16x16x32_bf16 v[136:139], v[68:71], v[96:99], v[136:139]
    s_waitcnt vmcnt(0)
    s_mov_b32 s58, 200000
np_4:
    v_readfirstlane_b32 s57, v28
    s_nop 0
    s_cmp_lg_u32 s57, 0
    s_cbranch_scc1 npx_5
    s_sleep 1
    global_load_dwordx2 v[28:29], v26, s[30:31] sc1
    s_waitcnt vmcnt(0)
    s_sub_u32 s58, s58, 1
    s_cmp_lg_u32 s58, 0
    s_cbranch_scc1 np_4
npx_5:
    buffer_store_dwordx2 v[28:29], v16, s[44:47], s76 offen offset:0 sc1
    s_barrier
    ds_read_b128 v[52:55], v250 offset:0
    v_mfma_f32_16x16x32_bf16 v[140:143], v[68:71], v[100:103], v[140:143]
    ds_read_b128 v[56:59], v250 offset:2048
    v_mfma_f32_16x16x32_bf16 v[144:147], v[72:75], v[88:91], v[144:147]
    ds_read_b128 v[60:63], v250 offset:4096
    v_mfma_f32_16x16x32_bf16 v[148:151], v[72:75], v[92:95], v[148:151]
    ds_read_b128 v[64:67], v250 offset:6144
    v_mfma_f32_16x16x32_bf16 v[152:155], v[72:75], v[96:99], v[152:155]
    ds_read_b128 v[32:35], v244 offset:0
    v_mfma_f32_16x16x32_bf16 v[156:159], v[72:75], v[100:103], v[156:159]
    ds_read_b128 v[36:39], v244 offset:2048
    v_mfma_f32_16x16x32_bf16 v[160:163], v[76:79], v[88:91], v[160:163]
    ds_read_b128 v[40:43], v244 offset:4096
    v_mfma_f32_16x16x32_bf16 v[164:167], v[76:79], v[92:95], v[164:167]
    ds_read_b128 v[44:47], v244 offset:6144
    v_mfma_f32_16x16x32_bf16 v[168:171], v[76:79], v[96:99], v[168:171]
    ds_read_b128 v[48:51], v244 offset:8192
    v_mfma_f32_16x16x32_bf16 v[172:175], v[76:79], v[100:103], v[172:175]
    v_mfma_f32_16x16x32_bf16 v[176:179], v[80:83], v[88:91], v[176:179]
    v_mfma_f32_16x16x32_bf16 v[180:183], v[80:83], v[92:95], v[180:183]
    v_mfma_f32_16x16x32_bf16 v[184:187], v[80:83], v[96:99], v[184:187]
    v_mfma_f32_16x16x32_bf16 v[188:191], v[80:83], v[100:103], v[188:191]
    v_mfma_f32_16x16x32_bf16 v[192:195], v[84:87], v[88:91], v[192:195]
    v_mfma_f32_16x16x32_bf16 v[196:199], v[84:87], v[92:95], v[196:199]
    v_mfma_f32_16x16x32_bf16 v[200:203], v[84:87], v[96:99], v[200:203]
    v_mfma_f32_16x16x32_bf16 v[204:207], v[84:87], v[100:103], v[204:207]
    s_waitcnt lgkmcnt(0)
    v_mfma_f32_16x16x32_bf16 v[128:131], v[32:35], v[52:55], v[128:131]
    ds_read_b128 v[88:91], v251 offset:0
    v_mfma_f32_16x16x32_bf16 v[132:135], v[32:35], v[56:59], v[132:135]
    ds_read_b128 v[92:95], v251 offset:2048
    v_mfma_f32_16x16x32_bf16 v[136:139], v[32:35], v[60:63], v[136:139]
    ds_read_b128 v[96:99], v251 offset:4096
    v_mfma_f32_16x16x32_bf16 v[140:143], v[32:35], v[64:67], v[140:143]
    ds_read_b128 v[100:103], v251 offset:6144
    v_mfma_f32_16x16x32_bf16 v[144:147], v[36:39], v[52:55], v[144:147]
    ds_read_b128 v[68:71], v245 offset:0
    v_mfma_f32_16x16x32_bf16 v[148:151], v[36:39], v[56:59], v[148:151]
    ds_read_b128 v[72:75], v245 offset:2048
    v_mfma_f32_16x16x32_bf16 v[152:155], v[36:39], v[60:63], v[152:155]
    ds_read_b128 v[76:79], v245 offset:4096
    v_mfma_f32_16x16x32_bf16 v[156:159], v[36:39], v[64:67], v[156:159]
    ds_read_b128 v[80:83], v245 offset:6144
    v_mfma_f32_16x16x32_bf16 v[160:163], v[40:43], v[52:55], v[160:163]
    ds_read_b128 v[84:87], v245 offset:8192
    v_mfma_f32_16x16x32_bf16 v[164:167], v[40:43], v[56:59], v[164:167]
    v_mfma_f32_16x16x32_bf16 v[168:171], v[40:43], v[60:63], v[168:171]
    v_mfma_f32_16x16x32_bf16 v[172:175], v[40:43], v[64:67], v[172:175]
    v_mfma_f32_16x16x32_bf16 v[176:179], v[44:47], v[52:55], v[176:179]
    v_mfma_f32_16x16x32_bf16 v[180:183], v[44:47], v[56:59], v[180:183]
    v_mfma_f32_16x16x32_bf16 v[184:187], v[44:47], v[60:63], v[184:187]
    v_mfma_f32_16x16x32_bf16 v[188:191], v[44:47], v[64:67], v[188:191]
    v_mfma_f32_16x16x32_bf16 v[192:195], v[48:51], v[52:55], v[192:195]
    v_mfma_f32_16x16x32_bf16 v[196:199], v[48:51], v[56:59], v[196:199]
    v_mfma_f32_16x16x32_bf16 v[200:203], v[48:51], v[60:63], v[200:203]
    v_mfma_f32_16x16x32_bf16 v[204:207], v[48:51], v[64:67], v[204:207]
    s_waitcnt lgkmcnt(0)
    v_mfma_f32_16x16x32_bf16 v[128:131], v[68:71], v[88:91], v[128:131]
    v_mfma_f32_16x16x32_bf16 v[132:135], v[68:71], v[92:95], v[132:135]
    v_mfma_f32_16x16x32_bf16 v[136:139], v[68:71], v[96:99], v[136:139]
    s_barrier
    ds_read_b128 v[52:55], v246 offset:0
    v_mfma_f32_16x16x32_bf16 v[140:143], v[68:71], v[100:103], v[140:143]
    ds_read_b128 v[56:59], v246 offset:2048
    v_mfma_f32_16x16x32_bf16 v[144:147], v[72:75], v[88:91], v[144:147]
    ds_read_b128 v[60:63], v246 offset:4096
    v_mfma_f32_16x16x32_bf16 v[148:151], v[72:75], v[92:95], v[148:151]
    ds_read_b128 v[64:67], v246 offset:6144
    v_mfma_f32_16x16x32_bf16 v[152:155], v[72:75], v[96:99], v[152:155]
    ds_read_b128 v[32:35], v240 offset:0
    v_mfma_f32_16x16x32_bf16 v[156:159], v[72:75], v[100:103], v[156:159]
    ds_read_b128 v[36:39], v240 offset:2048
    v_mfma_f32_16x16x32_bf16 v[160:163], v[76:79], v[88:91], v[160:163]
    ds_read_b128 v[40:43], v240 offset:4096
    v_mfma_f32_16x16x32_bf16 v[164:167], v[76:79], v[92:95], v[164:167]
    ds_read_b128 v[44:47], v240 offset:6144
    v_mfma_f32_16x16x32_bf16 v[168:171], v[76:79], v[96:99], v[168:171]
    ds_read_b128 v[48:51], v240 offset:8192
    v_mfma_f32_16x16x32_bf16 v[172:175], v[76:79], v[100:103], v[172:175]
    v_mfma_f32_16x16x32_bf16 v[176:179], v[80:83], v[88:91], v[176:179]
    v_mfma_f32_16x16x32_bf16 v[180:183], v[80:83], v[92:95], v[180:183]
    v_mfma_f32_16x16x32_bf16 v[184:187], v[80:83], v[96:99], v[184:187]
    v_mfma_f32_16x16x32_bf16 v[188:191], v[80:83], v[100:103], v[188:191]
    v_mfma_f32_16x16x32_bf16 v[192:195], v[84:87], v[88:91], v[192:195]
    v_mfma_f32_16x16x32_bf16 v[196:199], v[84:87], v[92:95], v[196:199]
    v_mfma_f32_16x16x32_bf16 v[200:203], v[84:87], v[96:99], v[200:203]
    v_mfma_f32_16x16x32_bf16 v[204:207], v[84:87], v[100:103], v[204:207]
    s_waitcnt lgkmcnt(0)
    v_mfma_f32_16x16x32_bf16 v[128:131], v[32:35], v[52:55], v[128:131]
    ds_read_b128 v[88:91], v247 offset:0
    v_mfma_f32_16x16x32_bf16 v[132:135], v[32:35], v[56:59], v[132:135]
    ds_read_b128 v[92:95], v247 offset:2048
    v_mfma_f32_16x16x32_bf16 v[136:139], v[32:35], v[60:63], v[136:139]
    ds_read_b128 v[96:99], v247 offset:4096
    v_mfma_f32_16x16x32_bf16 v[140:143], v[32:35], v[64:67], v[140:143]
    ds_read_b128 v[100:103], v247 offset:6144
    v_mfma_f32_16x16x32_bf16 v[144:147], v[36:39], v[52:55], v[144:147]
    ds_read_b128 v[68:71], v241 offset:0
    v_mfma_f32_16x16x32_bf16 v[148:151], v[36:39], v[56:59], v[148:151]
    ds_read_b128 v[72:75], v241 offset:2048
    v_mfma_f32_16x16x32_bf16 v[152:155], v[36:39], v[60:63], v[152:155]
    ds_read_b128 v[76:79], v241 offset:4096
    v_mfma_f32_16x16x32_bf16 v[156:159], v[36:39], v[64:67], v[156:159]
    ds_read_b128 v[80:83], v241 offset:6144
    v_mfma_f32_16x16x32_bf16 v[160:163], v[40:43], v[52:55], v[160:163]
    ds_read_b128 v[84:87], v241 offset:8192
    v_mfma_f32_16x16x32_bf16 v[164:167], v[40:43], v[56:59], v[164:167]
    v_mfma_f32_16x16x32_bf16 v[168:171], v[40:43], v[60:63], v[168:171]
    v_mfma_f32_16x16x32_bf16 v[172:175], v[40:43], v[64:67], v[172:175]
    v_mfma_f32_16x16x32_bf16 v[176:179], v[44:47], v[52:55], v[176:179]
    v_mfma_f32_16x16x32_bf16 v[180:183], v[44:47], v[56:59], v[180:183]
    v_mfma_f32_16x16x32_bf16 v[184:187], v[44:47], v[60:63], v[184:187]
    v_mfma_f32_16x16x32_bf16 v[188:191], v[44:47], v[64:67], v[188:191]
    v_mfma_f32_16x16x32_bf16 v[192:195], v[48:51], v[52:55], v[192:195]
    v_mfma_f32_16x16x32_bf16 v[196:199], v[48:51], v[56:59], v[196:199]
    v_mfma_f32_16x16x32_bf16 v[200:203], v[48:51], v[60:63], v[200:203]
    v_mfma_f32_16x16x32_bf16 v[204:207], v[48:51], v[64:67], v[204:207]
    s_waitcnt lgkmcnt(0)
    v_mfma_f32_16x16x32_bf16 v[128:131], v[68:71], v[88:91], v[128:131]
    v_mfma_f32_16x16x32_bf16 v[132:135], v[68:71], v[92:95], v[132:135]
    v_mfma_f32_16x16x32_bf16 v[136:139], v[68:71], v[96:99], v[136:139]
    s_barrier
    ds_read_b128 v[52:55], v248 offset:0
    v_mfma_f32_16x16x32_bf16 v[140:143], v[68:71], v[100:103], v[140:143]
    ds_read_b128 v[56:59], v248 offset:2048
    v_mfma_f32_16x16x32_bf16 v[144:147], v[72:75], v[88:91], v[144:147]
    ds_read_b128 v[60:63], v248 offset:4096
    v_mfma_f32_16x16x32_bf16 v[148:151], v[72:75], v[92:95], v[148:151]
    ds_read_b128 v[64:67], v248 offset:6144
    v_mfma_f32_16x16x32_bf16 v[152:155], v[72:75], v[96:99], v[152:155]
    ds_read_b128 v[32:35], v242 offset:0
    v_mfma_f32_16x16x32_bf16 v[156:159], v[72:75], v[100:103], v[156:159]
    ds_read_b128 v[36:39], v242 offset:2048
    v_mfma_f32_16x16x32_bf16 v[160:163], v[76:79], v[88:91], v[160:163]
    ds_read_b128 v[40:43], v242 offset:4096
    v_mfma_f32_16x16x32_bf16 v[164:167], v[76:79], v[92:95], v[164:167]
    ds_read_b128 v[44:47], v242 offset:6144
    v_mfma_f32_16x16x32_bf16 v[168:171], v[76:79], v[96:99], v[168:171]
    ds_read_b128 v[48:51], v242 offset:8192
    v_mfma_f32_16x16x32_bf16 v[172:175], v[76:79], v[100:103], v[172:175]
    v_mfma_f32_16x16x32_bf16 v[176:179], v[80:83], v[88:91], v[176:179]
    v_mfma_f32_16x16x32_bf16 v[180:183], v[80:83], v[92:95], v[180:183]
    v_mfma_f32_16x16x32_bf16 v[184:187], v[80:83], v[96:99], v[184:187]
    v_mfma_f32_16x16x32_bf16 v[188:191], v[80:83], v[100:103], v[188:191]
    v_mfma_f32_16x16x32_bf16 v[192:195], v[84:87], v[88:91], v[192:195]
    v_mfma_f32_16x16x32_bf16 v[196:199], v[84:87], v[92:95], v[196:199]
    v_mfma_f32_16x16x32_bf16 v[200:203], v[84:87], v[96:99], v[200:203]
    v_mfma_f32_16x16x32_bf16 v[204:207], v[84:87], v[100:103], v[204:207]
    s_waitcnt lgkmcnt(0)
    v_mfma_f32_16x16x32_bf16 v[128:131], v[32:35], v[52:55], v[128:131]
    ds_read_b128 v[88:91], v249 offset:0
    v_mfma_f32_16x16x32_bf16 v[132:135], v[32:35], v[56:59], v[132:135]
    ds_read_b128 v[92:95], v249 offset:2048
    v_mfma_f32_16x16x32_bf16 v[136:139], v[32:35], v[60:63], v[136:139]
    ds_read_b128 v[96:99], v249 offset:4096
    v_mfma_f32_16x16x32_bf16 v[140:143], v[32:35], v[64:67], v[140:143]
    ds_read_b128 v[100:103], v249 offset:6144
    v_mfma_f32_16x16x32_bf16 v[144:147], v[36:39], v[52:55], v[144:147]
    ds_read_b128 v[68:71], v243 offset:0
    v_mfma_f32_16x16x32_bf16 v[148:151], v[36:39], v[56:59], v[148:151]
    ds_read_b128 v[72:75], v243 offset:2048
    v_mfma_f32_16x16x32_bf16 v[152:155], v[36:39], v[60:63], v[152:155]
    ds_read_b128 v[76:79], v243 offset:4096
    v_mfma_f32_16x16x32_bf16 v[156:159], v[36:39], v[64:67], v[156:159]
    ds_read_b128 v[80:83], v243 offset:6144
    v_mfma_f32_16x16x32_bf16 v[160:163], v[40:43], v[52:55], v[160:163]
    ds_read_b128 v[84:87], v243 offset:8192
    v_mfma_f32_16x16x32_bf16 v[164:167], v[40:43], v[56:59], v[164:167]
    v_mfma_f32_16x16x32_bf16 v[168:171], v[40:43], v[60:63], v[168:171]
    v_mfma_f32_16x16x32_bf16 v[172:175], v[40:43], v[64:67], v[172:175]
    v_mfma_f32_16x16x32_bf16 v[176:179], v[44:47], v[52:55], v[176:179]
    v_mfma_f32_16x16x32_bf16 v[180:183], v[44:47], v[56:59], v[180:183]
    v_mfma_f32_16x16x32_bf16 v[184:187], v[44:47], v[60:63], v[184:187]
    v_mfma_f32_16x16x32_bf16 v[188:191], v[44:47], v[64:67], v[188:191]
    v_mfma_f32_16x16x32_bf16 v[192:195], v[48:51], v[52:55], v[192:195]
    v_mfma_f32_16x16x32_bf16 v[196:199], v[48:51], v[56:59], v[196:199]
    v_mfma_f32_16x16x32_bf16 v[200:203], v[48:51], v[60:63], v[200:203]
    v_mfma_f32_16x16x32_bf16 v[204:207], v[48:51], v[64:67], v[204:207]
    s_waitcnt lgkmcnt(0)
    v_mfma_f32_16x16x32_bf16 v[128:131], v[68:71], v[88:91], v[128:131]
    v_mfma_f32_16x16x32_bf16 v[132:135], v[68:71], v[92:95], v[132:135]
    v_mfma_f32_16x16x32_bf16 v[136:139], v[68:71], v[96:99], v[136:139]
    s_barrier
    ds_read_b128 v[52:55], v250 offset:0
    v_mfma_f32_16x16x32_bf16 v[140:143], v[68:71], v[100:103], v[140:143]
    ds_read_b128 v[56:59], v250 offset:2048
    v_mfma_f32_16x16x32_bf16 v[144:147], v[72:75], v[88:91], v[144:147]
    ds_read_b128 v[60:63], v250 offset:4096
    v_mfma_f32_16x16x32_bf16 v[148:151], v[72:75], v[92:95], v[148:151]
    ds_read_b128 v[64:67], v250 offset:6144
    v_mfma_f32_16x16x32_bf16 v[152:155], v[72:75], v[96:99], v[152:155]
    ds_read_b128 v[32:35], v244 offset:0
    v_mfma_f32_16x16x32_bf16 v[156:159], v[72:75], v[100:103], v[156:159]
    ds_read_b128 v[36:39], v244 offset:2048
    v_mfma_f32_16x16x32_bf16 v[160:163], v[76:79], v[88:91], v[160:163]
    ds_read_b128 v[40:43], v244 offset:4096
    v_mfma_f32_16x16x32_bf16 v[164:167], v[76:79], v[92:95], v[164:167]
    ds_read_b128 v[44:47], v244 offset:6144
    v_mfma_f32_16x16x32_bf16 v[168:171], v[76:79], v[96:99], v[168:171]
    ds_read_b128 v[48:51], v244 offset:8192
    v_mfma_f32_16x16x32_bf16 v[172:175], v[76:79], v[100:103], v[172:175]
    v_mfma_f32_16x16x32_bf16 v[176:179], v[80:83], v[88:91], v[176:179]
    v_mfma_f32_16x16x32_bf16 v[180:183], v[80:83], v[92:95], v[180:183]
    v_mfma_f32_16x16x32_bf16 v[184:187], v[80:83], v[96:99], v[184:187]
    v_mfma_f32_16x16x32_bf16 v[188:191], v[80:83], v[100:103], v[188:191]
    v_mfma_f32_16x16x32_bf16 v[192:195], v[84:87], v[88:91], v[192:195]
    v_mfma_f32_16x16x32_bf16 v[196:199], v[84:87], v[92:95], v[196:199]
    v_mfma_f32_16x16x32_bf16 v[200:203], v[84:87], v[96:99], v[200:203]
    v_mfma_f32_16x16x32_bf16 v[204:207], v[84:87], v[100:103], v[204:207]
    s_waitcnt lgkmcnt(0)
    v_mfma_f32_16x16x32_bf16 v[128:131], v[32:35], v[52:55], v[128:131]
    ds_read_b128 v[88:91], v251 offset:0
    v_mfma_f32_16x16x32_bf16 v[132:135], v[32:35], v[56:59], v[132:135]
    ds_read_b128 v[92:95], v251 offset:2048
    v_mfma_f32_16x16x32_bf16 v[136:139], v[32:35], v[60:63], v[136:139]
    ds_read_b128 v[96:99], v251 offset:4096
    v_mfma_f32_16x16x32_bf16 v[140:143], v[32:35], v[64:67], v[140:143]
    ds_read_b128 v[100:103], v251 offset:6144
    v_mfma_f32_16x16x32_bf16 v[144:147], v[36:39], v[52:55], v[144:147]
    ds_read_b128 v[68:71], v245 offset:0
    v_mfma_f32_16x16x32_bf16 v[148:151], v[36:39], v[56:59], v[148:151]
    ds_read_b128 v[72:75], v245 offset:2048
    v_mfma_f32_16x16x32_bf16 v[152:155], v[36:39], v[60:63], v[152:155]
    ds_read_b128 v[76:79], v245 offset:4096
    v_mfma_f32_16x16x32_bf16 v[156:159], v[36:39], v[64:67], v[156:159]
    ds_read_b128 v[80:83], v245 offset:6144
    v_mfma_f32_16x16x32_bf16 v[160:163], v[40:43], v[52:55], v[160:163]
    ds_read_b128 v[84:87], v245 offset:8192
    v_mfma_f32_16x16x32_bf16 v[164:167], v[40:43], v[56:59], v[164:167]
    v_mfma_f32_16x16x32_bf16 v[168:171], v[40:43], v[60:63], v[168:171]
    v_mfma_f32_16x16x32_bf16 v[172:175], v[40:43], v[64:67], v[172:175]
    v_mfma_f32_16x16x32_bf16 v[176:179], v[44:47], v[52:55], v[176:179]
    v_mfma_f32_16x16x32_bf16 v[180:183], v[44:47], v[56:59], v[180:183]
    v_mfma_f32_16x16x32_bf16 v[184:187], v[44:47], v[60:63], v[184:187]
    v_mfma_f32_16x16x32_bf16 v[188:191], v[44:47], v[64:67], v[188:191]
    v_mfma_f32_16x16x32_bf16 v[192:195], v[48:51], v[52:55], v[192:195]
    v_mfma_f32_16x16x32_bf16 v[196:199], v[48:51], v[56:59], v[196:199]
    v_mfma_f32_16x16x32_bf16 v[200:203], v[48:51], v[60:63], v[200:203]
    v_mfma_f32_16x16x32_bf16 v[204:207], v[48:51], v[64:67], v[204:207]
    s_waitcnt lgkmcnt(0)
    v_mfma_f32_16x16x32_bf16 v[128:131], v[68:71], v[88:91], v[128:131]
    v_mfma_f32_16x16x32_bf16 v[132:135], v[68:71], v[92:95], v[132:135]
    v_mfma_f32_16x16x32_bf16 v[136:139], v[68:71], v[96:99], v[136:139]
    s_barrier
    ds_read_b128 v[52:55], v246 offset:0
    v_mfma_f32_16x16x32_bf16 v[140:143], v[68:71], v[100:103], v[140:143]
    ds_read_b128 v[56:59], v246 offset:2048
    v_mfma_f32_16x16x32_bf16 v[144:147], v[72:75], v[88:91], v[144:147]
    ds_read_b128 v[60:63], v246 offset:4096
    v_mfma_f32_16x16x32_bf16 v[148:151], v[72:75], v[92:95], v[148:151]
    ds_read_b128 v[64:67], v246 offset:6144
    v_mfma_f32_16x16x32_bf16 v[152:155], v[72:75], v[96:99], v[152:155]
    ds_read_b128 v[32:35], v240 offset:0
    v_mfma_f32_16x16x32_bf16 v[156:159], v[72:75], v[100:103], v[156:159]
    ds_read_b128 v[36:39], v240 offset:2048
    v_mfma_f32_16x16x32_bf16 v[160:163], v[76:79], v[88:91], v[160:163]
    ds_read_b128 v[40:43], v240 offset:4096
    v_mfma_f32_16x16x32_bf16 v[164:167], v[76:79], v[92:95], v[164:167]
    ds_read_b128 v[44:47], v240 offset:6144
    v_mfma_f32_16x16x32_bf16 v[168:171], v[76:79], v[96:99], v[168:171]
    ds_read_b128 v[48:51], v240 offset:8192
    v_mfma_f32_16x16x32_bf16 v[172:175], v[76:79], v[100:103], v[172:175]
    v_mfma_f32_16x16x32_bf16 v[176:179], v[80:83], v[88:91], v[176:179]
    v_mfma_f32_16x16x32_bf16 v[180:183], v[80:83], v[92:95], v[180:183]
    v_mfma_f32_16x16x32_bf16 v[184:187], v[80:83], v[96:99], v[184:187]
    v_mfma_f32_16x16x32_bf16 v[188:191], v[80:83], v[100:103], v[188:191]
    v_mfma_f32_16x16x32_bf16 v[192:195], v[84:87], v[88:91], v[192:195]
    v_mfma_f32_16x16x32_bf16 v[196:199], v[84:87], v[92:95], v[196:199]
    v_mfma_f32_16x16x32_bf16 v[200:203], v[84:87], v[96:99], v[200:203]
    v_mfma_f32_16x16x32_bf16 v[204:207], v[84:87], v[100:103], v[204:207]
    s_waitcnt lgkmcnt(0)
    v_mfma_f32_16x16x32_bf16 v[128:131], v[32:35], v[52:55], v[128:131]
    ds_read_b128 v[88:91], v247 offset:0
    v_mfma_f32_16x16x32_bf16 v[132:135], v[32:35], v[56:59], v[132:135]
    ds_read_b128 v[92:95], v247 offset:2048
    v_mfma_f32_16x16x32_bf16 v[136:139], v[32:35], v[60:63], v[136:139]
    ds_read_b128 v[96:99], v247 offset:4096
    v_mfma_f32_16x16x32_bf16 v[140:143], v[32:35], v[64:67], v[140:143]
    ds_read_b128 v[100:103], v247 offset:6144
    v_mfma_f32_16x16x32_bf16 v[144:147], v[36:39], v[52:55], v[144:147]
    ds_read_b128 v[68:71], v241 offset:0
    v_mfma_f32_16x16x32_bf16 v[148:151], v[36:39], v[56:59], v[148:151]
    ds_read_b128 v[72:75], v241 offset:2048
    v_mfma_f32_16x16x32_bf16 v[152:155], v[36:39], v[60:63], v[152:155]
    ds_read_b128 v[76:79], v241 offset:4096
    v_mfma_f32_16x16x32_bf16 v[156:159], v[36:39], v[64:67], v[156:159]
    ds_read_b128 v[80:83], v241 offset:6144
    v_mfma_f32_16x16x32_bf16 v[160:163], v[40:43], v[52:55], v[160:163]
    ds_read_b128 v[84:87], v241 offset:8192
    v_mfma_f32_16x16x32_bf16 v[164:167], v[40:43], v[56:59], v[164:167]
    v_mfma_f32_16x16x32_bf16 v[168:171], v[40:43], v[60:63], v[168:171]
    v_mfma_f32_16x16x32_bf16 v[172:175], v[40:43], v[64:67], v[172:175]
    v_mfma_f32_16x16x32_bf16 v[176:179], v[44:47], v[52:55], v[176:179]
    v_mfma_f32_16x16x32_bf16 v[180:183], v[44:47], v[56:59], v[180:183]
    v_mfma_f32_16x16x32_bf16 v[184:187], v[44:47], v[60:63], v[184:187]
    v_mfma_f32_16x16x32_bf16 v[188:191], v[44:47], v[64:67], v[188:191]
    v_mfma_f32_16x16x32_bf16 v[192:195], v[48:51], v[52:55], v[192:195]
    v_mfma_f32_16x16x32_bf16 v[196:199], v[48:51], v[56:59], v[196:199]
    v_mfma_f32_16x16x32_bf16 v[200:203], v[48:51], v[60:63], v[200:203]
    v_mfma_f32_16x16x32_bf16 v[204:207], v[48:51], v[64:67], v[204:207]
    s_waitcnt lgkmcnt(0)
    v_mfma_f32_16x16x32_bf16 v[128:131], v[68:71], v[88:91], v[128:131]
    v_mfma_f32_16x16x32_bf16 v[132:135], v[68:71], v[92:95], v[132:135]
    v_mfma_f32_16x16x32_bf16 v[136:139], v[68:71], v[96:99], v[136:139]
    s_barrier
    ds_read_b128 v[52:55], v248 offset:0
    v_mfma_f32_16x16x32_bf16 v[140:143], v[68:71], v[100:103], v[140:143]
    ds_read_b128 v[56:59], v248 offset:2048
    v_mfma_f32_16x16x32_bf16 v[144:147], v[72:75], v[88:91], v[144:147]
    ds_read_b128 v[60:63], v248 offset:4096
    v_mfma_f32_16x16x32_bf16 v[148:151], v[72:75], v[92:95], v[148:151]
    ds_read_b128 v[64:67], v248 offset:6144
    v_mfma_f32_16x16x32_bf16 v[152:155], v[72:75], v[96:99], v[152:155]
    ds_read_b128 v[32:35], v242 offset:0
    v_mfma_f32_16x16x32_bf16 v[156:159], v[72:75], v[100:103], v[156:159]
    ds_read_b128 v[36:39], v242 offset:2048
    v_mfma_f32_16x16x32_bf16 v[160:163], v[76:79], v[88:91], v[160:163]
    ds_read_b128 v[40:43], v242 offset:4096
    v_mfma_f32_16x16x32_bf16 v[164:167], v[76:79], v[92:95], v[164:167]
    ds_read_b128 v[44:47], v242 offset:6144
    v_mfma_f32_16x16x32_bf16 v[168:171], v[76:79], v[96:99], v[168:171]
    ds_read_b128 v[48:51], v242 offset:8192
    v_mfma_f32_16x16x32_bf16 v[172:175], v[76:79], v[100:103], v[172:175]
    v_mfma_f32_16x16x32_bf16 v[176:179], v[80:83], v[88:91], v[176:179]
    v_mfma_f32_16x16x32_bf16 v[180:183], v[80:83], v[92:95], v[180:183]
    v_mfma_f32_16x16x32_bf16 v[184:187], v[80:83], v[96:99], v[184:187]
    v_mfma_f32_16x16x32_bf16 v[188:191], v[80:83], v[100:103], v[188:191]
    v_mfma_f32_16x16x32_bf16 v[192:195], v[84:87], v[88:91], v[192:195]
    v_mfma_f32_16x16x32_bf16 v[196:199], v[84:87], v[92:95], v[196:199]
    v_mfma_f32_16x16x32_bf16 v[200:203], v[84:87], v[96:99], v[200:203]
    v_mfma_f32_16x16x32_bf16 v[204:207], v[84:87], v[100:103], v[204:207]
    s_waitcnt lgkmcnt(0)
    v_mfma_f32_16x16x32_bf16 v[128:131], v[32:35], v[52:55], v[128:131]
    ds_read_b128 v[88:91], v249 offset:0
    v_mfma_f32_16x16x32_bf16 v[132:135], v[32:35], v[56:59], v[132:135]
    ds_read_b128 v[92:95], v249 offset:2048
    v_mfma_f32_16x16x32_bf16 v[136:139], v[32:35], v[60:63], v[136:139]
    ds_read_b128 v[96:99], v249 offset:4096
    v_mfma_f32_16x16x32_bf16 v[140:143], v[32:35], v[64:67], v[140:143]
    ds_read_b128 v[100:103], v249 offset:6144
    v_mfma_f32_16x16x32_bf16 v[144:147], v[36:39], v[52:55], v[144:147]
    ds_read_b128 v[68:71], v243 offset:0
    v_mfma_f32_16x16x32_bf16 v[148:151], v[36:39], v[56:59], v[148:151]
    ds_read_b128 v[72:75], v243 offset:2048
    v_mfma_f32_16x16x32_bf16 v[152:155], v[36:39], v[60:63], v[152:155]
    ds_read_b128 v[76:79], v243 offset:4096
    v_mfma_f32_16x16x32_bf16 v[156:159], v[36:39], v[64:67], v[156:159]
    ds_read_b128 v[80:83], v243 offset:6144
    v_mfma_f32_16x16x32_bf16 v[160:163], v[40:43], v[52:55], v[160:163]
    ds_read_b128 v[84:87], v243 offset:8192
    v_mfma_f32_16x16x32_bf16 v[164:167], v[40:43], v[56:59], v[164:167]
    v_mfma_f32_16x16x32_bf16 v[168:171], v[40:43], v[60:63], v[168:171]
    v_mfma_f32_16x16x32_bf16 v[172:175], v[40:43], v[64:67], v[172:175]
    v_mfma_f32_16x16x32_bf16 v[176:179], v[44:47], v[52:55], v[176:179]
    v_mfma_f32_16x16x32_bf16 v[180:183], v[44:47], v[56:59], v[180:183]
    v_mfma_f32_16x16x32_bf16 v[184:187], v[44:47], v[60:63], v[184:187]
    v_mfma_f32_16x16x32_bf16 v[188:191], v[44:47], v[64:67], v[188:191]
    v_mfma_f32_16x16x32_bf16 v[192:195], v[48:51], v[52:55], v[192:195]
    v_mfma_f32_16x16x32_bf16 v[196:199], v[48:51], v[56:59], v[196:199]
    v_mfma_f32_16x16x32_bf16 v[200:203], v[48:51], v[60:63], v[200:203]
    v_mfma_f32_16x16x32_bf16 v[204:207], v[48:51], v[64:67], v[204:207]
    s_waitcnt lgkmcnt(0)
    v_mfma_f32_16x16x32_bf16 v[128:131], v[68:71], v[88:91], v[128:131]
    v_mfma_f32_16x16x32_bf16 v[132:135], v[68:71], v[92:95], v[132:135]
    v_mfma_f32_16x16x32_bf16 v[136:139], v[68:71], v[96:99], v[136:139]
    s_barrier
    ds_read_b128 v[52:55], v250 offset:0
    v_mfma_f32_16x16x32_bf16 v[140:143], v[68:71], v[100:103], v[140:143]
    ds_read_b128 v[56:59], v250 offset:2048
    v_mfma_f32_16x16x32_bf16 v[144:147], v[72:75], v[88:91], v[144:147]
    ds_read_b128 v[60:63], v250 offset:4096
    v_mfma_f32_16x16x32_bf16 v[148:151], v[72:75], v[92:95], v[148:151]
    ds_read_b128 v[64:67], v250 offset:6144
    v_mfma_f32_16x16x32_bf16 v[152:155], v[72:75], v[96:99], v[152:155]
    ds_read_b128 v[32:35], v244 offset:0
    v_mfma_f32_16x16x32_bf16 v[156:159], v[72:75], v[100:103], v[156:159]
    ds_read_b128 v[36:39], v244 offset:2048
    v_mfma_f32_16x16x32_bf16 v[160:163], v[76:79], v[88:91], v[160:163]
    ds_read_b128 v[40:43], v244 offset:4096
    v_mfma_f32_16x16x32_bf16 v[164:167], v[76:79], v[92:95], v[164:167]
    ds_read_b128 v[44:47], v244 offset:6144
    v_mfma_f32_16x16x32_bf16 v[168:171], v[76:79], v[96:99], v[168:171]
    ds_read_b128 v[48:51], v244 offset:8192
    v_mfma_f32_16x16x32_bf16 v[172:175], v[76:79], v[100:103], v[172:175]
    v_mfma_f32_16x16x32_bf16 v[176:179], v[80:83], v[88:91], v[176:179]
    v_mfma_f32_16x16x32_bf16 v[180:183], v[80:83], v[92:95], v[180:183]
    v_mfma_f32_16x16x32_bf16 v[184:187], v[80:83], v[96:99], v[184:187]
    v_mfma_f32_16x16x32_bf16 v[188:191], v[80:83], v[100:103], v[188:191]
    v_mfma_f32_16x16x32_bf16 v[192:195], v[84:87], v[88:91], v[192:195]
    v_mfma_f32_16x16x32_bf16 v[196:199], v[84:87], v[92:95], v[196:199]
    v_mfma_f32_16x16x32_bf16 v[200:203], v[84:87], v[96:99], v[200:203]
    v_mfma_f32_16x16x32_bf16 v[204:207], v[84:87], v[100:103], v[204:207]
    s_waitcnt lgkmcnt(0)
    v_mfma_f32_16x16x32_bf16 v[128:131], v[32:35], v[52:55], v[128:131]
    ds_read_b128 v[88:91], v251 offset:0
    v_mfma_f32_16x16x32_bf16 v[132:135], v[32:35], v[56:59], v[132:135]
    ds_read_b128 v[92:95], v251 offset:2048
    v_mfma_f32_16x16x32_bf16 v[136:139], v[32:35], v[60:63], v[136:139]
    ds_read_b128 v[96:99], v251 offset:4096
    v_mfma_f32_16x16x32_bf16 v[140:143], v[32:35], v[64:67], v[140:143]
    ds_read_b128 v[100:103], v251 offset:6144
    v_mfma_f32_16x16x32_bf16 v[144:147], v[36:39], v[52:55], v[144:147]
    ds_read_b128 v[68:71], v245 offset:0
    v_mfma_f32_16x16x32_bf16 v[148:151], v[36:39], v[56:59], v[148:151]
    ds_read_b128 v[72:75], v245 offset:2048
    v_mfma_f32_16x16x32_bf16 v[152:155], v[36:39], v[60:63], v[152:155]
    ds_read_b128 v[76:79], v245 offset:4096
    v_mfma_f32_16x16x32_bf16 v[156:159], v[36:39], v[64:67], v[156:159]
    ds_read_b128 v[80:83], v245 offset:6144
    v_mfma_f32_16x16x32_bf16 v[160:163], v[40:43], v[52:55], v[160:163]
    ds_read_b128 v[84:87], v245 offset:8192
    v_mfma_f32_16x16x32_bf16 v[164:167], v[40:43], v[56:59], v[164:167]
    v_mfma_f32_16x16x32_bf16 v[168:171], v[40:43], v[60:63], v[168:171]
    v_mfma_f32_16x16x32_bf16 v[172:175], v[40:43], v[64:67], v[172:175]
    v_mfma_f32_16x16x32_bf16 v[176:179], v[44:47], v[52:55], v[176:179]
    v_mfma_f32_16x16x32_bf16 v[180:183], v[44:47], v[56:59], v[180:183]
    v_mfma_f32_16x16x32_bf16 v[184:187], v[44:47], v[60:63], v[184:187]
    v_mfma_f32_16x16x32_bf16 v[188:191], v[44:47], v[64:67], v[188:191]
    v_mfma_f32_16x16x32_bf16 v[192:195], v[48:51], v[52:55], v[192:195]
    v_mfma_f32_16x16x32_bf16 v[196:199], v[48:51], v[56:59], v[196:199]
    v_mfma_f32_16x16x32_bf16 v[200:203], v[48:51], v[60:63], v[200:203]
    v_mfma_f32_16x16x32_bf16 v[204:207], v[48:51], v[64:67], v[204:207]
    s_waitcnt lgkmcnt(0)
    v_mfma_f32_16x16x32_bf16 v[128:131], v[68:71], v[88:91], v[128:131]
    v_mfma_f32_16x16x32_bf16 v[132:135], v[68:71], v[92:95], v[132:135]
    v_mfma_f32_16x16x32_bf16 v[136:139], v[68:71], v[96:99], v[136:139]
    s_barrier
    ds_read_b128 v[52:55], v246 offset:0
    v_mfma_f32_16x16x32_bf16 v[140:143], v[68:71], v[100:103], v[140:143]
    ds_read_b128 v[56:59], v246 offset:2048
    v_mfma_f32_16x16x32_bf16 v[144:147], v[72:75], v[88:91], v[144:147]
    ds_read_b128 v[60:63], v246 offset:4096
    v_mfma_f32_16x16x32_bf16 v[148:151], v[72:75], v[92:95], v[148:151]
    ds_read_b128 v[64:67], v246 offset:6144
    v_mfma_f32_16x16x32_bf16 v[152:155], v[72:75], v[96:99], v[152:155]
    ds_read_b128 v[32:35], v240 offset:0
    v_mfma_f32_16x16x32_bf16 v[156:159], v[72:75], v[100:103], v[156:159]
    ds_read_b128 v[36:39], v240 offset:2048
    v_mfma_f32_16x16x32_bf16 v[160:163], v[76:79], v[88:91], v[160:163]
    ds_read_b128 v[40:43], v240 offset:4096
    v_mfma_f32_16x16x32_bf16 v[164:167], v[76:79], v[92:95], v[164:167]
    ds_read_b128 v[44:47], v240 offset:6144
    v_mfma_f32_16x16x32_bf16 v[168:171], v[76:79], v[96:99], v[168:171]
    ds_read_b128 v[48:51], v240 offset:8192
    v_mfma_f32_16x16x32_bf16 v[172:175], v[76:79], v[100:103], v[172:175]
    v_mfma_f32_16x16x32_bf16 v[176:179], v[80:83], v[88:91], v[176:179]
    v_mfma_f32_16x16x32_bf16 v[180:183], v[80:83], v[92:95], v[180:183]
    v_mfma_f32_16x16x32_bf16 v[184:187], v[80:83], v[96:99], v[184:187]
    v_mfma_f32_16x16x32_bf16 v[188:191], v[80:83], v[100:103], v[188:191]
    v_mfma_f32_16x16x32_bf16 v[192:195], v[84:87], v[88:91], v[192:195]
    v_mfma_f32_16x16x32_bf16 v[196:199], v[84:87], v[92:95], v[196:199]
    v_mfma_f32_16x16x32_bf16 v[200:203], v[84:87], v[96:99], v[200:203]
    v_mfma_f32_16x16x32_bf16 v[204:207], v[84:87], v[100:103], v[204:207]
    s_waitcnt lgkmcnt(0)
    v_mfma_f32_16x16x32_bf16 v[128:131], v[32:35], v[52:55], v[128:131]
    ds_read_b128 v[88:91], v247 offset:0
    v_mfma_f32_16x16x32_bf16 v[132:135], v[32:35], v[56:59], v[132:135]
    ds_read_b128 v[92:95], v247 offset:2048
    v_mfma_f32_16x16x32_bf16 v[136:139], v[32:35], v[60:63], v[136:139]
    ds_read_b128 v[96:99], v247 offset:4096
    v_mfma_f32_16x16x32_bf16 v[140:143], v[32:35], v[64:67], v[140:143]
    ds_read_b128 v[100:103], v247 offset:6144
    v_mfma_f32_16x16x32_bf16 v[144:147], v[36:39], v[52:55], v[144:147]
    ds_read_b128 v[68:71], v241 offset:0
    v_mfma_f32_16x16x32_bf16 v[148:151], v[36:39], v[56:59], v[148:151]
    ds_read_b128 v[72:75], v241 offset:2048
    v_mfma_f32_16x16x32_bf16 v[152:155], v[36:39], v[60:63], v[152:155]
    ds_read_b128 v[76:79], v241 offset:4096
    v_mfma_f32_16x16x32_bf16 v[156:159], v[36:39], v[64:67], v[156:159]
    ds_read_b128 v[80:83], v241 offset:6144
    v_mfma_f32_16x16x32_bf16 v[160:163], v[40:43], v[52:55], v[160:163]
    ds_read_b128 v[84:87], v241 offset:8192
    v_mfma_f32_16x16x32_bf16 v[164:167], v[40:43], v[56:59], v[164:167]
    v_mfma_f32_16x16x32_bf16 v[168:171], v[40:43], v[60:63], v[168:171]
    v_mfma_f32_16x16x32_bf16 v[172:175], v[40:43], v[64:67], v[172:175]
    v_mfma_f32_16x16x32_bf16 v[176:179], v[44:47], v[52:55], v[176:179]
    v_mfma_f32_16x16x32_bf16 v[180:183], v[44:47], v[56:59], v[180:183]
    v_mfma_f32_16x16x32_bf16 v[184:187], v[44:47], v[60:63], v[184:187]
    v_mfma_f32_16x16x32_bf16 v[188:191], v[44:47], v[64:67], v[188:191]
    v_mfma_f32_16x16x32_bf16 v[192:195], v[48:51], v[52:55], v[192:195]
    v_mfma_f32_16x16x32_bf16 v[196:199], v[48:51], v[56:59], v[196:199]
    v_mfma_f32_16x16x32_bf16 v[200:203], v[48:51], v[60:63], v[200:203]
    v_mfma_f32_16x16x32_bf16 v[204:207], v[48:51], v[64:67], v[204:207]
    s_waitcnt lgkmcnt(0)
    v_mfma_f32_16x16x32_bf16 v[128:131], v[68:71], v[88:91], v[128:131]
    v_mfma_f32_16x16x32_bf16 v[132:135], v[68:71], v[92:95], v[132:135]
    v_mfma_f32_16x16x32_bf16 v[136:139], v[68:71], v[96:99], v[136:139]
    v_mfma_f32_16x16x32_bf16 v[140:143], v[68:71], v[100:103], v[140:143]
    v_mfma_f32_16x16x32_bf16 v[144:147], v[72:75], v[88:91], v[144:147]
    v_mfma_f32_16x16x32_bf16 v[148:151], v[72:75], v[92:95], v[148:151]
    v_mfma_f32_16x16x32_bf16 v[152:155], v[72:75], v[96:99], v[152:155]
    v_mfma_f32_16x16x32_bf16 v[156:159], v[72:75], v[100:103], v[156:159]
    v_mfma_f32_16x16x32_bf16 v[160:163], v[76:79], v[88:91], v[160:163]
    v_mfma_f32_16x16x32_bf16 v[164:167], v[76:79], v[92:95], v[164:167]
    v_mfma_f32_16x16x32_bf16 v[168:171], v[76:79], v[96:99], v[168:171]
    v_mfma_f32_16x16x32_bf16 v[172:175], v[76:79], v[100:103], v[172:175]
    v_mfma_f32_16x16x32_bf16 v[176:179], v[80:83], v[88:91], v[176:179]
    v_mfma_f32_16x16x32_bf16 v[180:183], v[80:83], v[92:95], v[180:183]
    v_mfma_f32_16x16x32_bf16 v[184:187], v[80:83], v[96:99], v[184:187]
    v_mfma_f32_16x16x32_bf16 v[188:191], v[80:83], v[100:103], v[188:191]
    v_mfma_f32_16x16x32_bf16 v[192:195], v[84:87], v[88:91], v[192:195]
    v_mfma_f32_16x16x32_bf16 v[196:199], v[84:87], v[92:95], v[196:199]
    v_mfma_f32_16x16x32_bf16 v[200:203], v[84:87], v[96:99], v[200:203]
    v_mfma_f32_16x16x32_bf16 v[204:207], v[84:87], v[100:103], v[204:207]
    s_waitcnt vmcnt(0)
    s_barrier
    s_lshl_b32 s57, s53, 10
    v_lshlrev_b32 v17, 6, v6
    v_add_u32 v17, s57, v17
    ds_read_b64 v[32:33], v17 offset:0
    ds_read_b64 v[34:35], v17 offset:16
    ds_read_b64 v[36:37], v17 offset:32
    ds_read_b64 v[38:39], v17 offset:48
    v_mov_b32 v17, 0
    ds_read_b64 v[30:31], v17 offset:3008
    s_mul_i32 s57, s52, 320
    v_lshlrev_b32 v18, 4, v5
    v_add_u32 v18, s57, v18
    ds_read_b128 v[40:43], v18 offset:2048
    ds_read_b128 v[44:47], v18 offset:2112
    ds_read_b128 v[48:51], v18 offset:2176
    ds_read_b128 v[52:55], v18 offset:2240
    ds_read_b128 v[56:59], v18 offset:2304
    s_mul_i32 s57, s52, 11520
    v_mul_u32_u24 v19, 576, v5
    v_add_u32 v19, s57, v19
    v_lshl_add_u32 v20, v6, 3, v19
    s_mul_i32 s57, s53, 640
    s_mul_i32 s58, s52, 320
    s_add_u32 s57, s57, s58
    s_add_u32 s57, s57, 157184
    v_lshlrev_b32 v21, 4, v5
    v_add_u32 v21, s57, v21
    v_lshlrev_b32 v22, 4, v0
    v_add_u32 v22, 159744, v22
    v_cmp_eq_u32 vcc, 15, v6
    s_nop 1
    v_cndmask_b32 v22, v22, v21, vcc
    v_sub_u32 v23, 15, v6
    v_lshl_add_u32 v23, v23, 3, v19
    ds_read_b64 v[60:61], v19 offset:3344
    ds_read_b64 v[62:63], v23 offset:3072
    ds_read_b64 v[64:65], v19 offset:3632
    ds_read_b64 v[66:67], v23 offset:3360
    ds_read_b64 v[68:69], v19 offset:5648
    ds_read_b64 v[70:71], v23 offset:5376
    ds_read_b64 v[72:73], v19 offset:5936
    ds_read_b64 v[74:75], v23 offset:5664
    s_waitcnt lgkmcnt(8)
    ds_read_b64 v[76:77], v19 offset:7952
    ds_read_b64 v[78:79], v23 offset:7680
    ds_read_b64 v[80:81], v19 offset:8240
    ds_read_b64 v[82:83], v23 offset:7968
    ds_read_b64 v[84:85], v19 offset:10256
    ds_read_b64 v[86:87], v23 offset:9984
    ds_read_b64 v[88:89], v19 offset:10544
    ds_read_b64 v[90:91], v23 offset:10272
    ds_read_b64 v[92:93], v19 offset:12560
    ds_read_b64 v[94:95], v23 offset:12288
    ds_read_b64 v[96:97], v19 offset:12848
    ds_read_b64 v[98:99], v23 offset:12576
    v_pk_fma_f32 v[128:129], v[40:41], v[32:33], v[128:129] op_sel:[0,0,0] op_sel_hi:[1,0,1] neg_lo:[1,0,0] neg_hi:[1,0,0]
    v_pk_fma_f32 v[130:131], v[42:43], v[32:33], v[130:131] op_sel:[0,0,0] op_sel_hi:[1,0,1] neg_lo:[1,0,0] neg_hi:[1,0,0]
    v_pk_mul_f32 v[128:129], v[128:129], v[32:33] op_sel:[0,1] op_sel_hi:[1,1]
    v_pk_mul_f32 v[130:131], v[130:131], v[32:33] op_sel:[0,1] op_sel_hi:[1,1]
    v_pk_fma_f32 v[132:133], v[40:41], v[34:35], v[132:133] op_sel:[0,0,0] op_sel_hi:[1,0,1] neg_lo:[1,0,0] neg_hi:[1,0,0]
    v_pk_fma_f32 v[134:135], v[42:43], v[34:35], v[134:135] op_sel:[0,0,0] op_sel_hi:[1,0,1] neg_lo:[1,0,0] neg_hi:[1,0,0]
    v_pk_mul_f32 v[132:133], v[132:133], v[34:35] op_sel:[0,1] op_sel_hi:[1,1]
    v_pk_mul_f32 v[134:135], v[134:135], v[34:35] op_sel:[0,1] op_sel_hi:[1,1]
    v_pk_fma_f32 v[136:137], v[40:41], v[36:37], v[136:137] op_sel:[0,0,0] op_sel_hi:[1,0,1] neg_lo:[1,0,0] neg_hi:[1,0,0]
    v_pk_fma_f32 v[138:139], v[42:43], v[36:37], v[138:139] op_sel:[0,0,0] op_sel_hi:[1,0,1] neg_lo:[1,0,0] neg_hi:[1,0,0]
    v_pk_mul_f32 v[136:137], v[136:137], v[36:37] op_sel:[0,1] op_sel_hi:[1,1]
    v_pk_mul_f32 v[138:139], v[138:139], v[36:37] op_sel:[0,1] op_sel_hi:[1,1]
    v_pk_fma_f32 v[140:141], v[40:41], v[38:39], v[140:141] op_sel:[0,0,0] op_sel_hi:[1,0,1] neg_lo:[1,0,0] neg_hi:[1,0,0]
    v_pk_fma_f32 v[142:143], v[42:43], v[38:39], v[142:143] op_sel:[0,0,0] op_sel_hi:[1,0,1] neg_lo:[1,0,0] neg_hi:[1,0,0]
    v_pk_mul_f32 v[140:141], v[140:141], v[38:39] op_sel:[0,1] op_sel_hi:[1,1]
    v_pk_mul_f32 v[142:143], v[142:143], v[38:39] op_sel:[0,1] op_sel_hi:[1,1]
    v_pk_fma_f32 v[144:145], v[44:45], v[32:33], v[144:145] op_sel:[0,0,0] op_sel_hi:[1,0,1] neg_lo:[1,0,0] neg_hi:[1,0,0]
    v_pk_fma_f32 v[146:147], v[46:47], v[32:33], v[146:147] op_sel:[0,0,0] op_sel_hi:[1,0,1] neg_lo:[1,0,0] neg_hi:[1,0,0]
    v_pk_mul_f32 v[144:145], v[144:145], v[32:33] op_sel:[0,1] op_sel_hi:[1,1]
    v_pk_mul_f32 v[146:147], v[146:147], v[32:33] op_sel:[0,1] op_sel_hi:[1,1]
    v_pk_fma_f32 v[148:149], v[44:45], v[34:35], v[148:149] op_sel:[0,0,0] op_sel_hi:[1,0,1] neg_lo:[1,0,0] neg_hi:[1,0,0]
    v_pk_fma_f32 v[150:151], v[46:47], v[34:35], v[150:151] op_sel:[0,0,0] op_sel_hi:[1,0,1] neg_lo:[1,0,0] neg_hi:[1,0,0]
    v_pk_mul_f32 v[148:149], v[148:149], v[34:35] op_sel:[0,1] op_sel_hi:[1,1]
    v_pk_mul_f32 v[150:151], v[150:151], v[34:35] op_sel:[0,1] op_sel_hi:[1,1]
    v_pk_fma_f32 v[152:153], v[44:45], v[36:37], v[152:153] op_sel:[0,0,0] op_sel_hi:[1,0,1] neg_lo:[1,0,0] neg_hi:[1,0,0]
    v_pk_fma_f32 v[154:155], v[46:47], v[36:37], v[154:155] op_sel:[0,0,0] op_sel_hi:[1,0,1] neg_lo:[1,0,0] neg_hi:[1,0,0]
    v_pk_mul_f32 v[152:153], v[152:153], v[36:37] op_sel:[0,1] op_sel_hi:[1,1]
    v_pk_mul_f32 v[154:155], v[154:155], v[36:37] op_sel:[0,1] op_sel_hi:[1,1]
    v_pk_fma_f32 v[156:157], v[44:45], v[38:39], v[156:157] op_sel:[0,0,0] op_sel_hi:[1,0,1] neg_lo:[1,0,0] neg_hi:[1,0,0]
    v_pk_fma_f32 v[158:159], v[46:47], v[38:39], v[158:159] op_sel:[0,0,0] op_sel_hi:[1,0,1] neg_lo:[1,0,0] neg_hi:[1,0,0]
    v_pk_mul_f32 v[156:157], v[156:157], v[38:39] op_sel:[0,1] op_sel_hi:[1,1]
    v_pk_mul_f32 v[158:159], v[158:159], v[38:39] op_sel:[0,1] op_sel_hi:[1,1]
    v_pk_fma_f32 v[160:161], v[48:49], v[32:33], v[160:161] op_sel:[0,0,0] op_sel_hi:[1,0,1] neg_lo:[1,0,0] neg_hi:[1,0,0]
    v_pk_fma_f32 v[162:163], v[50:51], v[32:33], v[162:163] op_sel:[0,0,0] op_sel_hi:[1,0,1] neg_lo:[1,0,0] neg_hi:[1,0,0]
    v_pk_mul_f32 v[160:161], v[160:161], v[32:33] op_sel:[0,1] op_sel_hi:[1,1]
    v_pk_mul_f32 v[162:163], v[162:163], v[32:33] op_sel:[0,1] op_sel_hi:[1,1]
    v_pk_fma_f32 v[164:165], v[48:49], v[34:35], v[164:165] op_sel:[0,0,0] op_sel_hi:[1,0,1] neg_lo:[1,0,0] neg_hi:[1,0,0]
    v_pk_fma_f32 v[166:167], v[50:51], v[34:35], v[166:167] op_sel:[0,0,0] op_sel_hi:[1,0,1] neg_lo:[1,0,0] neg_hi:[1,0,0]
    v_pk_mul_f32 v[164:165], v[164:165], v[34:35] op_sel:[0,1] op_sel_hi:[1,1]
    v_pk_mul_f32 v[166:167], v[166:167], v[34:35] op_sel:[0,1] op_sel_hi:[1,1]
    v_pk_fma_f32 v[168:169], v[48:49], v[36:37], v[168:169] op_sel:[0,0,0] op_sel_hi:[1,0,1] neg_lo:[1,0,0] neg_hi:[1,0,0]
    v_pk_fma_f32 v[170:171], v[50:51], v[36:37], v[170:171] op_sel:[0,0,0] op_sel_hi:[1,0,1] neg_lo:[1,0,0] neg_hi:[1,0,0]
    v_pk_mul_f32 v[168:169], v[168:169], v[36:37] op_sel:[0,1] op_sel_hi:[1,1]
    v_pk_mul_f32 v[170:171], v[170:171], v[36:37] op_sel:[0,1] op_sel_hi:[1,1]
    v_pk_fma_f32 v[172:173], v[48:49], v[38:39], v[172:173] op_sel:[0,0,0] op_sel_hi:[1,0,1] neg_lo:[1,0,0] neg_hi:[1,0,0]
    v_pk_fma_f32 v[174:175], v[50:51], v[38:39], v[174:175] op_sel:[0,0,0] op_sel_hi:[1,0,1] neg_lo:[1,0,0] neg_hi:[1,0,0]
    v_pk_mul_f32 v[172:173], v[172:173], v[38:39] op_sel:[0,1] op_sel_hi:[1,1]
    v_pk_mul_f32 v[174:175], v[174:175], v[38:39] op_sel:[0,1] op_sel_hi:[1,1]
    v_pk_fma_f32 v[176:177], v[52:53], v[32:33], v[176:177] op_sel:[0,0,0] op_sel_hi:[1,0,1] neg_lo:[1,0,0] neg_hi:[1,0,0]
    v_pk_fma_f32 v[178:179], v[54:55], v[32:33], v[178:179] op_sel:[0,0,0] op_sel_hi:[1,0,1] neg_lo:[1,0,0] neg_hi:[1,0,0]
    v_pk_mul_f32 v[176:177], v[176:177], v[32:33] op_sel:[0,1] op_sel_hi:[1,1]
    v_pk_mul_f32 v[178:179], v[178:179], v[32:33] op_sel:[0,1] op_sel_hi:[1,1]
    v_pk_fma_f32 v[180:181], v[52:53], v[34:35], v[180:181] op_sel:[0,0,0] op_sel_hi:[1,0,1] neg_lo:[1,0,0] neg_hi:[1,0,0]
    v_pk_fma_f32 v[182:183], v[54:55], v[34:35], v[182:183] op_sel:[0,0,0] op_sel_hi:[1,0,1] neg_lo:[1,0,0] neg_hi:[1,0,0]
    v_pk_mul_f32 v[180:181], v[180:181], v[34:35] op_sel:[0,1] op_sel_hi:[1,1]
    v_pk_mul_f32 v[182:183], v[182:183], v[34:35] op_sel:[0,1] op_sel_hi:[1,1]
    v_pk_fma_f32 v[184:185], v[52:53], v[36:37], v[184:185] op_sel:[0,0,0] op_sel_hi:[1,0,1] neg_lo:[1,0,0] neg_hi:[1,0,0]
    v_pk_fma_f32 v[186:187], v[54:55], v[36:37], v[186:187] op_sel:[0,0,0] op_sel_hi:[1,0,1] neg_lo:[1,0,0] neg_hi:[1,0,0]
    v_pk_mul_f32 v[184:185], v[184:185], v[36:37] op_sel:[0,1] op_sel_hi:[1,1]
    v_pk_mul_f32 v[186:187], v[186:187], v[36:37] op_sel:[0,1] op_sel_hi:[1,1]
    v_pk_fma_f32 v[188:189], v[52:53], v[38:39], v[188:189] op_sel:[0,0,0] op_sel_hi:[1,0,1] neg_lo:[1,0,0] neg_hi:[1,0,0]
    v_pk_fma_f32 v[190:191], v[54:55], v[38:39], v[190:191] op_sel:[0,0,0] op_sel_hi:[1,0,1] neg_lo:[1,0,0] neg_hi:[1,0,0]
    v_pk_mul_f32 v[188:189], v[188:189], v[38:39] op_sel:[0,1] op_sel_hi:[1,1]
    v_pk_mul_f32 v[190:191], v[190:191], v[38:39] op_sel:[0,1] op_sel_hi:[1,1]
    v_pk_fma_f32 v[192:193], v[56:57], v[32:33], v[192:193] op_sel:[0,0,0] op_sel_hi:[1,0,1] neg_lo:[1,0,0] neg_hi:[1,0,0]
    v_pk_fma_f32 v[194:195], v[58:59], v[32:33], v[194:195] op_sel:[0,0,0] op_sel_hi:[1,0,1] neg_lo:[1,0,0] neg_hi:[1,0,0]
    v_pk_mul_f32 v[192:193], v[192:193], v[32:33] op_sel:[0,1] op_sel_hi:[1,1]
    v_pk_mul_f32 v[194:195], v[194:195], v[32:33] op_sel:[0,1] op_sel_hi:[1,1]
    v_pk_fma_f32 v[196:197], v[56:57], v[34:35], v[196:197] op_sel:[0,0,0] op_sel_hi:[1,0,1] neg_lo:[1,0,0] neg_hi:[1,0,0]
    v_pk_fma_f32 v[198:199], v[58:59], v[34:35], v[198:199] op_sel:[0,0,0] op_sel_hi:[1,0,1] neg_lo:[1,0,0] neg_hi:[1,0,0]
    v_pk_mul_f32 v[196:197], v[196:197], v[34:35] op_sel:[0,1] op_sel_hi:[1,1]
    v_pk_mul_f32 v[198:199], v[198:199], v[34:35] op_sel:[0,1] op_sel_hi:[1,1]
    v_pk_fma_f32 v[200:201], v[56:57], v[36:37], v[200:201] op_sel:[0,0,0] op_sel_hi:[1,0,1] neg_lo:[1,0,0] neg_hi:[1,0,0]
    v_pk_fma_f32 v[202:203], v[58:59], v[36:37], v[202:203] op_sel:[0,0,0] op_sel_hi:[1,0,1] neg_lo:[1,0,0] neg_hi:[1,0,0]
    v_pk_mul_f32 v[200:201], v[200:201], v[36:37] op_sel:[0,1] op_sel_hi:[1,1]
    v_pk_mul_f32 v[202:203], v[202:203], v[36:37] op_sel:[0,1] op_sel_hi:[1,1]
    v_pk_fma_f32 v[204:205], v[56:57], v[38:39], v[204:205] op_sel:[0,0,0] op_sel_hi:[1,0,1] neg_lo:[1,0,0] neg_hi:[1,0,0]
    v_pk_fma_f32 v[206:207], v[58:59], v[38:39], v[206:207] op_sel:[0,0,0] op_sel_hi:[1,0,1] neg_lo:[1,0,0] neg_hi:[1,0,0]
    v_pk_mul_f32 v[204:205], v[204:205], v[38:39] op_sel:[0,1] op_sel_hi:[1,1]
    v_pk_mul_f32 v[206:207], v[206:207], v[38:39] op_sel:[0,1] op_sel_hi:[1,1]
    s_waitcnt lgkmcnt(0)
    v_pk_fma_f32 v[208:209], v[60:61], v[128:129], v[132:133] op_sel:[0,0,0] op_sel_hi:[0,1,1]
    v_pk_fma_f32 v[208:209], v[60:61], v[128:129], v[208:209] op_sel:[1,1,0] op_sel_hi:[1,0,1] neg_lo:[1,0,0]
    v_pk_fma_f32 v[210:211], v[64:65], v[130:131], v[134:135] op_sel:[0,0,0] op_sel_hi:[0,1,1]
    v_pk_fma_f32 v[210:211], v[64:65], v[130:131], v[210:211] op_sel:[1,1,0] op_sel_hi:[1,0,1] neg_lo:[1,0,0]
    v_pk_fma_f32 v[212:213], v[68:69], v[144:145], v[148:149] op_sel:[0,0,0] op_sel_hi:[0,1,1]
    v_pk_fma_f32 v[212:213], v[68:69], v[144:145], v[212:213] op_sel:[1,1,0] op_sel_hi:[1,0,1] neg_lo:[1,0,0]
    v_pk_fma_f32 v[214:215], v[72:73], v[146:147], v[150:151] op_sel:[0,0,0] op_sel_hi:[0,1,1]
    v_pk_fma_f32 v[214:215], v[72:73], v[146:147], v[214:215] op_sel:[1,1,0] op_sel_hi:[1,0,1] neg_lo:[1,0,0]
    v_pk_fma_f32 v[216:217], v[76:77], v[160:161], v[164:165] op_sel:[0,0,0] op_sel_hi:[0,1,1]
    v_pk_fma_f32 v[216:217], v[76:77], v[160:161], v[216:217] op_sel:[1,1,0] op_sel_hi:[1,0,1] neg_lo:[1,0,0]
    v_pk_fma_f32 v[218:219], v[80:81], v[162:163], v[166:167] op_sel:[0,0,0] op_sel_hi:[0,1,1]
    v_pk_fma_f32 v[218:219], v[80:81], v[162:163], v[218:219] op_sel:[1,1,0] op_sel_hi:[1,0,1] neg_lo:[1,0,0]
    v_pk_fma_f32 v[220:221], v[84:85], v[176:177], v[180:181] op_sel:[0,0,0] op_sel_hi:[0,1,1]
    v_pk_fma_f32 v[220:221], v[84:85], v[176:177], v[220:221] op_sel:[1,1,0] op_sel_hi:[1,0,1] neg_lo:[1,0,0]
    v_pk_fma_f32 v[222:223], v[88:89], v[178:179], v[182:183] op_sel:[0,0,0] op_sel_hi:[0,1,1]
    v_pk_fma_f32 v[222:223], v[88:89], v[178:179], v[222:223] op_sel:[1,1,0] op_sel_hi:[1,0,1] neg_lo:[1,0,0]
    v_pk_fma_f32 v[224:225], v[92:93], v[192:193], v[196:197] op_sel:[0,0,0] op_sel_hi:[0,1,1]
    v_pk_fma_f32 v[224:225], v[92:93], v[192:193], v[224:225] op_sel:[1,1,0] op_sel_hi:[1,0,1] neg_lo:[1,0,0]
    v_pk_fma_f32 v[226:227], v[96:97], v[194:195], v[198:199] op_sel:[0,0,0] op_sel_hi:[0,1,1]
    v_pk_fma_f32 v[226:227], v[96:97], v[194:195], v[226:227] op_sel:[1,1,0] op_sel_hi:[1,0,1] neg_lo:[1,0,0]
    v_pk_fma_f32 v[100:101], v[60:61], v[208:209], v[136:137] op_sel:[0,0,0] op_sel_hi:[0,1,1]
    v_pk_fma_f32 v[100:101], v[60:61], v[208:209], v[100:101] op_sel:[1,1,0] op_sel_hi:[1,0,1] neg_lo:[1,0,0]
    v_pk_fma_f32 v[102:103], v[64:65], v[210:211], v[138:139] op_sel:[0,0,0] op_sel_hi:[0,1,1]
    v_pk_fma_f32 v[102:103], v[64:65], v[210:211], v[102:103] op_sel:[1,1,0] op_sel_hi:[1,0,1] neg_lo:[1,0,0]
    v_pk_fma_f32 v[104:105], v[68:69], v[212:213], v[152:153] op_sel:[0,0,0] op_sel_hi:[0,1,1]
    v_pk_fma_f32 v[104:105], v[68:69], v[212:213], v[104:105] op_sel:[1,1,0] op_sel_hi:[1,0,1] neg_lo:[1,0,0]
    v_pk_fma_f32 v[106:107], v[72:73], v[214:215], v[154:155] op_sel:[0,0,0] op_sel_hi:[0,1,1]
    v_pk_fma_f32 v[106:107], v[72:73], v[214:215], v[106:107] op_sel:[1,1,0] op_sel_hi:[1,0,1] neg_lo:[1,0,0]
    v_pk_fma_f32 v[108:109], v[76:77], v[216:217], v[168:169] op_sel:[0,0,0] op_sel_hi:[0,1,1]
    v_pk_fma_f32 v[108:109], v[76:77], v[216:217], v[108:109] op_sel:[1,1,0] op_sel_hi:[1,0,1] neg_lo:[1,0,0]
    v_pk_fma_f32 v[110:111], v[80:81], v[218:219], v[170:171] op_sel:[0,0,0] op_sel_hi:[0,1,1]
    v_pk_fma_f32 v[110:111], v[80:81], v[218:219], v[110:111] op_sel:[1,1,0] op_sel_hi:[1,0,1] neg_lo:[1,0,0]
    v_pk_fma_f32 v[112:113], v[84:85], v[220:221], v[184:185] op_sel:[0,0,0] op_sel_hi:[0,1,1]
    v_pk_fma_f32 v[112:113], v[84:85], v[220:221], v[112:113] op_sel:[1,1,0] op_sel_hi:[1,0,1] neg_lo:[1,0,0]
    v_pk_fma_f32 v[114:115], v[88:89], v[222:223], v[186:187] op_sel:[0,0,0] op_sel_hi:[0,1,1]
    v_pk_fma_f32 v[114:115], v[88:89], v[222:223], v[114:115] op_sel:[1,1,0] op_sel_hi:[1,0,1] neg_lo:[1,0,0]
    v_pk_fma_f32 v[116:117], v[92:93], v[224:225], v[200:201] op_sel:[0,0,0] op_sel_hi:[0,1,1]
    v_pk_fma_f32 v[116:117], v[92:93], v[224:225], v[116:117] op_sel:[1,1,0] op_sel_hi:[1,0,1] neg_lo:[1,0,0]
    v_pk_fma_f32 v[118:119], v[96:97], v[226:227], v[202:203] op_sel:[0,0,0] op_sel_hi:[0,1,1]
    v_pk_fma_f32 v[118:119], v[96:97], v[226:227], v[118:119] op_sel:[1,1,0] op_sel_hi:[1,0,1] neg_lo:[1,0,0]
    v_pk_fma_f32 v[208:209], v[60:61], v[100:101], v[140:141] op_sel:[0,0,0] op_sel_hi:[0,1,1]
    v_pk_fma_f32 v[208:209], v[60:61], v[100:101], v[208:209] op_sel:[1,1,0] op_sel_hi:[1,0,1] neg_lo:[1,0,0]
    v_pk_fma_f32 v[210:211], v[64:65], v[102:103], v[142:143] op_sel:[0,0,0] op_sel_hi:[0,1,1]
    v_pk_fma_f32 v[210:211], v[64:65], v[102:103], v[210:211] op_sel:[1,1,0] op_sel_hi:[1,0,1] neg_lo:[1,0,0]
    v_pk_fma_f32 v[212:213], v[68:69], v[104:105], v[156:157] op_sel:[0,0,0] op_sel_hi:[0,1,1]
    v_pk_fma_f32 v[212:213], v[68:69], v[104:105], v[212:213] op_sel:[1,1,0] op_sel_hi:[1,0,1] neg_lo:[1,0,0]
    v_pk_fma_f32 v[214:215], v[72:73], v[106:107], v[158:159] op_sel:[0,0,0] op_sel_hi:[0,1,1]
    v_pk_fma_f32 v[214:215], v[72:73], v[106:107], v[214:215] op_sel:[1,1,0] op_sel_hi:[1,0,1] neg_lo:[1,0,0]
    v_pk_fma_f32 v[216:217], v[76:77], v[108:109], v[172:173] op_sel:[0,0,0] op_sel_hi:[0,1,1]
    v_pk_fma_f32 v[216:217], v[76:77], v[108:109], v[216:217] op_sel:[1,1,0] op_sel_hi:[1,0,1] neg_lo:[1,0,0]
    v_pk_fma_f32 v[218:219], v[80:81], v[110:111], v[174:175] op_sel:[0,0,0] op_sel_hi:[0,1,1]
    v_pk_fma_f32 v[218:219], v[80:81], v[110:111], v[218:219] op_sel:[1,1,0] op_sel_hi:[1,0,1] neg_lo:[1,0,0]
    v_pk_fma_f32 v[220:221], v[84:85], v[112:113], v[188:189] op_sel:[0,0,0] op_sel_hi:[0,1,1]
    v_pk_fma_f32 v[220:221], v[84:85], v[112:113], v[220:221] op_sel:[1,1,0] op_sel_hi:[1,0,1] neg_lo:[1,0,0]
    v_pk_fma_f32 v[222:223], v[88:89], v[114:115], v[190:191] op_sel:[0,0,0] op_sel_hi:[0,1,1]
    v_pk_fma_f32 v[222:223], v[88:89], v[114:115], v[222:223] op_sel:[1,1,0] op_sel_hi:[1,0,1] neg_lo:[1,0,0]
    v_pk_fma_f32 v[224:225], v[92:93], v[116:117], v[204:205] op_sel:[0,0,0] op_sel_hi:[0,1,1]
    v_pk_fma_f32 v[224:225], v[92:93], v[116:117], v[224:225] op_sel:[1,1,0] op_sel_hi:[1,0,1] neg_lo:[1,0,0]
    v_pk_fma_f32 v[226:227], v[96:97], v[118:119], v[206:207] op_sel:[0,0,0] op_sel_hi:[0,1,1]
    v_pk_fma_f32 v[226:227], v[96:97], v[118:119], v[226:227] op_sel:[1,1,0] op_sel_hi:[1,0,1] neg_lo:[1,0,0]
    v_pk_mul_f32 v[100:101], v[62:63], v[208:209] op_sel:[0,0] op_sel_hi:[0,1]
    v_pk_fma_f32 v[100:101], v[62:63], v[208:209], v[100:101] op_sel:[1,1,0] op_sel_hi:[1,0,1] neg_lo:[1,0,0]
    v_pk_mul_f32 v[102:103], v[66:67], v[210:211] op_sel:[0,0] op_sel_hi:[0,1]
    v_pk_fma_f32 v[102:103], v[66:67], v[210:211], v[102:103] op_sel:[1,1,0] op_sel_hi:[1,0,1] neg_lo:[1,0,0]
    v_pk_mul_f32 v[104:105], v[70:71], v[212:213] op_sel:[0,0] op_sel_hi:[0,1]
    v_pk_fma_f32 v[104:105], v[70:71], v[212:213], v[104:105] op_sel:[1,1,0] op_sel_hi:[1,0,1] neg_lo:[1,0,0]
    v_pk_mul_f32 v[106:107], v[74:75], v[214:215] op_sel:[0,0] op_sel_hi:[0,1]
    v_pk_fma_f32 v[106:107], v[74:75], v[214:215], v[106:107] op_sel:[1,1,0] op_sel_hi:[1,0,1] neg_lo:[1,0,0]
    v_pk_mul_f32 v[108:109], v[78:79], v[216:217] op_sel:[0,0] op_sel_hi:[0,1]
    v_pk_fma_f32 v[108:109], v[78:79], v[216:217], v[108:109] op_sel:[1,1,0] op_sel_hi:[1,0,1] neg_lo:[1,0,0]
    v_pk_mul_f32 v[110:111], v[82:83], v[218:219] op_sel:[0,0] op_sel_hi:[0,1]
    v_pk_fma_f32 v[110:111], v[82:83], v[218:219], v[110:111] op_sel:[1,1,0] op_sel_hi:[1,0,1] neg_lo:[1,0,0]
    v_pk_mul_f32 v[112:113], v[86:87], v[220:221] op_sel:[0,0] op_sel_hi:[0,1]
    v_pk_fma_f32 v[112:113], v[86:87], v[220:221], v[112:113] op_sel:[1,1,0] op_sel_hi:[1,0,1] neg_lo:[1,0,0]
    v_pk_mul_f32 v[114:115], v[90:91], v[222:223] op_sel:[0,0] op_sel_hi:[0,1]
    v_pk_fma_f32 v[114:115], v[90:91], v[222:223], v[114:115] op_sel:[1,1,0] op_sel_hi:[1,0,1] neg_lo:[1,0,0]
    v_pk_mul_f32 v[116:117], v[94:95], v[224:225] op_sel:[0,0] op_sel_hi:[0,1]
    v_pk_fma_f32 v[116:117], v[94:95], v[224:225], v[116:117] op_sel:[1,1,0] op_sel_hi:[1,0,1] neg_lo:[1,0,0]
    v_pk_mul_f32 v[118:119], v[98:99], v[226:227] op_sel:[0,0] op_sel_hi:[0,1]
    v_pk_fma_f32 v[118:119], v[98:99], v[226:227], v[118:119] op_sel:[1,1,0] op_sel_hi:[1,0,1] neg_lo:[1,0,0]
    v_add_f32_dpp v100, v100, v100 row_ror:8 row_mask:0xf bank_mask:0xf
    v_add_f32_dpp v101, v101, v101 row_ror:8 row_mask:0xf bank_mask:0xf
    v_add_f32_dpp v102, v102, v102 row_ror:8 row_mask:0xf bank_mask:0xf
    v_add_f32_dpp v103, v103, v103 row_ror:8 row_mask:0xf bank_mask:0xf
    v_add_f32_dpp v104, v104, v104 row_ror:8 row_mask:0xf bank_mask:0xf
    v_add_f32_dpp v105, v105, v105 row_ror:8 row_mask:0xf bank_mask:0xf
    v_add_f32_dpp v106, v106, v106 row_ror:8 row_mask:0xf bank_mask:0xf
    v_add_f32_dpp v107, v107, v107 row_ror:8 row_mask:0xf bank_mask:0xf
    v_add_f32_dpp v108, v108, v108 row_ror:8 row_mask:0xf bank_mask:0xf
    v_add_f32_dpp v109, v109, v109 row_ror:8 row_mask:0xf bank_mask:0xf
    v_add_f32_dpp v110, v110, v110 row_ror:8 row_mask:0xf bank_mask:0xf
    v_add_f32_dpp v111, v111, v111 row_ror:8 row_mask:0xf bank_mask:0xf
    v_add_f32_dpp v112, v112, v112 row_ror:8 row_mask:0xf bank_mask:0xf
    v_add_f32_dpp v113, v113, v113 row_ror:8 row_mask:0xf bank_mask:0xf
    v_add_f32_dpp v114, v114, v114 row_ror:8 row_mask:0xf bank_mask:0xf
    v_add_f32_dpp v115, v115, v115 row_ror:8 row_mask:0xf bank_mask:0xf
    v_add_f32_dpp v116, v116, v116 row_ror:8 row_mask:0xf bank_mask:0xf
    v_add_f32_dpp v117, v117, v117 row_ror:8 row_mask:0xf bank_mask:0xf
    v_add_f32_dpp v118, v118, v118 row_ror:8 row_mask:0xf bank_mask:0xf
    v_add_f32_dpp v119, v119, v119 row_ror:8 row_mask:0xf bank_mask:0xf
    v_add_f32_dpp v100, v100, v100 row_ror:4 row_mask:0xf bank_mask:0xf
    v_add_f32_dpp v101, v101, v101 row_ror:4 row_mask:0xf bank_mask:0xf
    v_add_f32_dpp v102, v102, v102 row_ror:4 row_mask:0xf bank_mask:0xf
    v_add_f32_dpp v103, v103, v103 row_ror:4 row_mask:0xf bank_mask:0xf
    v_add_f32_dpp v104, v104, v104 row_ror:4 row_mask:0xf bank_mask:0xf
    v_add_f32_dpp v105, v105, v105 row_ror:4 row_mask:0xf bank_mask:0xf
    v_add_f32_dpp v106, v106, v106 row_ror:4 row_mask:0xf bank_mask:0xf
    v_add_f32_dpp v107, v107, v107 row_ror:4 row_mask:0xf bank_mask:0xf
    v_add_f32_dpp v108, v108, v108 row_ror:4 row_mask:0xf bank_mask:0xf
    v_add_f32_dpp v109, v109, v109 row_ror:4 row_mask:0xf bank_mask:0xf
    v_add_f32_dpp v110, v110, v110 row_ror:4 row_mask:0xf bank_mask:0xf
    v_add_f32_dpp v111, v111, v111 row_ror:4 row_mask:0xf bank_mask:0xf
    v_add_f32_dpp v112, v112, v112 row_ror:4 row_mask:0xf bank_mask:0xf
    v_add_f32_dpp v113, v113, v113 row_ror:4 row_mask:0xf bank_mask:0xf
    v_add_f32_dpp v114, v114, v114 row_ror:4 row_mask:0xf bank_mask:0xf
    v_add_f32_dpp v115, v115, v115 row_ror:4 row_mask:0xf bank_mask:0xf
    v_add_f32_dpp v116, v116, v116 row_ror:4 row_mask:0xf bank_mask:0xf
    v_add_f32_dpp v117, v117, v117 row_ror:4 row_mask:0xf bank_mask:0xf
    v_add_f32_dpp v118, v118, v118 row_ror:4 row_mask:0xf bank_mask:0xf
    v_add_f32_dpp v119, v119, v119 row_ror:4 row_mask:0xf bank_mask:0xf
    v_add_f32_dpp v100, v100, v100 row_ror:2 row_mask:0xf bank_mask:0xf
    v_add_f32_dpp v101, v101, v101 row_ror:2 row_mask:0xf bank_mask:0xf
    v_add_f32_dpp v102, v102, v102 row_ror:2 row_mask:0xf bank_mask:0xf
    v_add_f32_dpp v103, v103, v103 row_ror:2 row_mask:0xf bank_mask:0xf
    v_add_f32_dpp v104, v104, v104 row_ror:2 row_mask:0xf bank_mask:0xf
    v_add_f32_dpp v105, v105, v105 row_ror:2 row_mask:0xf bank_mask:0xf
    v_add_f32_dpp v106, v106, v106 row_ror:2 row_mask:0xf bank_mask:0xf
    v_add_f32_dpp v107, v107, v107 row_ror:2 row_mask:0xf bank_mask:0xf
    v_add_f32_dpp v108, v108, v108 row_ror:2 row_mask:0xf bank_mask:0xf
    v_add_f32_dpp v109, v109, v109 row_ror:2 row_mask:0xf bank_mask:0xf
    v_add_f32_dpp v110, v110, v110 row_ror:2 row_mask:0xf bank_mask:0xf
    v_add_f32_dpp v111, v111, v111 row_ror:2 row_mask:0xf bank_mask:0xf
    v_add_f32_dpp v112, v112, v112 row_ror:2 row_mask:0xf bank_mask:0xf
    v_add_f32_dpp v113, v113, v113 row_ror:2 row_mask:0xf bank_mask:0xf
    v_add_f32_dpp v114, v114, v114 row_ror:2 row_mask:0xf bank_mask:0xf
    v_add_f32_dpp v115, v115, v115 row_ror:2 row_mask:0xf bank_mask:0xf
    v_add_f32_dpp v116, v116, v116 row_ror:2 row_mask:0xf bank_mask:0xf
    v_add_f32_dpp v117, v117, v117 row_ror:2 row_mask:0xf bank_mask:0xf
    v_add_f32_dpp v118, v118, v118 row_ror:2 row_mask:0xf bank_mask:0xf
    v_add_f32_dpp v119, v119, v119 row_ror:2 row_mask:0xf bank_mask:0xf
    v_add_f32_dpp v100, v100, v100 row_ror:1 row_mask:0xf bank_mask:0xf
    v_add_f32_dpp v101, v101, v101 row_ror:1 row_mask:0xf bank_mask:0xf
    v_add_f32_dpp v102, v102, v102 row_ror:1 row_mask:0xf bank_mask:0xf
    v_add_f32_dpp v103, v103, v103 row_ror:1 row_mask:0xf bank_mask:0xf
    v_add_f32_dpp v104, v104, v104 row_ror:1 row_mask:0xf bank_mask:0xf
    v_add_f32_dpp v105, v105, v105 row_ror:1 row_mask:0xf bank_mask:0xf
    v_add_f32_dpp v106, v106, v106 row_ror:1 row_mask:0xf bank_mask:0xf
    v_add_f32_dpp v107, v107, v107 row_ror:1 row_mask:0xf bank_mask:0xf
    v_add_f32_dpp v108, v108, v108 row_ror:1 row_mask:0xf bank_mask:0xf
    v_add_f32_dpp v109, v109, v109 row_ror:1 row_mask:0xf bank_mask:0xf
    v_add_f32_dpp v110, v110, v110 row_ror:1 row_mask:0xf bank_mask:0xf
    v_add_f32_dpp v111, v111, v111 row_ror:1 row_mask:0xf bank_mask:0xf
    v_add_f32_dpp v112, v112, v112 row_ror:1 row_mask:0xf bank_mask:0xf
    v_add_f32_dpp v113, v113, v113 row_ror:1 row_mask:0xf bank_mask:0xf
    v_add_f32_dpp v114, v114, v114 row_ror:1 row_mask:0xf bank_mask:0xf
    v_add_f32_dpp v115, v115, v115 row_ror:1 row_mask:0xf bank_mask:0xf
    v_add_f32_dpp v116, v116, v116 row_ror:1 row_mask:0xf bank_mask:0xf
    v_add_f32_dpp v117, v117, v117 row_ror:1 row_mask:0xf bank_mask:0xf
    v_add_f32_dpp v118, v118, v118 row_ror:1 row_mask:0xf bank_mask:0xf
    v_add_f32_dpp v119, v119, v119 row_ror:1 row_mask:0xf bank_mask:0xf
    ds_write_b128 v22, v[100:103] offset:0
    ds_write_b128 v22, v[104:107] offset:64
    ds_write_b128 v22, v[108:111] offset:128
    ds_write_b128 v22, v[112:115] offset:192
    ds_write_b128 v22, v[116:119] offset:256
    s_waitcnt lgkmcnt(0)
    s_barrier
    ds_read_b64 v[100:101], v19 offset:3352
    ds_read_b64 v[102:103], v19 offset:3080
    ds_read_b64 v[104:105], v19 offset:3088
    ds_read_b64 v[106:107], v19 offset:3104
    ds_read_b64 v[108:109], v19 offset:3136
    ds_read_b64 v[110:111], v20 offset:3072
    ds_read_b64 v[112:113], v19 offset:3640
    ds_read_b64 v[114:115], v19 offset:3368
    ds_read_b64 v[116:117], v19 offset:3376
    ds_read_b64 v[118:119], v19 offset:3392
    ds_read_b64 v[120:121], v19 offset:3424
    ds_read_b64 v[122:123], v20 offset:3360
    s_mul_i32 s57, s51, 5
    s_lshl_b32 s58, s52, 1
    s_add_u32 s57, s57, s58
    s_mul_i32 s58, s50, 40
    s_add_u32 s57, s57, s58
    s_lshl_b32 s57, s57, 3
    s_lshl_b32 s58, s53, 2
    s_add_u32 s57, s57, s58
    s_lshl_b32 s57, s57, 10
    s_add_u32 s65, s57, 6291456
    v_lshlrev_b32 v27, 4, v0
    s_waitcnt lgkmcnt(0)
    ds_read_b64 v[228:229], v19 offset:5656
    ds_read_b64 v[230:231], v19 offset:5384
    ds_read_b64 v[232:233], v19 offset:5392
    ds_read_b64 v[234:235], v19 offset:5408
    ds_read_b64 v[236:237], v19 offset:5440
    ds_read_b64 v[238:239], v20 offset:5376
    ds_read_b64 v[240:241], v19 offset:5944
    ds_read_b64 v[242:243], v19 offset:5672
    ds_read_b64 v[244:245], v19 offset:5680
    ds_read_b64 v[246:247], v19 offset:5696
    ds_read_b64 v[248:249], v19 offset:5728
    ds_read_b64 v[250:251], v20 offset:5664
    v_mov_b32_dpp v124, v208 row_shr:1 row_mask:0xf bank_mask:0xf bound_ctrl:0
    v_mov_b32_dpp v125, v209 row_shr:1 row_mask:0xf bank_mask:0xf bound_ctrl:0
    v_mov_b32_dpp v126, v210 row_shr:1 row_mask:0xf bank_mask:0xf bound_ctrl:0
    v_mov_b32_dpp v127, v211 row_shr:1 row_mask:0xf bank_mask:0xf bound_ctrl:0
    v_pk_fma_f32 v[208:209], v[102:103], v[124:125], v[208:209] op_sel:[0,0,0] op_sel_hi:[0,1,1]
    v_pk_fma_f32 v[208:209], v[102:103], v[124:125], v[208:209] op_sel:[1,1,0] op_sel_hi:[1,0,1] neg_lo:[1,0,0]
    v_pk_fma_f32 v[210:211], v[114:115], v[126:127], v[210:211] op_sel:[0,0,0] op_sel_hi:[0,1,1]
    v_pk_fma_f32 v[210:211], v[114:115], v[126:127], v[210:211] op_sel:[1,1,0] op_sel_hi:[1,0,1] neg_lo:[1,0,0]
    v_mov_b32_dpp v124, v208 row_shr:2 row_mask:0xf bank_mask:0xf bound_ctrl:0
    v_mov_b32_dpp v125, v209 row_shr:2 row_mask:0xf bank_mask:0xf bound_ctrl:0
    v_mov_b32_dpp v126, v210 row_shr:2 row_mask:0xf bank_mask:0xf bound_ctrl:0
    v_mov_b32_dpp v127, v211 row_shr:2 row_mask:0xf bank_mask:0xf bound_ctrl:0
    v_pk_fma_f32 v[208:209], v[104:105], v[124:125], v[208:209] op_sel:[0,0,0] op_sel_hi:[0,1,1]
    v_pk_fma_f32 v[208:209], v[104:105], v[124:125], v[208:209] op_sel:[1,1,0] op_sel_hi:[1,0,1] neg_lo:[1,0,0]
    v_pk_fma_f32 v[210:211], v[116:117], v[126:127], v[210:211] op_sel:[0,0,0] op_sel_hi:[0,1,1]
    v_pk_fma_f32 v[210:211], v[116:117], v[126:127], v[210:211] op_sel:[1,1,0] op_sel_hi:[1,0,1] neg_lo:[1,0,0]
    v_mov_b32_dpp v124, v208 row_shr:4 row_mask:0xf bank_mask:0xf bound_ctrl:0
    v_mov_b32_dpp v125, v209 row_shr:4 row_mask:0xf bank_mask:0xf bound_ctrl:0
    v_mov_b32_dpp v126, v210 row_shr:4 row_mask:0xf bank_mask:0xf bound_ctrl:0
    v_mov_b32_dpp v127, v211 row_shr:4 row_mask:0xf bank_mask:0xf bound_ctrl:0
    v_pk_fma_f32 v[208:209], v[106:107], v[124:125], v[208:209] op_sel:[0,0,0] op_sel_hi:[0,1,1]
    v_pk_fma_f32 v[208:209], v[106:107], v[124:125], v[208:209] op_sel:[1,1,0] op_sel_hi:[1,0,1] neg_lo:[1,0,0]
    v_pk_fma_f32 v[210:211], v[118:119], v[126:127], v[210:211] op_sel:[0,0,0] op_sel_hi:[0,1,1]
    v_pk_fma_f32 v[210:211], v[118:119], v[126:127], v[210:211] op_sel:[1,1,0] op_sel_hi:[1,0,1] neg_lo:[1,0,0]
    v_mov_b32_dpp v124, v208 row_shr:8 row_mask:0xf bank_mask:0xf bound_ctrl:0
    v_mov_b32_dpp v125, v209 row_shr:8 row_mask:0xf bank_mask:0xf bound_ctrl:0
    v_mov_b32_dpp v126, v210 row_shr:8 row_mask:0xf bank_mask:0xf bound_ctrl:0
    v_mov_b32_dpp v127, v211 row_shr:8 row_mask:0xf bank_mask:0xf bound_ctrl:0
    v_pk_fma_f32 v[208:209], v[108:109], v[124:125], v[208:209] op_sel:[0,0,0] op_sel_hi:[0,1,1]
    v_pk_fma_f32 v[208:209], v[108:109], v[124:125], v[208:209] op_sel:[1,1,0] op_sel_hi:[1,0,1] neg_lo:[1,0,0]
    v_pk_fma_f32 v[210:211], v[120:121], v[126:127], v[210:211] op_sel:[0,0,0] op_sel_hi:[0,1,1]
    v_pk_fma_f32 v[210:211], v[120:121], v[126:127], v[210:211] op_sel:[1,1,0] op_sel_hi:[1,0,1] neg_lo:[1,0,0]
    v_mov_b32_dpp v124, v208 row_shr:1 row_mask:0xf bank_mask:0xf bound_ctrl:0
    v_mov_b32_dpp v125, v209 row_shr:1 row_mask:0xf bank_mask:0xf bound_ctrl:0
    v_mov_b32_dpp v126, v210 row_shr:1 row_mask:0xf bank_mask:0xf bound_ctrl:0
    v_mov_b32_dpp v127, v211 row_shr:1 row_mask:0xf bank_mask:0xf bound_ctrl:0
    v_pk_mul_f32 v[208:209], v[100:101], v[124:125] op_sel:[0,0] op_sel_hi:[0,1]
    v_pk_fma_f32 v[208:209], v[100:101], v[124:125], v[208:209] op_sel:[1,1,0] op_sel_hi:[1,0,1] neg_lo:[1,0,0]
    v_pk_mul_f32 v[62:63], v[100:101], v[110:111] op_sel:[0,0] op_sel_hi:[0,1]
    v_pk_fma_f32 v[62:63], v[100:101], v[110:111], v[62:63] op_sel:[1,1,0] op_sel_hi:[1,0,1] neg_lo:[1,0,0]
    v_pk_mul_f32 v[210:211], v[112:113], v[126:127] op_sel:[0,0] op_sel_hi:[0,1]
    v_pk_fma_f32 v[210:211], v[112:113], v[126:127], v[210:211] op_sel:[1,1,0] op_sel_hi:[1,0,1] neg_lo:[1,0,0]
    v_pk_mul_f32 v[66:67], v[112:113], v[122:123] op_sel:[0,0] op_sel_hi:[0,1]
    v_pk_fma_f32 v[66:67], v[112:113], v[122:123], v[66:67] op_sel:[1,1,0] op_sel_hi:[1,0,1] neg_lo:[1,0,0]
    v_pk_mul_f32 v[124:125], v[100:101], v[128:129] op_sel:[0,0] op_sel_hi:[0,1]
    v_pk_fma_f32 v[128:129], v[100:101], v[128:129], v[124:125] op_sel:[1,1,0] op_sel_hi:[1,0,1] neg_lo:[1,0,0]
    v_pk_mul_f32 v[126:127], v[112:113], v[130:131] op_sel:[0,0] op_sel_hi:[0,1]
    v_pk_fma_f32 v[130:131], v[112:113], v[130:131], v[126:127] op_sel:[1,1,0] op_sel_hi:[1,0,1] neg_lo:[1,0,0]
    v_pk_mul_f32 v[124:125], v[100:101], v[132:133] op_sel:[0,0] op_sel_hi:[0,1]
    v_pk_fma_f32 v[132:133], v[100:101], v[132:133], v[124:125] op_sel:[1,1,0] op_sel_hi:[1,0,1] neg_lo:[1,0,0]
    v_pk_mul_f32 v[126:127], v[112:113], v[134:135] op_sel:[0,0] op_sel_hi:[0,1]
    v_pk_fma_f32 v[134:135], v[112:113], v[134:135], v[126:127] op_sel:[1,1,0] op_sel_hi:[1,0,1] neg_lo:[1,0,0]
    v_pk_mul_f32 v[124:125], v[100:101], v[136:137] op_sel:[0,0] op_sel_hi:[0,1]
    v_pk_fma_f32 v[136:137], v[100:101], v[136:137], v[124:125] op_sel:[1,1,0] op_sel_hi:[1,0,1] neg_lo:[1,0,0]
    v_pk_mul_f32 v[126:127], v[112:113], v[138:139] op_sel:[0,0] op_sel_hi:[0,1]
    v_pk_fma_f32 v[138:139], v[112:113], v[138:139], v[126:127] op_sel:[1,1,0] op_sel_hi:[1,0,1] neg_lo:[1,0,0]
    v_pk_mul_f32 v[124:125], v[100:101], v[140:141] op_sel:[0,0] op_sel_hi:[0,1]
    v_pk_fma_f32 v[140:141], v[100:101], v[140:141], v[124:125] op_sel:[1,1,0] op_sel_hi:[1,0,1] neg_lo:[1,0,0]
    v_pk_mul_f32 v[126:127], v[112:113], v[142:143] op_sel:[0,0] op_sel_hi:[0,1]
    v_pk_fma_f32 v[142:143], v[112:113], v[142:143], v[126:127] op_sel:[1,1,0] op_sel_hi:[1,0,1] neg_lo:[1,0,0]
    s_waitcnt lgkmcnt(0)
    ds_read_b64 v[100:101], v19 offset:7960
    ds_read_b64 v[102:103], v19 offset:7688
    ds_read_b64 v[104:105], v19 offset:7696
    ds_read_b64 v[106:107], v19 offset:7712
    ds_read_b64 v[108:109], v19 offset:7744
    ds_read_b64 v[110:111], v20 offset:7680
    ds_read_b64 v[112:113], v19 offset:8248
    ds_read_b64 v[114:115], v19 offset:7976
    ds_read_b64 v[116:117], v19 offset:7984
    ds_read_b64 v[118:119], v19 offset:8000
    ds_read_b64 v[120:121], v19 offset:8032
    ds_read_b64 v[122:123], v20 offset:7968
    v_mov_b32_dpp v124, v212 row_shr:1 row_mask:0xf bank_mask:0xf bound_ctrl:0
    v_mov_b32_dpp v125, v213 row_shr:1 row_mask:0xf bank_mask:0xf bound_ctrl:0
    v_mov_b32_dpp v126, v214 row_shr:1 row_mask:0xf bank_mask:0xf bound_ctrl:0
    v_mov_b32_dpp v127, v215 row_shr:1 row_mask:0xf bank_mask:0xf bound_ctrl:0
    v_pk_fma_f32 v[212:213], v[230:231], v[124:125], v[212:213] op_sel:[0,0,0] op_sel_hi:[0,1,1]
    v_pk_fma_f32 v[212:213], v[230:231], v[124:125], v[212:213] op_sel:[1,1,0] op_sel_hi:[1,0,1] neg_lo:[1,0,0]
    v_pk_fma_f32 v[214:215], v[242:243], v[126:127], v[214:215] op_sel:[0,0,0] op_sel_hi:[0,1,1]
    v_pk_fma_f32 v[214:215], v[242:243], v[126:127], v[214:215] op_sel:[1,1,0] op_sel_hi:[1,0,1] neg_lo:[1,0,0]
    v_mov_b32_dpp v124, v212 row_shr:2 row_mask:0xf bank_mask:0xf bound_ctrl:0
    v_mov_b32_dpp v125, v213 row_shr:2 row_mask:0xf bank_mask:0xf bound_ctrl:0
    v_mov_b32_dpp v126, v214 row_shr:2 row_mask:0xf bank_mask:0xf bound_ctrl:0
    v_mov_b32_dpp v127, v215 row_shr:2 row_mask:0xf bank_mask:0xf bound_ctrl:0
    v_pk_fma_f32 v[212:213], v[232:233], v[124:125], v[212:213] op_sel:[0,0,0] op_sel_hi:[0,1,1]
    v_pk_fma_f32 v[212:213], v[232:233], v[124:125], v[212:213] op_sel:[1,1,0] op_sel_hi:[1,0,1] neg_lo:[1,0,0]
    v_pk_fma_f32 v[214:215], v[244:245], v[126:127], v[214:215] op_sel:[0,0,0] op_sel_hi:[0,1,1]
    v_pk_fma_f32 v[214:215], v[244:245], v[126:127], v[214:215] op_sel:[1,1,0] op_sel_hi:[1,0,1] neg_lo:[1,0,0]
    v_mov_b32_dpp v124, v212 row_shr:4 row_mask:0xf bank_mask:0xf bound_ctrl:0
    v_mov_b32_dpp v125, v213 row_shr:4 row_mask:0xf bank_mask:0xf bound_ctrl:0
    v_mov_b32_dpp v126, v214 row_shr:4 row_mask:0xf bank_mask:0xf bound_ctrl:0
    v_mov_b32_dpp v127, v215 row_shr:4 row_mask:0xf bank_mask:0xf bound_ctrl:0
    v_pk_fma_f32 v[212:213], v[234:235], v[124:125], v[212:213] op_sel:[0,0,0] op_sel_hi:[0,1,1]
    v_pk_fma_f32 v[212:213], v[234:235], v[124:125], v[212:213] op_sel:[1,1,0] op_sel_hi:[1,0,1] neg_lo:[1,0,0]
    v_pk_fma_f32 v[214:215], v[246:247], v[126:127], v[214:215] op_sel:[0,0,0] op_sel_hi:[0,1,1]
    v_pk_fma_f32 v[214:215], v[246:247], v[126:127], v[214:215] op_sel:[1,1,0] op_sel_hi:[1,0,1] neg_lo:[1,0,0]
    v_mov_b32_dpp v124, v212 row_shr:8 row_mask:0xf bank_mask:0xf bound_ctrl:0
    v_mov_b32_dpp v125, v213 row_shr:8 row_mask:0xf bank_mask:0xf bound_ctrl:0
    v_mov_b32_dpp v126, v214 row_shr:8 row_mask:0xf bank_mask:0xf bound_ctrl:0
    v_mov_b32_dpp v127, v215 row_shr:8 row_mask:0xf bank_mask:0xf bound_ctrl:0
    v_pk_fma_f32 v[212:213], v[236:237], v[124:125], v[212:213] op_sel:[0,0,0] op_sel_hi:[0,1,1]
    v_pk_fma_f32 v[212:213], v[236:237], v[124:125], v[212:213] op_sel:[1,1,0] op_sel_hi:[1,0,1] neg_lo:[1,0,0]
    v_pk_fma_f32 v[214:215], v[248:249], v[126:127], v[214:215] op_sel:[0,0,0] op_sel_hi:[0,1,1]
    v_pk_fma_f32 v[214:215], v[248:249], v[126:127], v[214:215] op_sel:[1,1,0] op_sel_hi:[1,0,1] neg_lo:[1,0,0]
    v_mov_b32_dpp v124, v212 row_shr:1 row_mask:0xf bank_mask:0xf bound_ctrl:0
    v_mov_b32_dpp v125, v213 row_shr:1 row_mask:0xf bank_mask:0xf bound_ctrl:0
    v_mov_b32_dpp v126, v214 row_shr:1 row_mask:0xf bank_mask:0xf bound_ctrl:0
    v_mov_b32_dpp v127, v215 row_shr:1 row_mask:0xf bank_mask:0xf bound_ctrl:0
    v_pk_mul_f32 v[212:213], v[228:229], v[124:125] op_sel:[0,0] op_sel_hi:[0,1]
    v_pk_fma_f32 v[212:213], v[228:229], v[124:125], v[212:213] op_sel:[1,1,0] op_sel_hi:[1,0,1] neg_lo:[1,0,0]
    v_pk_mul_f32 v[70:71], v[228:229], v[238:239] op_sel:[0,0] op_sel_hi:[0,1]
    v_pk_fma_f32 v[70:71], v[228:229], v[238:239], v[70:71] op_sel:[1,1,0] op_sel_hi:[1,0,1] neg_lo:[1,0,0]
    v_pk_mul_f32 v[214:215], v[240:241], v[126:127] op_sel:[0,0] op_sel_hi:[0,1]
    v_pk_fma_f32 v[214:215], v[240:241], v[126:127], v[214:215] op_sel:[1,1,0] op_sel_hi:[1,0,1] neg_lo:[1,0,0]
    v_pk_mul_f32 v[74:75], v[240:241], v[250:251] op_sel:[0,0] op_sel_hi:[0,1]
    v_pk_fma_f32 v[74:75], v[240:241], v[250:251], v[74:75] op_sel:[1,1,0] op_sel_hi:[1,0,1] neg_lo:[1,0,0]
    v_pk_mul_f32 v[124:125], v[228:229], v[144:145] op_sel:[0,0] op_sel_hi:[0,1]
    v_pk_fma_f32 v[144:145], v[228:229], v[144:145], v[124:125] op_sel:[1,1,0] op_sel_hi:[1,0,1] neg_lo:[1,0,0]
    v_pk_mul_f32 v[126:127], v[240:241], v[146:147] op_sel:[0,0] op_sel_hi:[0,1]
    v_pk_fma_f32 v[146:147], v[240:241], v[146:147], v[126:127] op_sel:[1,1,0] op_sel_hi:[1,0,1] neg_lo:[1,0,0]
    v_pk_mul_f32 v[124:125], v[228:229], v[148:149] op_sel:[0,0] op_sel_hi:[0,1]
    v_pk_fma_f32 v[148:149], v[228:229], v[148:149], v[124:125] op_sel:[1,1,0] op_sel_hi:[1,0,1] neg_lo:[1,0,0]
    v_pk_mul_f32 v[126:127], v[240:241], v[150:151] op_sel:[0,0] op_sel_hi:[0,1]
    v_pk_fma_f32 v[150:151], v[240:241], v[150:151], v[126:127] op_sel:[1,1,0] op_sel_hi:[1,0,1] neg_lo:[1,0,0]
    v_pk_mul_f32 v[124:125], v[228:229], v[152:153] op_sel:[0,0] op_sel_hi:[0,1]
    v_pk_fma_f32 v[152:153], v[228:229], v[152:153], v[124:125] op_sel:[1,1,0] op_sel_hi:[1,0,1] neg_lo:[1,0,0]
    v_pk_mul_f32 v[126:127], v[240:241], v[154:155] op_sel:[0,0] op_sel_hi:[0,1]
    v_pk_fma_f32 v[154:155], v[240:241], v[154:155], v[126:127] op_sel:[1,1,0] op_sel_hi:[1,0,1] neg_lo:[1,0,0]
    v_pk_mul_f32 v[124:125], v[228:229], v[156:157] op_sel:[0,0] op_sel_hi:[0,1]
    v_pk_fma_f32 v[156:157], v[228:229], v[156:157], v[124:125] op_sel:[1,1,0] op_sel_hi:[1,0,1] neg_lo:[1,0,0]
    v_pk_mul_f32 v[126:127], v[240:241], v[158:159] op_sel:[0,0] op_sel_hi:[0,1]
    v_pk_fma_f32 v[158:159], v[240:241], v[158:159], v[126:127] op_sel:[1,1,0] op_sel_hi:[1,0,1] neg_lo:[1,0,0]
    s_waitcnt lgkmcnt(0)
    ds_read_b64 v[228:229], v19 offset:10264
    ds_read_b64 v[230:231], v19 offset:9992
    ds_read_b64 v[232:233], v19 offset:10000
    ds_read_b64 v[234:235], v19 offset:10016
    ds_read_b64 v[236:237], v19 offset:10048
    ds_read_b64 v[238:239], v20 offset:9984
    ds_read_b64 v[240:241], v19 offset:10552
    ds_read_b64 v[242:243], v19 offset:10280
    ds_read_b64 v[244:245], v19 offset:10288
    ds_read_b64 v[246:247], v19 offset:10304
    ds_read_b64 v[248:249], v19 offset:10336
    ds_read_b64 v[250:251], v20 offset:10272
    v_mov_b32_dpp v124, v216 row_shr:1 row_mask:0xf bank_mask:0xf bound_ctrl:0
    v_mov_b32_dpp v125, v217 row_shr:1 row_mask:0xf bank_mask:0xf bound_ctrl:0
    v_mov_b32_dpp v126, v218 row_shr:1 row_mask:0xf bank_mask:0xf bound_ctrl:0
    v_mov_b32_dpp v127, v219 row_shr:1 row_mask:0xf bank_mask:0xf bound_ctrl:0
    v_pk_fma_f32 v[216:217], v[102:103], v[124:125], v[216:217] op_sel:[0,0,0] op_sel_hi:[0,1,1]
    v_pk_fma_f32 v[216:217], v[102:103], v[124:125], v[216:217] op_sel:[1,1,0] op_sel_hi:[1,0,1] neg_lo:[1,0,0]
    v_pk_fma_f32 v[218:219], v[114:115], v[126:127], v[218:219] op_sel:[0,0,0] op_sel_hi:[0,1,1]
    v_pk_fma_f32 v[218:219], v[114:115], v[126:127], v[218:219] op_sel:[1,1,0] op_sel_hi:[1,0,1] neg_lo:[1,0,0]
    v_mov_b32_dpp v124, v216 row_shr:2 row_mask:0xf bank_mask:0xf bound_ctrl:0
    v_mov_b32_dpp v125, v217 row_shr:2 row_mask:0xf bank_mask:0xf bound_ctrl:0
    v_mov_b32_dpp v126, v218 row_shr:2 row_mask:0xf bank_mask:0xf bound_ctrl:0
    v_mov_b32_dpp v127, v219 row_shr:2 row_mask:0xf bank_mask:0xf bound_ctrl:0
    v_pk_fma_f32 v[216:217], v[104:105], v[124:125], v[216:217] op_sel:[0,0,0] op_sel_hi:[0,1,1]
    v_pk_fma_f32 v[216:217], v[104:105], v[124:125], v[216:217] op_sel:[1,1,0] op_sel_hi:[1,0,1] neg_lo:[1,0,0]
    v_pk_fma_f32 v[218:219], v[116:117], v[126:127], v[218:219] op_sel:[0,0,0] op_sel_hi:[0,1,1]
    v_pk_fma_f32 v[218:219], v[116:117], v[126:127], v[218:219] op_sel:[1,1,0] op_sel_hi:[1,0,1] neg_lo:[1,0,0]
    v_mov_b32_dpp v124, v216 row_shr:4 row_mask:0xf bank_mask:0xf bound_ctrl:0
    v_mov_b32_dpp v125, v217 row_shr:4 row_mask:0xf bank_mask:0xf bound_ctrl:0
    v_mov_b32_dpp v126, v218 row_shr:4 row_mask:0xf bank_mask:0xf bound_ctrl:0
    v_mov_b32_dpp v127, v219 row_shr:4 row_mask:0xf bank_mask:0xf bound_ctrl:0
    v_pk_fma_f32 v[216:217], v[106:107], v[124:125], v[216:217] op_sel:[0,0,0] op_sel_hi:[0,1,1]
    v_pk_fma_f32 v[216:217], v[106:107], v[124:125], v[216:217] op_sel:[1,1,0] op_sel_hi:[1,0,1] neg_lo:[1,0,0]
    v_pk_fma_f32 v[218:219], v[118:119], v[126:127], v[218:219] op_sel:[0,0,0] op_sel_hi:[0,1,1]
    v_pk_fma_f32 v[218:219], v[118:119], v[126:127], v[218:219] op_sel:[1,1,0] op_sel_hi:[1,0,1] neg_lo:[1,0,0]
    v_mov_b32_dpp v124, v216 row_shr:8 row_mask:0xf bank_mask:0xf bound_ctrl:0
    v_mov_b32_dpp v125, v217 row_shr:8 row_mask:0xf bank_mask:0xf bound_ctrl:0
    v_mov_b32_dpp v126, v218 row_shr:8 row_mask:0xf bank_mask:0xf bound_ctrl:0
    v_mov_b32_dpp v127, v219 row_shr:8 row_mask:0xf bank_mask:0xf bound_ctrl:0
    v_pk_fma_f32 v[216:217], v[108:109], v[124:125], v[216:217] op_sel:[0,0,0] op_sel_hi:[0,1,1]
    v_pk_fma_f32 v[216:217], v[108:109], v[124:125], v[216:217] op_sel:[1,1,0] op_sel_hi:[1,0,1] neg_lo:[1,0,0]
    v_pk_fma_f32 v[218:219], v[120:121], v[126:127], v[218:219] op_sel:[0,0,0] op_sel_hi:[0,1,1]
    v_pk_fma_f32 v[218:219], v[120:121], v[126:127], v[218:219] op_sel:[1,1,0] op_sel_hi:[1,0,1] neg_lo:[1,0,0]
    v_mov_b32_dpp v124, v216 row_shr:1 row_mask:0xf bank_mask:0xf bound_ctrl:0
    v_mov_b32_dpp v125, v217 row_shr:1 row_mask:0xf bank_mask:0xf bound_ctrl:0
    v_mov_b32_dpp v126, v218 row_shr:1 row_mask:0xf bank_mask:0xf bound_ctrl:0
    v_mov_b32_dpp v127, v219 row_shr:1 row_mask:0xf bank_mask:0xf bound_ctrl:0
    v_pk_mul_f32 v[216:217], v[100:101], v[124:125] op_sel:[0,0] op_sel_hi:[0,1]
    v_pk_fma_f32 v[216:217], v[100:101], v[124:125], v[216:217] op_sel:[1,1,0] op_sel_hi:[1,0,1] neg_lo:[1,0,0]
    v_pk_mul_f32 v[78:79], v[100:101], v[110:111] op_sel:[0,0] op_sel_hi:[0,1]
    v_pk_fma_f32 v[78:79], v[100:101], v[110:111], v[78:79] op_sel:[1,1,0] op_sel_hi:[1,0,1] neg_lo:[1,0,0]
    v_pk_mul_f32 v[218:219], v[112:113], v[126:127] op_sel:[0,0] op_sel_hi:[0,1]
    v_pk_fma_f32 v[218:219], v[112:113], v[126:127], v[218:219] op_sel:[1,1,0] op_sel_hi:[1,0,1] neg_lo:[1,0,0]
    v_pk_mul_f32 v[82:83], v[112:113], v[122:123] op_sel:[0,0] op_sel_hi:[0,1]
    v_pk_fma_f32 v[82:83], v[112:113], v[122:123], v[82:83] op_sel:[1,1,0] op_sel_hi:[1,0,1] neg_lo:[1,0,0]
    v_pk_mul_f32 v[124:125], v[100:101], v[160:161] op_sel:[0,0] op_sel_hi:[0,1]
    v_pk_fma_f32 v[160:161], v[100:101], v[160:161], v[124:125] op_sel:[1,1,0] op_sel_hi:[1,0,1] neg_lo:[1,0,0]
    v_pk_mul_f32 v[126:127], v[112:113], v[162:163] op_sel:[0,0] op_sel_hi:[0,1]
    v_pk_fma_f32 v[162:163], v[112:113], v[162:163], v[126:127] op_sel:[1,1,0] op_sel_hi:[1,0,1] neg_lo:[1,0,0]
    v_pk_mul_f32 v[124:125], v[100:101], v[164:165] op_sel:[0,0] op_sel_hi:[0,1]
    v_pk_fma_f32 v[164:165], v[100:101], v[164:165], v[124:125] op_sel:[1,1,0] op_sel_hi:[1,0,1] neg_lo:[1,0,0]
    v_pk_mul_f32 v[126:127], v[112:113], v[166:167] op_sel:[0,0] op_sel_hi:[0,1]
    v_pk_fma_f32 v[166:167], v[112:113], v[166:167], v[126:127] op_sel:[1,1,0] op_sel_hi:[1,0,1] neg_lo:[1,0,0]
    v_pk_mul_f32 v[124:125], v[100:101], v[168:169] op_sel:[0,0] op_sel_hi:[0,1]
    v_pk_fma_f32 v[168:169], v[100:101], v[168:169], v[124:125] op_sel:[1,1,0] op_sel_hi:[1,0,1] neg_lo:[1,0,0]
    v_pk_mul_f32 v[126:127], v[112:113], v[170:171] op_sel:[0,0] op_sel_hi:[0,1]
    v_pk_fma_f32 v[170:171], v[112:113], v[170:171], v[126:127] op_sel:[1,1,0] op_sel_hi:[1,0,1] neg_lo:[1,0,0]
    v_pk_mul_f32 v[124:125], v[100:101], v[172:173] op_sel:[0,0] op_sel_hi:[0,1]
    v_pk_fma_f32 v[172:173], v[100:101], v[172:173], v[124:125] op_sel:[1,1,0] op_sel_hi:[1,0,1] neg_lo:[1,0,0]
    v_pk_mul_f32 v[126:127], v[112:113], v[174:175] op_sel:[0,0] op_sel_hi:[0,1]
    v_pk_fma_f32 v[174:175], v[112:113], v[174:175], v[126:127] op_sel:[1,1,0] op_sel_hi:[1,0,1] neg_lo:[1,0,0]
    s_waitcnt lgkmcnt(0)
    ds_read_b64 v[100:101], v19 offset:12568
    ds_read_b64 v[102:103], v19 offset:12296
    ds_read_b64 v[104:105], v19 offset:12304
    ds_read_b64 v[106:107], v19 offset:12320
    ds_read_b64 v[108:109], v19 offset:12352
    ds_read_b64 v[110:111], v20 offset:12288
    ds_read_b64 v[112:113], v19 offset:12856
    ds_read_b64 v[114:115], v19 offset:12584
    ds_read_b64 v[116:117], v19 offset:12592
    ds_read_b64 v[118:119], v19 offset:12608
    ds_read_b64 v[120:121], v19 offset:12640
    ds_read_b64 v[122:123], v20 offset:12576
    v_mov_b32_dpp v124, v220 row_shr:1 row_mask:0xf bank_mask:0xf bound_ctrl:0
    v_mov_b32_dpp v125, v221 row_shr:1 row_mask:0xf bank_mask:0xf bound_ctrl:0
    v_mov_b32_dpp v126, v222 row_shr:1 row_mask:0xf bank_mask:0xf bound_ctrl:0
    v_mov_b32_dpp v127, v223 row_shr:1 row_mask:0xf bank_mask:0xf bound_ctrl:0
    v_pk_fma_f32 v[220:221], v[230:231], v[124:125], v[220:221] op_sel:[0,0,0] op_sel_hi:[0,1,1]
    v_pk_fma_f32 v[220:221], v[230:231], v[124:125], v[220:221] op_sel:[1,1,0] op_sel_hi:[1,0,1] neg_lo:[1,0,0]
    v_pk_fma_f32 v[222:223], v[242:243], v[126:127], v[222:223] op_sel:[0,0,0] op_sel_hi:[0,1,1]
    v_pk_fma_f32 v[222:223], v[242:243], v[126:127], v[222:223] op_sel:[1,1,0] op_sel_hi:[1,0,1] neg_lo:[1,0,0]
    v_mov_b32_dpp v124, v220 row_shr:2 row_mask:0xf bank_mask:0xf bound_ctrl:0
    v_mov_b32_dpp v125, v221 row_shr:2 row_mask:0xf bank_mask:0xf bound_ctrl:0
    v_mov_b32_dpp v126, v222 row_shr:2 row_mask:0xf bank_mask:0xf bound_ctrl:0
    v_mov_b32_dpp v127, v223 row_shr:2 row_mask:0xf bank_mask:0xf bound_ctrl:0
    v_pk_fma_f32 v[220:221], v[232:233], v[124:125], v[220:221] op_sel:[0,0,0] op_sel_hi:[0,1,1]
    v_pk_fma_f32 v[220:221], v[232:233], v[124:125], v[220:221] op_sel:[1,1,0] op_sel_hi:[1,0,1] neg_lo:[1,0,0]
    v_pk_fma_f32 v[222:223], v[244:245], v[126:127], v[222:223] op_sel:[0,0,0] op_sel_hi:[0,1,1]
    v_pk_fma_f32 v[222:223], v[244:245], v[126:127], v[222:223] op_sel:[1,1,0] op_sel_hi:[1,0,1] neg_lo:[1,0,0]
    v_mov_b32_dpp v124, v220 row_shr:4 row_mask:0xf bank_mask:0xf bound_ctrl:0
    v_mov_b32_dpp v125, v221 row_shr:4 row_mask:0xf bank_mask:0xf bound_ctrl:0
    v_mov_b32_dpp v126, v222 row_shr:4 row_mask:0xf bank_mask:0xf bound_ctrl:0
    v_mov_b32_dpp v127, v223 row_shr:4 row_mask:0xf bank_mask:0xf bound_ctrl:0
    v_pk_fma_f32 v[220:221], v[234:235], v[124:125], v[220:221] op_sel:[0,0,0] op_sel_hi:[0,1,1]
    v_pk_fma_f32 v[220:221], v[234:235], v[124:125], v[220:221] op_sel:[1,1,0] op_sel_hi:[1,0,1] neg_lo:[1,0,0]
    v_pk_fma_f32 v[222:223], v[246:247], v[126:127], v[222:223] op_sel:[0,0,0] op_sel_hi:[0,1,1]
    v_pk_fma_f32 v[222:223], v[246:247], v[126:127], v[222:223] op_sel:[1,1,0] op_sel_hi:[1,0,1] neg_lo:[1,0,0]
    v_mov_b32_dpp v124, v220 row_shr:8 row_mask:0xf bank_mask:0xf bound_ctrl:0
    v_mov_b32_dpp v125, v221 row_shr:8 row_mask:0xf bank_mask:0xf bound_ctrl:0
    v_mov_b32_dpp v126, v222 row_shr:8 row_mask:0xf bank_mask:0xf bound_ctrl:0
    v_mov_b32_dpp v127, v223 row_shr:8 row_mask:0xf bank_mask:0xf bound_ctrl:0
    v_pk_fma_f32 v[220:221], v[236:237], v[124:125], v[220:221] op_sel:[0,0,0] op_sel_hi:[0,1,1]
    v_pk_fma_f32 v[220:221], v[236:237], v[124:125], v[220:221] op_sel:[1,1,0] op_sel_hi:[1,0,1] neg_lo:[1,0,0]
    v_pk_fma_f32 v[222:223], v[248:249], v[126:127], v[222:223] op_sel:[0,0,0] op_sel_hi:[0,1,1]
    v_pk_fma_f32 v[222:223], v[248:249], v[126:127], v[222:223] op_sel:[1,1,0] op_sel_hi:[1,0,1] neg_lo:[1,0,0]
    v_mov_b32_dpp v124, v220 row_shr:1 row_mask:0xf bank_mask:0xf bound_ctrl:0
    v_mov_b32_dpp v125, v221 row_shr:1 row_mask:0xf bank_mask:0xf bound_ctrl:0
    v_mov_b32_dpp v126, v222 row_shr:1 row_mask:0xf bank_mask:0xf bound_ctrl:0
    v_mov_b32_dpp v127, v223 row_shr:1 row_mask:0xf bank_mask:0xf bound_ctrl:0
    v_pk_mul_f32 v[220:221], v[228:229], v[124:125] op_sel:[0,0] op_sel_hi:[0,1]
    v_pk_fma_f32 v[220:221], v[228:229], v[124:125], v[220:221] op_sel:[1,1,0] op_sel_hi:[1,0,1] neg_lo:[1,0,0]
    v_pk_mul_f32 v[86:87], v[228:229], v[238:239] op_sel:[0,0] op_sel_hi:[0,1]
    v_pk_fma_f32 v[86:87], v[228:229], v[238:239], v[86:87] op_sel:[1,1,0] op_sel_hi:[1,0,1] neg_lo:[1,0,0]
    v_pk_mul_f32 v[222:223], v[240:241], v[126:127] op_sel:[0,0] op_sel_hi:[0,1]
    v_pk_fma_f32 v[222:223], v[240:241], v[126:127], v[222:223] op_sel:[1,1,0] op_sel_hi:[1,0,1] neg_lo:[1,0,0]
    v_pk_mul_f32 v[90:91], v[240:241], v[250:251] op_sel:[0,0] op_sel_hi:[0,1]
    v_pk_fma_f32 v[90:91], v[240:241], v[250:251], v[90:91] op_sel:[1,1,0] op_sel_hi:[1,0,1] neg_lo:[1,0,0]
    v_pk_mul_f32 v[124:125], v[228:229], v[176:177] op_sel:[0,0] op_sel_hi:[0,1]
    v_pk_fma_f32 v[176:177], v[228:229], v[176:177], v[124:125] op_sel:[1,1,0] op_sel_hi:[1,0,1] neg_lo:[1,0,0]
    v_pk_mul_f32 v[126:127], v[240:241], v[178:179] op_sel:[0,0] op_sel_hi:[0,1]
    v_pk_fma_f32 v[178:179], v[240:241], v[178:179], v[126:127] op_sel:[1,1,0] op_sel_hi:[1,0,1] neg_lo:[1,0,0]
    v_pk_mul_f32 v[124:125], v[228:229], v[180:181] op_sel:[0,0] op_sel_hi:[0,1]
    v_pk_fma_f32 v[180:181], v[228:229], v[180:181], v[124:125] op_sel:[1,1,0] op_sel_hi:[1,0,1] neg_lo:[1,0,0]
    v_pk_mul_f32 v[126:127], v[240:241], v[182:183] op_sel:[0,0] op_sel_hi:[0,1]
    v_pk_fma_f32 v[182:183], v[240:241], v[182:183], v[126:127] op_sel:[1,1,0] op_sel_hi:[1,0,1] neg_lo:[1,0,0]
    v_pk_mul_f32 v[124:125], v[228:229], v[184:185] op_sel:[0,0] op_sel_hi:[0,1]
    v_pk_fma_f32 v[184:185], v[228:229], v[184:185], v[124:125] op_sel:[1,1,0] op_sel_hi:[1,0,1] neg_lo:[1,0,0]
    v_pk_mul_f32 v[126:127], v[240:241], v[186:187] op_sel:[0,0] op_sel_hi:[0,1]
    v_pk_fma_f32 v[186:187], v[240:241], v[186:187], v[126:127] op_sel:[1,1,0] op_sel_hi:[1,0,1] neg_lo:[1,0,0]
    v_pk_mul_f32 v[124:125], v[228:229], v[188:189] op_sel:[0,0] op_sel_hi:[0,1]
    v_pk_fma_f32 v[188:189], v[228:229], v[188:189], v[124:125] op_sel:[1,1,0] op_sel_hi:[1,0,1] neg_lo:[1,0,0]
    v_pk_mul_f32 v[126:127], v[240:241], v[190:191] op_sel:[0,0] op_sel_hi:[0,1]
    v_pk_fma_f32 v[190:191], v[240:241], v[190:191], v[126:127] op_sel:[1,1,0] op_sel_hi:[1,0,1] neg_lo:[1,0,0]
    s_waitcnt lgkmcnt(0)
    v_mov_b32_dpp v124, v224 row_shr:1 row_mask:0xf bank_mask:0xf bound_ctrl:0
    v_mov_b32_dpp v125, v225 row_shr:1 row_mask:0xf bank_mask:0xf bound_ctrl:0
    v_mov_b32_dpp v126, v226 row_shr:1 row_mask:0xf bank_mask:0xf bound_ctrl:0
    v_mov_b32_dpp v127, v227 row_shr:1 row_mask:0xf bank_mask:0xf bound_ctrl:0
    v_pk_fma_f32 v[224:225], v[102:103], v[124:125], v[224:225] op_sel:[0,0,0] op_sel_hi:[0,1,1]
    v_pk_fma_f32 v[224:225], v[102:103], v[124:125], v[224:225] op_sel:[1,1,0] op_sel_hi:[1,0,1] neg_lo:[1,0,0]
    v_pk_fma_f32 v[226:227], v[114:115], v[126:127], v[226:227] op_sel:[0,0,0] op_sel_hi:[0,1,1]
    v_pk_fma_f32 v[226:227], v[114:115], v[126:127], v[226:227] op_sel:[1,1,0] op_sel_hi:[1,0,1] neg_lo:[1,0,0]
    v_mov_b32_dpp v124, v224 row_shr:2 row_mask:0xf bank_mask:0xf bound_ctrl:0
    v_mov_b32_dpp v125, v225 row_shr:2 row_mask:0xf bank_mask:0xf bound_ctrl:0
    v_mov_b32_dpp v126, v226 row_shr:2 row_mask:0xf bank_mask:0xf bound_ctrl:0
    v_mov_b32_dpp v127, v227 row_shr:2 row_mask:0xf bank_mask:0xf bound_ctrl:0
    v_pk_fma_f32 v[224:225], v[104:105], v[124:125], v[224:225] op_sel:[0,0,0] op_sel_hi:[0,1,1]
    v_pk_fma_f32 v[224:225], v[104:105], v[124:125], v[224:225] op_sel:[1,1,0] op_sel_hi:[1,0,1] neg_lo:[1,0,0]
    v_pk_fma_f32 v[226:227], v[116:117], v[126:127], v[226:227] op_sel:[0,0,0] op_sel_hi:[0,1,1]
    v_pk_fma_f32 v[226:227], v[116:117], v[126:127], v[226:227] op_sel:[1,1,0] op_sel_hi:[1,0,1] neg_lo:[1,0,0]
    v_mov_b32_dpp v124, v224 row_shr:4 row_mask:0xf bank_mask:0xf bound_ctrl:0
    v_mov_b32_dpp v125, v225 row_shr:4 row_mask:0xf bank_mask:0xf bound_ctrl:0
    v_mov_b32_dpp v126, v226 row_shr:4 row_mask:0xf bank_mask:0xf bound_ctrl:0
    v_mov_b32_dpp v127, v227 row_shr:4 row_mask:0xf bank_mask:0xf bound_ctrl:0
    v_pk_fma_f32 v[224:225], v[106:107], v[124:125], v[224:225] op_sel:[0,0,0] op_sel_hi:[0,1,1]
    v_pk_fma_f32 v[224:225], v[106:107], v[124:125], v[224:225] op_sel:[1,1,0] op_sel_hi:[1,0,1] neg_lo:[1,0,0]
    v_pk_fma_f32 v[226:227], v[118:119], v[126:127], v[226:227] op_sel:[0,0,0] op_sel_hi:[0,1,1]
    v_pk_fma_f32 v[226:227], v[118:119], v[126:127], v[226:227] op_sel:[1,1,0] op_sel_hi:[1,0,1] neg_lo:[1,0,0]
    v_mov_b32_dpp v124, v224 row_shr:8 row_mask:0xf bank_mask:0xf bound_ctrl:0
    v_mov_b32_dpp v125, v225 row_shr:8 row_mask:0xf bank_mask:0xf bound_ctrl:0
    v_mov_b32_dpp v126, v226 row_shr:8 row_mask:0xf bank_mask:0xf bound_ctrl:0
    v_mov_b32_dpp v127, v227 row_shr:8 row_mask:0xf bank_mask:0xf bound_ctrl:0
    v_pk_fma_f32 v[224:225], v[108:109], v[124:125], v[224:225] op_sel:[0,0,0] op_sel_hi:[0,1,1]
    v_pk_fma_f32 v[224:225], v[108:109], v[124:125], v[224:225] op_sel:[1,1,0] op_sel_hi:[1,0,1] neg_lo:[1,0,0]
    v_pk_fma_f32 v[226:227], v[120:121], v[126:127], v[226:227] op_sel:[0,0,0] op_sel_hi:[0,1,1]
    v_pk_fma_f32 v[226:227], v[120:121], v[126:127], v[226:227] op_sel:[1,1,0] op_sel_hi:[1,0,1] neg_lo:[1,0,0]
    v_mov_b32_dpp v124, v224 row_shr:1 row_mask:0xf bank_mask:0xf bound_ctrl:0
    v_mov_b32_dpp v125, v225 row_shr:1 row_mask:0xf bank_mask:0xf bound_ctrl:0
    v_mov_b32_dpp v126, v226 row_shr:1 row_mask:0xf bank_mask:0xf bound_ctrl:0
    v_mov_b32_dpp v127, v227 row_shr:1 row_mask:0xf bank_mask:0xf bound_ctrl:0
    v_pk_mul_f32 v[224:225], v[100:101], v[124:125] op_sel:[0,0] op_sel_hi:[0,1]
    v_pk_fma_f32 v[224:225], v[100:101], v[124:125], v[224:225] op_sel:[1,1,0] op_sel_hi:[1,0,1] neg_lo:[1,0,0]
    v_pk_mul_f32 v[94:95], v[100:101], v[110:111] op_sel:[0,0] op_sel_hi:[0,1]
    v_pk_fma_f32 v[94:95], v[100:101], v[110:111], v[94:95] op_sel:[1,1,0] op_sel_hi:[1,0,1] neg_lo:[1,0,0]
    v_pk_mul_f32 v[226:227], v[112:113], v[126:127] op_sel:[0,0] op_sel_hi:[0,1]
    v_pk_fma_f32 v[226:227], v[112:113], v[126:127], v[226:227] op_sel:[1,1,0] op_sel_hi:[1,0,1] neg_lo:[1,0,0]
    v_pk_mul_f32 v[98:99], v[112:113], v[122:123] op_sel:[0,0] op_sel_hi:[0,1]
    v_pk_fma_f32 v[98:99], v[112:113], v[122:123], v[98:99] op_sel:[1,1,0] op_sel_hi:[1,0,1] neg_lo:[1,0,0]
    v_pk_mul_f32 v[124:125], v[100:101], v[192:193] op_sel:[0,0] op_sel_hi:[0,1]
    v_pk_fma_f32 v[192:193], v[100:101], v[192:193], v[124:125] op_sel:[1,1,0] op_sel_hi:[1,0,1] neg_lo:[1,0,0]
    v_pk_mul_f32 v[126:127], v[112:113], v[194:195] op_sel:[0,0] op_sel_hi:[0,1]
    v_pk_fma_f32 v[194:195], v[112:113], v[194:195], v[126:127] op_sel:[1,1,0] op_sel_hi:[1,0,1] neg_lo:[1,0,0]
    v_pk_mul_f32 v[124:125], v[100:101], v[196:197] op_sel:[0,0] op_sel_hi:[0,1]
    v_pk_fma_f32 v[196:197], v[100:101], v[196:197], v[124:125] op_sel:[1,1,0] op_sel_hi:[1,0,1] neg_lo:[1,0,0]
    v_pk_mul_f32 v[126:127], v[112:113], v[198:199] op_sel:[0,0] op_sel_hi:[0,1]
    v_pk_fma_f32 v[198:199], v[112:113], v[198:199], v[126:127] op_sel:[1,1,0] op_sel_hi:[1,0,1] neg_lo:[1,0,0]
    v_pk_mul_f32 v[124:125], v[100:101], v[200:201] op_sel:[0,0] op_sel_hi:[0,1]
    v_pk_fma_f32 v[200:201], v[100:101], v[200:201], v[124:125] op_sel:[1,1,0] op_sel_hi:[1,0,1] neg_lo:[1,0,0]
    v_pk_mul_f32 v[126:127], v[112:113], v[202:203] op_sel:[0,0] op_sel_hi:[0,1]
    v_pk_fma_f32 v[202:203], v[112:113], v[202:203], v[126:127] op_sel:[1,1,0] op_sel_hi:[1,0,1] neg_lo:[1,0,0]
    v_pk_mul_f32 v[124:125], v[100:101], v[204:205] op_sel:[0,0] op_sel_hi:[0,1]
    v_pk_fma_f32 v[204:205], v[100:101], v[204:205], v[124:125] op_sel:[1,1,0] op_sel_hi:[1,0,1] neg_lo:[1,0,0]
    v_pk_mul_f32 v[126:127], v[112:113], v[206:207] op_sel:[0,0] op_sel_hi:[0,1]
    v_pk_fma_f32 v[206:207], v[112:113], v[206:207], v[126:127] op_sel:[1,1,0] op_sel_hi:[1,0,1] neg_lo:[1,0,0]
    s_waitcnt lgkmcnt(0)
    s_barrier
    ds_read_b128 v[100:103], v21 offset:1280
    ds_read_b128 v[104:107], v21 offset:1344
    ds_read_b128 v[108:111], v21 offset:1408
    ds_read_b128 v[112:115], v21 offset:1472
    ds_read_b128 v[116:119], v21 offset:1536
    s_waitcnt lgkmcnt(0)
    v_pk_fma_f32 v[208:209], v[62:63], v[100:101], v[208:209] op_sel:[0,0,0] op_sel_hi:[0,1,1]
    v_pk_fma_f32 v[208:209], v[62:63], v[100:101], v[208:209] op_sel:[1,1,0] op_sel_hi:[1,0,1] neg_lo:[1,0,0]
    v_pk_fma_f32 v[210:211], v[66:67], v[102:103], v[210:211] op_sel:[0,0,0] op_sel_hi:[0,1,1]
    v_pk_fma_f32 v[210:211], v[66:67], v[102:103], v[210:211] op_sel:[1,1,0] op_sel_hi:[1,0,1] neg_lo:[1,0,0]
    v_pk_fma_f32 v[212:213], v[70:71], v[104:105], v[212:213] op_sel:[0,0,0] op_sel_hi:[0,1,1]
    v_pk_fma_f32 v[212:213], v[70:71], v[104:105], v[212:213] op_sel:[1,1,0] op_sel_hi:[1,0,1] neg_lo:[1,0,0]
    v_pk_fma_f32 v[214:215], v[74:75], v[106:107], v[214:215] op_sel:[0,0,0] op_sel_hi:[0,1,1]
    v_pk_fma_f32 v[214:215], v[74:75], v[106:107], v[214:215] op_sel:[1,1,0] op_sel_hi:[1,0,1] neg_lo:[1,0,0]
    v_pk_fma_f32 v[216:217], v[78:79], v[108:109], v[216:217] op_sel:[0,0,0] op_sel_hi:[0,1,1]
    v_pk_fma_f32 v[216:217], v[78:79], v[108:109], v[216:217] op_sel:[1,1,0] op_sel_hi:[1,0,1] neg_lo:[1,0,0]
    v_pk_fma_f32 v[218:219], v[82:83], v[110:111], v[218:219] op_sel:[0,0,0] op_sel_hi:[0,1,1]
    v_pk_fma_f32 v[218:219], v[82:83], v[110:111], v[218:219] op_sel:[1,1,0] op_sel_hi:[1,0,1] neg_lo:[1,0,0]
    v_pk_fma_f32 v[220:221], v[86:87], v[112:113], v[220:221] op_sel:[0,0,0] op_sel_hi:[0,1,1]
    v_pk_fma_f32 v[220:221], v[86:87], v[112:113], v[220:221] op_sel:[1,1,0] op_sel_hi:[1,0,1] neg_lo:[1,0,0]
    v_pk_fma_f32 v[222:223], v[90:91], v[114:115], v[222:223] op_sel:[0,0,0] op_sel_hi:[0,1,1]
    v_pk_fma_f32 v[222:223], v[90:91], v[114:115], v[222:223] op_sel:[1,1,0] op_sel_hi:[1,0,1] neg_lo:[1,0,0]
    v_pk_fma_f32 v[224:225], v[94:95], v[116:117], v[224:225] op_sel:[0,0,0] op_sel_hi:[0,1,1]
    v_pk_fma_f32 v[224:225], v[94:95], v[116:117], v[224:225] op_sel:[1,1,0] op_sel_hi:[1,0,1] neg_lo:[1,0,0]
    v_pk_fma_f32 v[226:227], v[98:99], v[118:119], v[226:227] op_sel:[0,0,0] op_sel_hi:[0,1,1]
    v_pk_fma_f32 v[226:227], v[98:99], v[118:119], v[226:227] op_sel:[1,1,0] op_sel_hi:[1,0,1] neg_lo:[1,0,0]
    v_pk_fma_f32 v[128:129], v[60:61], v[208:209], v[128:129] op_sel:[0,0,0] op_sel_hi:[0,1,1]
    v_pk_fma_f32 v[128:129], v[60:61], v[208:209], v[128:129] op_sel:[1,1,0] op_sel_hi:[1,0,1] neg_lo:[1,0,0]
    v_pk_fma_f32 v[130:131], v[64:65], v[210:211], v[130:131] op_sel:[0,0,0] op_sel_hi:[0,1,1]
    v_pk_fma_f32 v[130:131], v[64:65], v[210:211], v[130:131] op_sel:[1,1,0] op_sel_hi:[1,0,1] neg_lo:[1,0,0]
    v_pk_fma_f32 v[144:145], v[68:69], v[212:213], v[144:145] op_sel:[0,0,0] op_sel_hi:[0,1,1]
    v_pk_fma_f32 v[144:145], v[68:69], v[212:213], v[144:145] op_sel:[1,1,0] op_sel_hi:[1,0,1] neg_lo:[1,0,0]
    v_pk_fma_f32 v[146:147], v[72:73], v[214:215], v[146:147] op_sel:[0,0,0] op_sel_hi:[0,1,1]
    v_pk_fma_f32 v[146:147], v[72:73], v[214:215], v[146:147] op_sel:[1,1,0] op_sel_hi:[1,0,1] neg_lo:[1,0,0]
    v_pk_fma_f32 v[160:161], v[76:77], v[216:217], v[160:161] op_sel:[0,0,0] op_sel_hi:[0,1,1]
    v_pk_fma_f32 v[160:161], v[76:77], v[216:217], v[160:161] op_sel:[1,1,0] op_sel_hi:[1,0,1] neg_lo:[1,0,0]
    v_pk_fma_f32 v[162:163], v[80:81], v[218:219], v[162:163] op_sel:[0,0,0] op_sel_hi:[0,1,1]
    v_pk_fma_f32 v[162:163], v[80:81], v[218:219], v[162:163] op_sel:[1,1,0] op_sel_hi:[1,0,1] neg_lo:[1,0,0]
    v_pk_fma_f32 v[176:177], v[84:85], v[220:221], v[176:177] op_sel:[0,0,0] op_sel_hi:[0,1,1]
    v_pk_fma_f32 v[176:177], v[84:85], v[220:221], v[176:177] op_sel:[1,1,0] op_sel_hi:[1,0,1] neg_lo:[1,0,0]
    v_pk_fma_f32 v[178:179], v[88:89], v[222:223], v[178:179] op_sel:[0,0,0] op_sel_hi:[0,1,1]
    v_pk_fma_f32 v[178:179], v[88:89], v[222:223], v[178:179] op_sel:[1,1,0] op_sel_hi:[1,0,1] neg_lo:[1,0,0]
    v_pk_fma_f32 v[192:193], v[92:93], v[224:225], v[192:193] op_sel:[0,0,0] op_sel_hi:[0,1,1]
    v_pk_fma_f32 v[192:193], v[92:93], v[224:225], v[192:193] op_sel:[1,1,0] op_sel_hi:[1,0,1] neg_lo:[1,0,0]
    v_pk_fma_f32 v[194:195], v[96:97], v[226:227], v[194:195] op_sel:[0,0,0] op_sel_hi:[0,1,1]
    v_pk_fma_f32 v[194:195], v[96:97], v[226:227], v[194:195] op_sel:[1,1,0] op_sel_hi:[1,0,1] neg_lo:[1,0,0]
    v_pk_fma_f32 v[132:133], v[60:61], v[128:129], v[132:133] op_sel:[0,0,0] op_sel_hi:[0,1,1]
    v_pk_fma_f32 v[132:133], v[60:61], v[128:129], v[132:133] op_sel:[1,1,0] op_sel_hi:[1,0,1] neg_lo:[1,0,0]
    v_pk_fma_f32 v[134:135], v[64:65], v[130:131], v[134:135] op_sel:[0,0,0] op_sel_hi:[0,1,1]
    v_pk_fma_f32 v[134:135], v[64:65], v[130:131], v[134:135] op_sel:[1,1,0] op_sel_hi:[1,0,1] neg_lo:[1,0,0]
    v_pk_fma_f32 v[148:149], v[68:69], v[144:145], v[148:149] op_sel:[0,0,0] op_sel_hi:[0,1,1]
    v_pk_fma_f32 v[148:149], v[68:69], v[144:145], v[148:149] op_sel:[1,1,0] op_sel_hi:[1,0,1] neg_lo:[1,0,0]
    v_pk_fma_f32 v[150:151], v[72:73], v[146:147], v[150:151] op_sel:[0,0,0] op_sel_hi:[0,1,1]
    v_pk_fma_f32 v[150:151], v[72:73], v[146:147], v[150:151] op_sel:[1,1,0] op_sel_hi:[1,0,1] neg_lo:[1,0,0]
    v_pk_fma_f32 v[164:165], v[76:77], v[160:161], v[164:165] op_sel:[0,0,0] op_sel_hi:[0,1,1]
    v_pk_fma_f32 v[164:165], v[76:77], v[160:161], v[164:165] op_sel:[1,1,0] op_sel_hi:[1,0,1] neg_lo:[1,0,0]
    v_pk_fma_f32 v[166:167], v[80:81], v[162:163], v[166:167] op_sel:[0,0,0] op_sel_hi:[0,1,1]
    v_pk_fma_f32 v[166:167], v[80:81], v[162:163], v[166:167] op_sel:[1,1,0] op_sel_hi:[1,0,1] neg_lo:[1,0,0]
    v_pk_fma_f32 v[180:181], v[84:85], v[176:177], v[180:181] op_sel:[0,0,0] op_sel_hi:[0,1,1]
    v_pk_fma_f32 v[180:181], v[84:85], v[176:177], v[180:181] op_sel:[1,1,0] op_sel_hi:[1,0,1] neg_lo:[1,0,0]
    v_pk_fma_f32 v[182:183], v[88:89], v[178:179], v[182:183] op_sel:[0,0,0] op_sel_hi:[0,1,1]
    v_pk_fma_f32 v[182:183], v[88:89], v[178:179], v[182:183] op_sel:[1,1,0] op_sel_hi:[1,0,1] neg_lo:[1,0,0]
    v_pk_fma_f32 v[196:197], v[92:93], v[192:193], v[196:197] op_sel:[0,0,0] op_sel_hi:[0,1,1]
    v_pk_fma_f32 v[196:197], v[92:93], v[192:193], v[196:197] op_sel:[1,1,0] op_sel_hi:[1,0,1] neg_lo:[1,0,0]
    v_pk_fma_f32 v[198:199], v[96:97], v[194:195], v[198:199] op_sel:[0,0,0] op_sel_hi:[0,1,1]
    v_pk_fma_f32 v[198:199], v[96:97], v[194:195], v[198:199] op_sel:[1,1,0] op_sel_hi:[1,0,1] neg_lo:[1,0,0]
    v_pk_fma_f32 v[136:137], v[60:61], v[132:133], v[136:137] op_sel:[0,0,0] op_sel_hi:[0,1,1]
    v_pk_fma_f32 v[136:137], v[60:61], v[132:133], v[136:137] op_sel:[1,1,0] op_sel_hi:[1,0,1] neg_lo:[1,0,0]
    v_pk_fma_f32 v[138:139], v[64:65], v[134:135], v[138:139] op_sel:[0,0,0] op_sel_hi:[0,1,1]
    v_pk_fma_f32 v[138:139], v[64:65], v[134:135], v[138:139] op_sel:[1,1,0] op_sel_hi:[1,0,1] neg_lo:[1,0,0]
    v_pk_fma_f32 v[152:153], v[68:69], v[148:149], v[152:153] op_sel:[0,0,0] op_sel_hi:[0,1,1]
    v_pk_fma_f32 v[152:153], v[68:69], v[148:149], v[152:153] op_sel:[1,1,0] op_sel_hi:[1,0,1] neg_lo:[1,0,0]
    v_pk_fma_f32 v[154:155], v[72:73], v[150:151], v[154:155] op_sel:[0,0,0] op_sel_hi:[0,1,1]
    v_pk_fma_f32 v[154:155], v[72:73], v[150:151], v[154:155] op_sel:[1,1,0] op_sel_hi:[1,0,1] neg_lo:[1,0,0]
    v_pk_fma_f32 v[168:169], v[76:77], v[164:165], v[168:169] op_sel:[0,0,0] op_sel_hi:[0,1,1]
    v_pk_fma_f32 v[168:169], v[76:77], v[164:165], v[168:169] op_sel:[1,1,0] op_sel_hi:[1,0,1] neg_lo:[1,0,0]
    v_pk_fma_f32 v[170:171], v[80:81], v[166:167], v[170:171] op_sel:[0,0,0] op_sel_hi:[0,1,1]
    v_pk_fma_f32 v[170:171], v[80:81], v[166:167], v[170:171] op_sel:[1,1,0] op_sel_hi:[1,0,1] neg_lo:[1,0,0]
    v_pk_fma_f32 v[184:185], v[84:85], v[180:181], v[184:185] op_sel:[0,0,0] op_sel_hi:[0,1,1]
    v_pk_fma_f32 v[184:185], v[84:85], v[180:181], v[184:185] op_sel:[1,1,0] op_sel_hi:[1,0,1] neg_lo:[1,0,0]
    v_pk_fma_f32 v[186:187], v[88:89], v[182:183], v[186:187] op_sel:[0,0,0] op_sel_hi:[0,1,1]
    v_pk_fma_f32 v[186:187], v[88:89], v[182:183], v[186:187] op_sel:[1,1,0] op_sel_hi:[1,0,1] neg_lo:[1,0,0]
    v_pk_fma_f32 v[200:201], v[92:93], v[196:197], v[200:201] op_sel:[0,0,0] op_sel_hi:[0,1,1]
    v_pk_fma_f32 v[200:201], v[92:93], v[196:197], v[200:201] op_sel:[1,1,0] op_sel_hi:[1,0,1] neg_lo:[1,0,0]
    v_pk_fma_f32 v[202:203], v[96:97], v[198:199], v[202:203] op_sel:[0,0,0] op_sel_hi:[0,1,1]
    v_pk_fma_f32 v[202:203], v[96:97], v[198:199], v[202:203] op_sel:[1,1,0] op_sel_hi:[1,0,1] neg_lo:[1,0,0]
    v_pk_fma_f32 v[140:141], v[60:61], v[136:137], v[140:141] op_sel:[0,0,0] op_sel_hi:[0,1,1]
    v_pk_fma_f32 v[140:141], v[60:61], v[136:137], v[140:141] op_sel:[1,1,0] op_sel_hi:[1,0,1] neg_lo:[1,0,0]
    v_pk_fma_f32 v[142:143], v[64:65], v[138:139], v[142:143] op_sel:[0,0,0] op_sel_hi:[0,1,1]
    v_pk_fma_f32 v[142:143], v[64:65], v[138:139], v[142:143] op_sel:[1,1,0] op_sel_hi:[1,0,1] neg_lo:[1,0,0]
    v_pk_fma_f32 v[156:157], v[68:69], v[152:153], v[156:157] op_sel:[0,0,0] op_sel_hi:[0,1,1]
    v_pk_fma_f32 v[156:157], v[68:69], v[152:153], v[156:157] op_sel:[1,1,0] op_sel_hi:[1,0,1] neg_lo:[1,0,0]
    v_pk_fma_f32 v[158:159], v[72:73], v[154:155], v[158:159] op_sel:[0,0,0] op_sel_hi:[0,1,1]
    v_pk_fma_f32 v[158:159], v[72:73], v[154:155], v[158:159] op_sel:[1,1,0] op_sel_hi:[1,0,1] neg_lo:[1,0,0]
    v_pk_fma_f32 v[172:173], v[76:77], v[168:169], v[172:173] op_sel:[0,0,0] op_sel_hi:[0,1,1]
    v_pk_fma_f32 v[172:173], v[76:77], v[168:169], v[172:173] op_sel:[1,1,0] op_sel_hi:[1,0,1] neg_lo:[1,0,0]
    v_pk_fma_f32 v[174:175], v[80:81], v[170:171], v[174:175] op_sel:[0,0,0] op_sel_hi:[0,1,1]
    v_pk_fma_f32 v[174:175], v[80:81], v[170:171], v[174:175] op_sel:[1,1,0] op_sel_hi:[1,0,1] neg_lo:[1,0,0]
    v_pk_fma_f32 v[188:189], v[84:85], v[184:185], v[188:189] op_sel:[0,0,0] op_sel_hi:[0,1,1]
    v_pk_fma_f32 v[188:189], v[84:85], v[184:185], v[188:189] op_sel:[1,1,0] op_sel_hi:[1,0,1] neg_lo:[1,0,0]
    v_pk_fma_f32 v[190:191], v[88:89], v[186:187], v[190:191] op_sel:[0,0,0] op_sel_hi:[0,1,1]
    v_pk_fma_f32 v[190:191], v[88:89], v[186:187], v[190:191] op_sel:[1,1,0] op_sel_hi:[1,0,1] neg_lo:[1,0,0]
    v_pk_fma_f32 v[204:205], v[92:93], v[200:201], v[204:205] op_sel:[0,0,0] op_sel_hi:[0,1,1]
    v_pk_fma_f32 v[204:205], v[92:93], v[200:201], v[204:205] op_sel:[1,1,0] op_sel_hi:[1,0,1] neg_lo:[1,0,0]
    v_pk_fma_f32 v[206:207], v[96:97], v[202:203], v[206:207] op_sel:[0,0,0] op_sel_hi:[0,1,1]
    v_pk_fma_f32 v[206:207], v[96:97], v[202:203], v[206:207] op_sel:[1,1,0] op_sel_hi:[1,0,1] neg_lo:[1,0,0]
    s_cmp_lg_u32 s52, 0
    s_cbranch_scc1 ey1_6
    s_add_u32 s57, s65, 0
    v_cvt_pk_bf16_f32 v32, v128, v129
    v_cvt_pk_bf16_f32 v33, v130, v131
    v_cvt_pk_bf16_f32 v34, v144, v145
    v_cvt_pk_bf16_f32 v35, v146, v147
    buffer_store_dwordx4 v[32:35], v27, s[44:47], s57 offen offset:0 sc1
    v_cvt_pk_bf16_f32 v36, v132, v133
    v_cvt_pk_bf16_f32 v37, v134, v135
    v_cvt_pk_bf16_f32 v38, v148, v149
    v_cvt_pk_bf16_f32 v39, v150, v151
    buffer_store_dwordx4 v[36:39], v27, s[44:47], s57 offen offset:1024 sc1
    v_cvt_pk_bf16_f32 v40, v136, v137
    v_cvt_pk_bf16_f32 v41, v138, v139
    v_cvt_pk_bf16_f32 v42, v152, v153
    v_cvt_pk_bf16_f32 v43, v154, v155
    buffer_store_dwordx4 v[40:43], v27, s[44:47], s57 offen offset:2048 sc1
    v_cvt_pk_bf16_f32 v44, v140, v141
    v_cvt_pk_bf16_f32 v45, v142, v143
    v_cvt_pk_bf16_f32 v46, v156, v157
    v_cvt_pk_bf16_f32 v47, v158, v159
    buffer_store_dwordx4 v[44:47], v27, s[44:47], s57 offen offset:3072 sc1
    s_add_u32 s57, s65, 8192
    v_cvt_pk_bf16_f32 v48, v160, v161
    v_cvt_pk_bf16_f32 v49, v162, v163
    v_cvt_pk_bf16_f32 v50, v176, v177
    v_cvt_pk_bf16_f32 v51, v178, v179
    buffer_store_dwordx4 v[48:51], v27, s[44:47], s57 offen offset:0 sc1
    v_cvt_pk_bf16_f32 v52, v164, v165
    v_cvt_pk_bf16_f32 v53, v166, v167
    v_cvt_pk_bf16_f32 v54, v180, v181
    v_cvt_pk_bf16_f32 v55, v182, v183
    buffer_store_dwordx4 v[52:55], v27, s[44:47], s57 offen offset:1024 sc1
    v_cvt_pk_bf16_f32 v56, v168, v169
    v_cvt_pk_bf16_f32 v57, v170, v171
    v_cvt_pk_bf16_f32 v58, v184, v185
    v_cvt_pk_bf16_f32 v59, v186, v187
    buffer_store_dwordx4 v[56:59], v27, s[44:47], s57 offen offset:2048 sc1
    v_cvt_pk_bf16_f32 v60, v172, v173
    v_cvt_pk_bf16_f32 v61, v174, v175
    v_cvt_pk_bf16_f32 v62, v188, v189
    v_cvt_pk_bf16_f32 v63, v190, v191
    buffer_store_dwordx4 v[60:63], v27, s[44:47], s57 offen offset:3072 sc1
    s_add_u32 s57, s65, 16384
    v_cvt_pk_bf16_f32 v32, v192, v193
    v_cvt_pk_bf16_f32 v33, v194, v195
    buffer_store_dwordx2 v[32:33], v27, s[44:47], s57 offen offset:0 sc1
    v_cvt_pk_bf16_f32 v36, v196, v197
    v_cvt_pk_bf16_f32 v37, v198, v199
    buffer_store_dwordx2 v[36:37], v27, s[44:47], s57 offen offset:1024 sc1
    v_cvt_pk_bf16_f32 v40, v200, v201
    v_cvt_pk_bf16_f32 v41, v202, v203
    buffer_store_dwordx2 v[40:41], v27, s[44:47], s57 offen offset:2048 sc1
    v_cvt_pk_bf16_f32 v44, v204, v205
    v_cvt_pk_bf16_f32 v45, v206, v207
    buffer_store_dwordx2 v[44:45], v27, s[44:47], s57 offen offset:3072 sc1
    s_branch eyx_7
ey1_6:
    s_add_u32 s57, s65, 0
    v_cvt_pk_bf16_f32 v32, v128, v129
    v_cvt_pk_bf16_f32 v33, v130, v131
    buffer_store_dwordx2 v[32:33], v27, s[44:47], s57 offen offset:8 sc1
    v_cvt_pk_bf16_f32 v36, v132, v133
    v_cvt_pk_bf16_f32 v37, v134, v135
    buffer_store_dwordx2 v[36:37], v27, s[44:47], s57 offen offset:1032 sc1
    v_cvt_pk_bf16_f32 v40, v136, v137
    v_cvt_pk_bf16_f32 v41, v138, v139
    buffer_store_dwordx2 v[40:41], v27, s[44:47], s57 offen offset:2056 sc1
    v_cvt_pk_bf16_f32 v44, v140, v141
    v_cvt_pk_bf16_f32 v45, v142, v143
    buffer_store_dwordx2 v[44:45], v27, s[44:47], s57 offen offset:3080 sc1
    s_add_u32 s57, s65, 8192
    v_cvt_pk_bf16_f32 v48, v144, v145
    v_cvt_pk_bf16_f32 v49, v146, v147
    v_cvt_pk_bf16_f32 v50, v160, v161
    v_cvt_pk_bf16_f32 v51, v162, v163
    buffer_store_dwordx4 v[48:51], v27, s[44:47], s57 offen offset:0 sc1
    v_cvt_pk_bf16_f32 v52, v148, v149
    v_cvt_pk_bf16_f32 v53, v150, v151
    v_cvt_pk_bf16_f32 v54, v164, v165
    v_cvt_pk_bf16_f32 v55, v166, v167
    buffer_store_dwordx4 v[52:55], v27, s[44:47], s57 offen offset:1024 sc1
    v_cvt_pk_bf16_f32 v56, v152, v153
    v_cvt_pk_bf16_f32 v57, v154, v155
    v_cvt_pk_bf16_f32 v58, v168, v169
    v_cvt_pk_bf16_f32 v59, v170, v171
    buffer_store_dwordx4 v[56:59], v27, s[44:47], s57 offen offset:2048 sc1
    v_cvt_pk_bf16_f32 v60, v156, v157
    v_cvt_pk_bf16_f32 v61, v158, v159
    v_cvt_pk_bf16_f32 v62, v172, v173
    v_cvt_pk_bf16_f32 v63, v174, v175
    buffer_store_dwordx4 v[60:63], v27, s[44:47], s57 offen offset:3072 sc1
    s_add_u32 s57, s65, 16384
    v_cvt_pk_bf16_f32 v32, v176, v177
    v_cvt_pk_bf16_f32 v33, v178, v179
    v_cvt_pk_bf16_f32 v34, v192, v193
    v_cvt_pk_bf16_f32 v35, v194, v195
    buffer_store_dwordx4 v[32:35], v27, s[44:47], s57 offen offset:0 sc1
    v_cvt_pk_bf16_f32 v36, v180, v181
    v_cvt_pk_bf16_f32 v37, v182, v183
    v_cvt_pk_bf16_f32 v38, v196, v197
    v_cvt_pk_bf16_f32 v39, v198, v199
    buffer_store_dwordx4 v[36:39], v27, s[44:47], s57 offen offset:1024 sc1
    v_cvt_pk_bf16_f32 v40, v184, v185
    v_cvt_pk_bf16_f32 v41, v186, v187
    v_cvt_pk_bf16_f32 v42, v200, v201
    v_cvt_pk_bf16_f32 v43, v202, v203
    buffer_store_dwordx4 v[40:43], v27, s[44:47], s57 offen offset:2048 sc1
    v_cvt_pk_bf16_f32 v44, v188, v189
    v_cvt_pk_bf16_f32 v45, v190, v191
    v_cvt_pk_bf16_f32 v46, v204, v205
    v_cvt_pk_bf16_f32 v47, v206, v207
    buffer_store_dwordx4 v[44:47], v27, s[44:47], s57 offen offset:3072 sc1
eyx_7:
    s_branch p2_comp
k1_cF:
    v_lshrrev_b32 v17, 2, v6
    v_lshl_add_u32 v17, v5, 3, v17
    v_mul_u32_u24 v17, 448, v17
    v_and_b32 v18, 3, v6
    v_lshl_add_u32 v17, v18, 3, v17
    s_mul_i32 s57, s52, 224
    s_add_u32 s57, s57, 10240
    v_add_u32 v17, s57, v17
    v_and_b32 v18, 1, v5
    v_lshlrev_b32 v18, 5, v18
    v_add_u32 v19, v17, v18
    v_sub_u32 v17, v17, v18
    s_cmp_eq_u32 s52, 0
    s_cselect_b64 vcc, -1, 0
    v_cndmask_b32 v240, v17, v19, vcc
    v_cndmask_b32 v241, v19, v17, vcc
    v_and_b32 v18, 7, v0
    v_xor_b32 v18, v18, v5
    v_lshlrev_b32 v17, 7, v6
    s_lshl_b32 s57, s53, 13
    s_add_u32 s57, s57, 38912
    v_add_u32 v17, s57, v17
    v_lshl_add_u32 v246, v18, 4, v17
    v_xor_b32 v247, 64, v246
    v_add_u32 v242, 45056, v240
    v_add_u32 v248, 45056, v246
    v_add_u32 v243, 45056, v241
    v_add_u32 v249, 45056, v247
    v_add_u32 v244, 90112, v240
    v_add_u32 v250, 90112, v246
    v_add_u32 v245, 90112, v241
    v_add_u32 v251, 90112, v247
    v_mov_b32 v128, 0
    v_mov_b32 v129, 0
    v_mov_b32 v130, 0
    v_mov_b32 v131, 0
    v_mov_b32 v132, 0
    v_mov_b32 v133, 0
    v_mov_b32 v134, 0
    v_mov_b32 v135, 0
    v_mov_b32 v136, 0
    v_mov_b32 v137, 0
    v_mov_b32 v138, 0
    v_mov_b32 v139, 0
    v_mov_b32 v140, 0
    v_mov_b32 v141, 0
    v_mov_b32 v142, 0
    v_mov_b32 v143, 0
    v_mov_b32 v144, 0
    v_mov_b32 v145, 0
    v_mov_b32 v146, 0
    v_mov_b32 v147, 0
    v_mov_b32 v148, 0
    v_mov_b32 v149, 0
    v_mov_b32 v150, 0
    v_mov_b32 v151, 0
    v_mov_b32 v152, 0
    v_mov_b32 v153, 0
    v_mov_b32 v154, 0
    v_mov_b32 v155, 0
    v_mov_b32 v156, 0
    v_mov_b32 v157, 0
    v_mov_b32 v158, 0
    v_mov_b32 v159, 0
    v_mov_b32 v160, 0
    v_mov_b32 v161, 0
    v_mov_b32 v162, 0
    v_mov_b32 v163, 0
    v_mov_b32 v164, 0
    v_mov_b32 v165, 0
    v_mov_b32 v166, 0
    v_mov_b32 v167, 0
    v_mov_b32 v168, 0
    v_mov_b32 v169, 0
    v_mov_b32 v170, 0
    v_mov_b32 v171, 0
    v_mov_b32 v172, 0
    v_mov_b32 v173, 0
    v_mov_b32 v174, 0
    v_mov_b32 v175, 0
    v_mov_b32 v176, 0
    v_mov_b32 v177, 0
    v_mov_b32 v178, 0
    v_mov_b32 v179, 0
    v_mov_b32 v180, 0
    v_mov_b32 v181, 0
    v_mov_b32 v182, 0
    v_mov_b32 v183, 0
    v_mov_b32 v184, 0
    v_mov_b32 v185, 0
    v_mov_b32 v186, 0
    v_mov_b32 v187, 0
    v_mov_b32 v188, 0
    v_mov_b32 v189, 0
    v_mov_b32 v190, 0
    v_mov_b32 v191, 0
    v_mov_b32 v192, 0
    v_mov_b32 v193, 0
    v_mov_b32 v194, 0
    v_mov_b32 v195, 0
    v_mov_b32 v196, 0
    v_mov_b32 v197, 0
    v_mov_b32 v198, 0
    v_mov_b32 v199, 0
    v_mov_b32 v200, 0
    v_mov_b32 v201, 0
    v_mov_b32 v202, 0
    v_mov_b32 v203, 0
    v_mov_b32 v204, 0
    v_mov_b32 v205, 0
    v_mov_b32 v206, 0
    v_mov_b32 v207, 0
    v_mov_b32 v208, 0
    v_mov_b32 v209, 0
    v_mov_b32 v210, 0
    v_mov_b32 v211, 0
    v_mov_b32 v212, 0
    v_mov_b32 v213, 0
    v_mov_b32 v214, 0
    v_mov_b32 v215, 0
    v_mov_b32 v216, 0
    v_mov_b32 v217, 0
    v_mov_b32 v218, 0
    v_mov_b32 v219, 0
    v_mov_b32 v220, 0
    v_mov_b32 v221, 0
    v_mov_b32 v222, 0
    v_mov_b32 v223, 0
    v_mov_b32 v224, 0
    v_mov_b32 v225, 0
    v_mov_b32 v226, 0
    v_mov_b32 v227, 0
    v_mov_b32 v228, 0
    v_mov_b32 v229, 0
    v_mov_b32 v230, 0
    v_mov_b32 v231, 0
    v_mov_b32 v232, 0
    v_mov_b32 v233, 0
    v_mov_b32 v234, 0
    v_mov_b32 v235, 0
    v_mov_b32 v236, 0
    v_mov_b32 v237, 0
    v_mov_b32 v238, 0
    v_mov_b32 v239, 0
    s_setprio 2
    v_mov_b32 v15, 2147483632
    v_mov_b32 v26, 0
    v_lshlrev_b32 v2, 2, v0
    v_lshlrev_b32 v13, 4, v0
    v_cmp_gt_u32 vcc, 56, v1
    s_nop 1
    v_cndmask_b32 v12, v15, v13, vcc
    s_mul_i32 s57, s50, 1792
    s_mul_i32 s58, s51, 224
    s_add_u32 s57, s57, s58
    s_lshl_b32 s57, s57, 2
    s_add_u32 s62, s57, 655360
    s_lshl_b32 s59, s51, 4
    s_lshl_b32 s58, s50, 7
    s_add_u32 s59, s59, s58
    s_lshl_b32 s58, s48, 2
    s_add_u32 s63, s59, s58
    s_mul_i32 s59, s63, 1280
    s_barrier
    buffer_load_dword v80, v2, s[36:39], s59 offen offset:0
    buffer_load_dword v81, v2, s[36:39], s59 offen offset:256
    buffer_load_dword v82, v2, s[36:39], s59 offen offset:512
    buffer_load_dword v83, v2, s[36:39], s59 offen offset:768
    buffer_load_dword v84, v2, s[36:39], s59 offen offset:1024
    s_add_u32 s59, s59, 1280
    buffer_load_dword v85, v2, s[36:39], s59 offen offset:0
    buffer_load_dword v86, v2, s[36:39], s59 offen offset:256
    buffer_load_dword v87, v2, s[36:39], s59 offen offset:512
    buffer_load_dword v88, v2, s[36:39], s59 offen offset:768
    buffer_load_dword v89, v2, s[36:39], s59 offen offset:1024
    s_add_u32 s59, s59, 1280
    buffer_load_dword v90, v2, s[36:39], s59 offen offset:0
    buffer_load_dword v91, v2, s[36:39], s59 offen offset:256
    buffer_load_dword v92, v2, s[36:39], s59 offen offset:512
    buffer_load_dword v93, v2, s[36:39], s59 offen offset:768
    buffer_load_dword v94, v2, s[36:39], s59 offen offset:1024
    s_add_u32 s59, s59, 1280
    buffer_load_dword v95, v2, s[36:39], s59 offen offset:0
    buffer_load_dword v96, v2, s[36:39], s59 offen offset:256
    buffer_load_dword v97, v2, s[36:39], s59 offen offset:512
    buffer_load_dword v98, v2, s[36:39], s59 offen offset:768
    buffer_load_dword v99, v2, s[36:39], s59 offen offset:1024
    s_add_u32 s59, s59, 1280
    global_load_dwordx2 v[28:29], v26, s[30:31] sc1
    s_waitcnt vmcnt(11)
    v_lshlrev_b32 v40, 16, v80
    v_and_b32 v41, 0xffff0000, v80
    v_lshlrev_b32 v42, 16, v81
    v_and_b32 v43, 0xffff0000, v81
    v_lshlrev_b32 v44, 16, v82
    v_and_b32 v45, 0xffff0000, v82
    v_lshlrev_b32 v46, 16, v83
    v_and_b32 v47, 0xffff0000, v83
    v_lshlrev_b32 v48, 16, v84
    v_and_b32 v49, 0xffff0000, v84
    v_lshlrev_b32 v50, 16, v85
    v_and_b32 v51, 0xffff0000, v85
    v_lshlrev_b32 v52, 16, v86
    v_and_b32 v53, 0xffff0000, v86
    v_lshlrev_b32 v54, 16, v87
    v_and_b32 v55, 0xffff0000, v87
    v_lshlrev_b32 v56, 16, v88
    v_and_b32 v57, 0xffff0000, v88
    v_lshlrev_b32 v58, 16, v89
    v_and_b32 v59, 0xffff0000, v89
    v_add_f32 v60, v40, v41
    v_add_f32 v60, v60, v42
    v_add_f32 v60, v60, v43
    v_add_f32 v60, v60, v44
    v_add_f32 v60, v60, v45
    v_add_f32 v60, v60, v46
    v_add_f32 v60, v60, v47
    v_add_f32 v60, v60, v48
    v_add_f32 v60, v60, v49
    v_add_f32 v61, v50, v51
    v_add_f32 v61, v61, v52
    v_add_f32 v61, v61, v53
    v_add_f32 v61, v61, v54
    v_add_f32 v61, v61, v55
    v_add_f32 v61, v61, v56
    v_add_f32 v61, v61, v57
    v_add_f32 v61, v61, v58
    v_add_f32 v61, v61, v59
    v_add_f32_dpp v60, v60, v60 row_shr:1 row_mask:0xf bank_mask:0xf bound_ctrl:0
    s_nop 0
    v_add_f32_dpp v61, v61, v61 row_shr:1 row_mask:0xf bank_mask:0xf bound_ctrl:0
    v_add_f32_dpp v60, v60, v60 row_shr:2 row_mask:0xf bank_mask:0xf bound_ctrl:0
    s_nop 0
    v_add_f32_dpp v61, v61, v61 row_shr:2 row_mask:0xf bank_mask:0xf bound_ctrl:0
    v_add_f32_dpp v60, v60, v60 row_shr:4 row_mask:0xf bank_mask:0xf bound_ctrl:0
    s_nop 0
    v_add_f32_dpp v61, v61, v61 row_shr:4 row_mask:0xf bank_mask:0xf bound_ctrl:0
    v_add_f32_dpp v60, v60, v60 row_shr:8 row_mask:0xf bank_mask:0xf bound_ctrl:0
    s_nop 0
    v_add_f32_dpp v61, v61, v61 row_shr:8 row_mask:0xf bank_mask:0xf bound_ctrl:0
    v_add_f32_dpp v60, v60, v60 row_bcast:15 row_mask:0xa bank_mask:0xf
    s_nop 0
    v_add_f32_dpp v61, v61, v61 row_bcast:15 row_mask:0xa bank_mask:0xf
    v_add_f32_dpp v60, v60, v60 row_bcast:31 row_mask:0xc bank_mask:0xf
    s_nop 0
    v_add_f32_dpp v61, v61, v61 row_bcast:31 row_mask:0xc bank_mask:0xf
    v_readlane_b32 s57, v60, 63
    v_readlane_b32 s58, v61, 63
    v_mov_b32 v62, 0x3acccccd
    v_mul_f32 v60, s57, v62
    v_mul_f32 v61, s58, v62
    v_sub_f32 v40, v40, v60
    v_sub_f32 v41, v41, v60
    v_sub_f32 v42, v42, v60
    v_sub_f32 v43, v43, v60
    v_sub_f32 v44, v44, v60
    v_sub_f32 v45, v45, v60
    v_sub_f32 v46, v46, v60
    v_sub_f32 v47, v47, v60
    v_sub_f32 v48, v48, v60
    v_sub_f32 v49, v49, v60
    v_sub_f32 v50, v50, v61
    v_sub_f32 v51, v51, v61
    v_sub_f32 v52, v52, v61
    v_sub_f32 v53, v53, v61
    v_sub_f32 v54, v54, v61
    v_sub_f32 v55, v55, v61
    v_sub_f32 v56, v56, v61
    v_sub_f32 v57, v57, v61
    v_sub_f32 v58, v58, v61
    v_sub_f32 v59, v59, v61
    v_mul_f32 v64, v40, v40
    v_fmac_f32 v64, v41, v41
    v_fmac_f32 v64, v42, v42
    v_fmac_f32 v64, v43, v43
    v_fmac_f32 v64, v44, v44
    v_fmac_f32 v64, v45, v45
    v_fmac_f32 v64, v46, v46
    v_fmac_f32 v64, v47, v47
    v_fmac_f32 v64, v48, v48
    v_fmac_f32 v64, v49, v49
    v_mul_f32 v65, v50, v50
    v_fmac_f32 v65, v51, v51
    v_fmac_f32 v65, v52, v52
    v_fmac_f32 v65, v53, v53
    v_fmac_f32 v65, v54, v54
    v_fmac_f32 v65, v55, v55
    v_fmac_f32 v65, v56, v56
    v_fmac_f32 v65, v57, v57
    v_fmac_f32 v65, v58, v58
    v_fmac_f32 v65, v59, v59
    v_add_f32_dpp v64, v64, v64 row_shr:1 row_mask:0xf bank_mask:0xf bound_ctrl:0
    s_nop 0
    v_add_f32_dpp v65, v65, v65 row_shr:1 row_mask:0xf bank_mask:0xf bound_ctrl:0
    v_add_f32_dpp v64, v64, v64 row_shr:2 row_mask:0xf bank_mask:0xf bound_ctrl:0
    s_nop 0
    v_add_f32_dpp v65, v65, v65 row_shr:2 row_mask:0xf bank_mask:0xf bound_ctrl:0
    v_add_f32_dpp v64, v64, v64 row_shr:4 row_mask:0xf bank_mask:0xf bound_ctrl:0
    s_nop 0
    v_add_f32_dpp v65, v65, v65 row_shr:4 row_mask:0xf bank_mask:0xf bound_ctrl:0
    v_add_f32_dpp v64, v64, v64 row_shr:8 row_mask:0xf bank_mask:0xf bound_ctrl:0
    s_nop 0
    v_add_f32_dpp v65, v65, v65 row_shr:8 row_mask:0xf bank_mask:0xf bound_ctrl:0
    v_add_f32_dpp v64, v64, v64 row_bcast:15 row_mask:0xa bank_mask:0xf
    s_nop 0
    v_add_f32_dpp v65, v65, v65 row_bcast:15 row_mask:0xa bank_mask:0xf
    v_add_f32_dpp v64, v64, v64 row_bcast:31 row_mask:0xc bank_mask:0xf
    s_nop 0
    v_add_f32_dpp v65, v65, v65 row_bcast:31 row_mask:0xc bank_mask:0xf
    v_readlane_b32 s57, v64, 63
    v_readlane_b32 s58, v65, 63
    s_nop 0
    v_mul_f32 v64, s57, v62
    v_mul_f32 v65, s58, v62
    v_and_b32 v66, 1, v0
    v_cmp_eq_u32 vcc, 1, v66
    s_nop 1
    v_cndmask_b32 v68, v60, v61, vcc
    v_cndmask_b32 v70, v64, v65, vcc
    v_cvt_pk_bf16_f32 v68, v68, v68
    v_lshlrev_b32 v68, 16, v68
    v_cvt_pk_bf16_f32 v70, v70, v70
    v_lshlrev_b32 v70, 16, v70
    v_add_f32 v70, 0x3727c5ac, v70
    v_cvt_pk_bf16_f32 v70, v70, v70
    v_lshlrev_b32 v70, 16, v70
    v_sqrt_f32 v70, v70
    s_nop 0
    v_cvt_pk_bf16_f32 v70, v70, v70
    v_lshlrev_b32 v70, 16, v70
    v_rcp_f32 v69, v70
    s_nop 0
    v_fma_f32 v71, -v70, v69, 1.0
    v_fma_f32 v69, v71, v69, v69
    v_mov_b32 v71, 0
    v_lshlrev_b32 v66, 4, v0
    v_mov_b32 v67, 2147483632
    v_cmp_gt_u32 vcc, 2, v0
    s_nop 1
    v_cndmask_b32 v66, v67, v66, vcc
    s_lshl_b32 s57, s63, 4
    s_add_u32 s57, s57, 0
    buffer_store_dwordx4 v[68:71], v66, s[44:47], s57 offen sc1
    s_add_u32 s63, s63, 2
    s_waitcnt vmcnt(2)
    v_lshlrev_b32 v40, 16, v90
    v_and_b32 v41, 0xffff0000, v90
    v_lshlrev_b32 v42, 16, v91
    v_and_b32 v43, 0xffff0000, v91
    v_lshlrev_b32 v44, 16, v92
    v_and_b32 v45, 0xffff0000, v92
    v_lshlrev_b32 v46, 16, v93
    v_and_b32 v47, 0xffff0000, v93
    v_lshlrev_b32 v48, 16, v94
    v_and_b32 v49, 0xffff0000, v94
    v_lshlrev_b32 v50, 16, v95
    v_and_b32 v51, 0xffff0000, v95
    v_lshlrev_b32 v52, 16, v96
    v_and_b32 v53, 0xffff0000, v96
    v_lshlrev_b32 v54, 16, v97
    v_and_b32 v55, 0xffff0000, v97
    v_lshlrev_b32 v56, 16, v98
    v_and_b32 v57, 0xffff0000, v98
    v_lshlrev_b32 v58, 16, v99
    v_and_b32 v59, 0xffff0000, v99
    v_add_f32 v60, v40, v41
    v_add_f32 v60, v60, v42
    v_add_f32 v60, v60, v43
    v_add_f32 v60, v60, v44
    v_add_f32 v60, v60, v45
    v_add_f32 v60, v60, v46
    v_add_f32 v60, v60, v47
    v_add_f32 v60, v60, v48
    v_add_f32 v60, v60, v49
    v_add_f32 v61, v50, v51
    v_add_f32 v61, v61, v52
    v_add_f32 v61, v61, v53
    v_add_f32 v61, v61, v54
    v_add_f32 v61, v61, v55
    v_add_f32 v61, v61, v56
    v_add_f32 v61, v61, v57
    v_add_f32 v61, v61, v58
    v_add_f32 v61, v61, v59
    v_add_f32_dpp v60, v60, v60 row_shr:1 row_mask:0xf bank_mask:0xf bound_ctrl:0
    s_nop 0
    v_add_f32_dpp v61, v61, v61 row_shr:1 row_mask:0xf bank_mask:0xf bound_ctrl:0
    v_add_f32_dpp v60, v60, v60 row_shr:2 row_mask:0xf bank_mask:0xf bound_ctrl:0
    s_nop 0
    v_add_f32_dpp v61, v61, v61 row_shr:2 row_mask:0xf bank_mask:0xf bound_ctrl:0
    v_add_f32_dpp v60, v60, v60 row_shr:4 row_mask:0xf bank_mask:0xf bound_ctrl:0
    s_nop 0
    v_add_f32_dpp v61, v61, v61 row_shr:4 row_mask:0xf bank_mask:0xf bound_ctrl:0
    v_add_f32_dpp v60, v60, v60 row_shr:8 row_mask:0xf bank_mask:0xf bound_ctrl:0
    s_nop 0
    v_add_f32_dpp v61, v61, v61 row_shr:8 row_mask:0xf bank_mask:0xf bound_ctrl:0
    v_add_f32_dpp v60, v60, v60 row_bcast:15 row_mask:0xa bank_mask:0xf
    s_nop 0
    v_add_f32_dpp v61, v61, v61 row_bcast:15 row_mask:0xa bank_mask:0xf
    v_add_f32_dpp v60, v60, v60 row_bcast:31 row_mask:0xc bank_mask:0xf
    s_nop 0
    v_add_f32_dpp v61, v61, v61 row_bcast:31 row_mask:0xc bank_mask:0xf
    v_readlane_b32 s57, v60, 63
    v_readlane_b32 s58, v61, 63
    v_mov_b32 v62, 0x3acccccd
    v_mul_f32 v60, s57, v62
    v_mul_f32 v61, s58, v62
    v_sub_f32 v40, v40, v60
    v_sub_f32 v41, v41, v60
    v_sub_f32 v42, v42, v60
    v_sub_f32 v43, v43, v60
    v_sub_f32 v44, v44, v60
    v_sub_f32 v45, v45, v60
    v_sub_f32 v46, v46, v60
    v_sub_f32 v47, v47, v60
    v_sub_f32 v48, v48, v60
    v_sub_f32 v49, v49, v60
    v_sub_f32 v50, v50, v61
    v_sub_f32 v51, v51, v61
    v_sub_f32 v52, v52, v61
    v_sub_f32 v53, v53, v61
    v_sub_f32 v54, v54, v61
    v_sub_f32 v55, v55, v61
    v_sub_f32 v56, v56, v61
    v_sub_f32 v57, v57, v61
    v_sub_f32 v58, v58, v61
    v_sub_f32 v59, v59, v61
    v_mul_f32 v64, v40, v40
    v_fmac_f32 v64, v41, v41
    v_fmac_f32 v64, v42, v42
    v_fmac_f32 v64, v43, v43
    v_fmac_f32 v64, v44, v44
    v_fmac_f32 v64, v45, v45
    v_fmac_f32 v64, v46, v46
    v_fmac_f32 v64, v47, v47
    v_fmac_f32 v64, v48, v48
    v_fmac_f32 v64, v49, v49
    v_mul_f32 v65, v50, v50
    v_fmac_f32 v65, v51, v51
    v_fmac_f32 v65, v52, v52
    v_fmac_f32 v65, v53, v53
    v_fmac_f32 v65, v54, v54
    v_fmac_f32 v65, v55, v55
    v_fmac_f32 v65, v56, v56
    v_fmac_f32 v65, v57, v57
    v_fmac_f32 v65, v58, v58
    v_fmac_f32 v65, v59, v59
    v_add_f32_dpp v64, v64, v64 row_shr:1 row_mask:0xf bank_mask:0xf bound_ctrl:0
    s_nop 0
    v_add_f32_dpp v65, v65, v65 row_shr:1 row_mask:0xf bank_mask:0xf bound_ctrl:0
    v_add_f32_dpp v64, v64, v64 row_shr:2 row_mask:0xf bank_mask:0xf bound_ctrl:0
    s_nop 0
    v_add_f32_dpp v65, v65, v65 row_shr:2 row_mask:0xf bank_mask:0xf bound_ctrl:0
    v_add_f32_dpp v64, v64, v64 row_shr:4 row_mask:0xf bank_mask:0xf bound_ctrl:0
    s_nop 0
    v_add_f32_dpp v65, v65, v65 row_shr:4 row_mask:0xf bank_mask:0xf bound_ctrl:0
    v_add_f32_dpp v64, v64, v64 row_shr:8 row_mask:0xf bank_mask:0xf bound_ctrl:0
    s_nop 0
    v_add_f32_dpp v65, v65, v65 row_shr:8 row_mask:0xf bank_mask:0xf bound_ctrl:0
    v_add_f32_dpp v64, v64, v64 row_bcast:15 row_mask:0xa bank_mask:0xf
    s_nop 0
    v_add_f32_dpp v65, v65, v65 row_bcast:15 row_mask:0xa bank_mask:0xf
    v_add_f32_dpp v64, v64, v64 row_bcast:31 row_mask:0xc bank_mask:0xf
    s_nop 0
    v_add_f32_dpp v65, v65, v65 row_bcast:31 row_mask:0xc bank_mask:0xf
    v_readlane_b32 s57, v64, 63
    v_readlane_b32 s58, v65, 63
    s_nop 0
    v_mul_f32 v64, s57, v62
    v_mul_f32 v65, s58, v62
    v_and_b32 v66, 1, v0
    v_cmp_eq_u32 vcc, 1, v66
    s_nop 1
    v_cndmask_b32 v68, v60, v61, vcc
    v_cndmask_b32 v70, v64, v65, vcc
    v_cvt_pk_bf16_f32 v68, v68, v68
    v_lshlrev_b32 v68, 16, v68
    v_cvt_pk_bf16_f32 v70, v70, v70
    v_lshlrev_b32 v70, 16, v70
    v_add_f32 v70, 0x3727c5ac, v70
    v_cvt_pk_bf16_f32 v70, v70, v70
    v_lshlrev_b32 v70, 16, v70
    v_sqrt_f32 v70, v70
    s_nop 0
    v_cvt_pk_bf16_f32 v70, v70, v70
    v_lshlrev_b32 v70, 16, v70
    v_rcp_f32 v69, v70
    s_nop 0
    v_fma_f32 v71, -v70, v69, 1.0
    v_fma_f32 v69, v71, v69, v69
    v_mov_b32 v71, 0
    v_lshlrev_b32 v66, 4, v0
    v_mov_b32 v67, 2147483632
    v_cmp_gt_u32 vcc, 2, v0
    s_nop 1
    v_cndmask_b32 v66, v67, v66, vcc
    s_lshl_b32 s57, s63, 4
    s_add_u32 s57, s57, 0
    buffer_store_dwordx4 v[68:71], v66, s[44:47], s57 offen sc1
    s_waitcnt lgkmcnt(0)
    v_cmp_eq_u32 vcc, 0, v0
    s_nop 1
    v_cndmask_b32 v16, v15, v26, vcc
    s_lshl_b32 s57, s49, 7
    s_lshl_b32 s58, s50, 3
    s_add_u32 s57, s57, s58
    s_add_u32 s57, s57, s51
    s_lshl_b32 s57, s57, 7
    s_lshl_b32 s58, s48, 3
    s_add_u32 s57, s57, s58
    s_add_u32 s76, s57, 950272
    s_barrier
    ds_read_b128 v[60:63], v246 offset:0
    ds_read_b128 v[64:67], v246 offset:2048
    ds_read_b128 v[68:71], v246 offset:4096
    ds_read_b128 v[72:75], v246 offset:6144
    ds_read_b64_tr_b16 v[32:33], v240 offset:0
    ds_read_b64_tr_b16 v[34:35], v240 offset:1792
    ds_read_b64_tr_b16 v[36:37], v241 offset:32
    ds_read_b64_tr_b16 v[38:39], v241 offset:1824
    ds_read_b64_tr_b16 v[40:41], v240 offset:64
    ds_read_b64_tr_b16 v[42:43], v240 offset:1856
    ds_read_b64_tr_b16 v[44:45], v241 offset:96
    ds_read_b64_tr_b16 v[46:47], v241 offset:1888
    ds_read_b64_tr_b16 v[48:49], v240 offset:128
    ds_read_b64_tr_b16 v[50:51], v240 offset:1920
    ds_read_b64_tr_b16 v[52:53], v241 offset:160
    ds_read_b64_tr_b16 v[54:55], v241 offset:1952
    ds_read_b64_tr_b16 v[56:57], v240 offset:192
    ds_read_b64_tr_b16 v[58:59], v240 offset:1984
    s_waitcnt lgkmcnt(0)
    v_mfma_f32_16x16x32_bf16 v[128:131], v[32:35], v[60:63], v[128:131]
    ds_read_b128 v[104:107], v247 offset:0
    v_mfma_f32_16x16x32_bf16 v[132:135], v[32:35], v[64:67], v[132:135]
    ds_read_b128 v[108:111], v247 offset:2048
    v_mfma_f32_16x16x32_bf16 v[136:139], v[32:35], v[68:71], v[136:139]
    ds_read_b128 v[112:115], v247 offset:4096
    v_mfma_f32_16x16x32_bf16 v[140:143], v[32:35], v[72:75], v[140:143]
    ds_read_b128 v[116:119], v247 offset:6144
    v_mfma_f32_16x16x32_bf16 v[144:147], v[36:39], v[60:63], v[144:147]
    ds_read_b64_tr_b16 v[76:77], v240 offset:14336
    v_mfma_f32_16x16x32_bf16 v[148:151], v[36:39], v[64:67], v[148:151]
    ds_read_b64_tr_b16 v[78:79], v240 offset:16128
    v_mfma_f32_16x16x32_bf16 v[152:155], v[36:39], v[68:71], v[152:155]
    ds_read_b64_tr_b16 v[80:81], v241 offset:14368
    v_mfma_f32_16x16x32_bf16 v[156:159], v[36:39], v[72:75], v[156:159]
    ds_read_b64_tr_b16 v[82:83], v241 offset:16160
    v_mfma_f32_16x16x32_bf16 v[160:163], v[40:43], v[60:63], v[160:163]
    ds_read_b64_tr_b16 v[84:85], v240 offset:14400
    v_mfma_f32_16x16x32_bf16 v[164:167], v[40:43], v[64:67], v[164:167]
    ds_read_b64_tr_b16 v[86:87], v240 offset:16192
    v_mfma_f32_16x16x32_bf16 v[168:171], v[40:43], v[68:71], v[168:171]
    ds_read_b64_tr_b16 v[88:89], v241 offset:14432
    v_mfma_f32_16x16x32_bf16 v[172:175], v[40:43], v[72:75], v[172:175]
    ds_read_b64_tr_b16 v[90:91], v241 offset:16224
    v_mfma_f32_16x16x32_bf16 v[176:179], v[44:47], v[60:63], v[176:179]
    ds_read_b64_tr_b16 v[92:93], v240 offset:14464
    v_mfma_f32_16x16x32_bf16 v[180:183], v[44:47], v[64:67], v[180:183]
    ds_read_b64_tr_b16 v[94:95], v240 offset:16256
    v_mfma_f32_16x16x32_bf16 v[184:187], v[44:47], v[68:71], v[184:187]
    ds_read_b64_tr_b16 v[96:97], v241 offset:14496
    v_mfma_f32_16x16x32_bf16 v[188:191], v[44:47], v[72:75], v[188:191]
    ds_read_b64_tr_b16 v[98:99], v241 offset:16288
    v_mfma_f32_16x16x32_bf16 v[192:195], v[48:51], v[60:63], v[192:195]
    ds_read_b64_tr_b16 v[100:101], v240 offset:14528
    v_mfma_f32_16x16x32_bf16 v[196:199], v[48:51], v[64:67], v[196:199]
    ds_read_b64_tr_b16 v[102:103], v240 offset:16320
    v_mfma_f32_16x16x32_bf16 v[200:203], v[48:51], v[68:71], v[200:203]
    v_mfma_f32_16x16x32_bf16 v[204:207], v[48:51], v[72:75], v[204:207]
    v_mfma_f32_16x16x32_bf16 v[208:211], v[52:55], v[60:63], v[208:211]
    v_mfma_f32_16x16x32_bf16 v[212:215], v[52:55], v[64:67], v[212:215]
    v_mfma_f32_16x16x32_bf16 v[216:219], v[52:55], v[68:71], v[216:219]
    v_mfma_f32_16x16x32_bf16 v[220:223], v[52:55], v[72:75], v[220:223]
    v_mfma_f32_16x16x32_bf16 v[224:227], v[56:59], v[60:63], v[224:227]
    v_mfma_f32_16x16x32_bf16 v[228:231], v[56:59], v[64:67], v[228:231]
    v_mfma_f32_16x16x32_bf16 v[232:235], v[56:59], v[68:71], v[232:235]
    v_mfma_f32_16x16x32_bf16 v[236:239], v[56:59], v[72:75], v[236:239]
    s_waitcnt lgkmcnt(0)
    v_mfma_f32_16x16x32_bf16 v[128:131], v[76:79], v[104:107], v[128:131]
    v_mfma_f32_16x16x32_bf16 v[132:135], v[76:79], v[108:111], v[132:135]
    v_mfma_f32_16x16x32_bf16 v[136:139], v[76:79], v[112:115], v[136:139]
    s_barrier
    ds_read_b128 v[60:63], v248 offset:0
    v_mfma_f32_16x16x32_bf16 v[140:143], v[76:79], v[116:119], v[140:143]
    ds_read_b128 v[64:67], v248 offset:2048
    v_mfma_f32_16x16x32_bf16 v[144:147], v[80:83], v[104:107], v[144:147]
    ds_read_b128 v[68:71], v248 offset:4096
    v_mfma_f32_16x16x32_bf16 v[148:151], v[80:83], v[108:111], v[148:151]
    ds_read_b128 v[72:75], v248 offset:6144
    v_mfma_f32_16x16x32_bf16 v[152:155], v[80:83], v[112:115], v[152:155]
    ds_read_b64_tr_b16 v[32:33], v242 offset:0
    v_mfma_f32_16x16x32_bf16 v[156:159], v[80:83], v[116:119], v[156:159]
    ds_read_b64_tr_b16 v[34:35], v242 offset:1792
    v_mfma_f32_16x16x32_bf16 v[160:163], v[84:87], v[104:107], v[160:163]
    ds_read_b64_tr_b16 v[36:37], v243 offset:32
    v_mfma_f32_16x16x32_bf16 v[164:167], v[84:87], v[108:111], v[164:167]
    ds_read_b64_tr_b16 v[38:39], v243 offset:1824
    v_mfma_f32_16x16x32_bf16 v[168:171], v[84:87], v[112:115], v[168:171]
    ds_read_b64_tr_b16 v[40:41], v242 offset:64
    v_mfma_f32_16x16x32_bf16 v[172:175], v[84:87], v[116:119], v[172:175]
    ds_read_b64_tr_b16 v[42:43], v242 offset:1856
    v_mfma_f32_16x16x32_bf16 v[176:179], v[88:91], v[104:107], v[176:179]
    ds_read_b64_tr_b16 v[44:45], v243 offset:96
    v_mfma_f32_16x16x32_bf16 v[180:183], v[88:91], v[108:111], v[180:183]
    ds_read_b64_tr_b16 v[46:47], v243 offset:1888
    v_mfma_f32_16x16x32_bf16 v[184:187], v[88:91], v[112:115], v[184:187]
    ds_read_b64_tr_b16 v[48:49], v242 offset:128
    v_mfma_f32_16x16x32_bf16 v[188:191], v[88:91], v[116:119], v[188:191]
    ds_read_b64_tr_b16 v[50:51], v242 offset:1920
    v_mfma_f32_16x16x32_bf16 v[192:195], v[92:95], v[104:107], v[192:195]
    ds_read_b64_tr_b16 v[52:53], v243 offset:160
    v_mfma_f32_16x16x32_bf16 v[196:199], v[92:95], v[108:111], v[196:199]
    ds_read_b64_tr_b16 v[54:55], v243 offset:1952
    v_mfma_f32_16x16x32_bf16 v[200:203], v[92:95], v[112:115], v[200:203]
    ds_read_b64_tr_b16 v[56:57], v242 offset:192
    v_mfma_f32_16x16x32_bf16 v[204:207], v[92:95], v[116:119], v[204:207]
    ds_read_b64_tr_b16 v[58:59], v242 offset:1984
    v_mfma_f32_16x16x32_bf16 v[208:211], v[96:99], v[104:107], v[208:211]
    v_mfma_f32_16x16x32_bf16 v[212:215], v[96:99], v[108:111], v[212:215]
    v_mfma_f32_16x16x32_bf16 v[216:219], v[96:99], v[112:115], v[216:219]
    v_mfma_f32_16x16x32_bf16 v[220:223], v[96:99], v[116:119], v[220:223]
    v_mfma_f32_16x16x32_bf16 v[224:227], v[100:103], v[104:107], v[224:227]
    v_mfma_f32_16x16x32_bf16 v[228:231], v[100:103], v[108:111], v[228:231]
    v_mfma_f32_16x16x32_bf16 v[232:235], v[100:103], v[112:115], v[232:235]
    v_mfma_f32_16x16x32_bf16 v[236:239], v[100:103], v[116:119], v[236:239]
    s_waitcnt lgkmcnt(0)
    v_mfma_f32_16x16x32_bf16 v[128:131], v[32:35], v[60:63], v[128:131]
    ds_read_b128 v[104:107], v249 offset:0
    v_mfma_f32_16x16x32_bf16 v[132:135], v[32:35], v[64:67], v[132:135]
    ds_read_b128 v[108:111], v249 offset:2048
    v_mfma_f32_16x16x32_bf16 v[136:139], v[32:35], v[68:71], v[136:139]
    ds_read_b128 v[112:115], v249 offset:4096
    v_mfma_f32_16x16x32_bf16 v[140:143], v[32:35], v[72:75], v[140:143]
    ds_read_b128 v[116:119], v249 offset:6144
    v_mfma_f32_16x16x32_bf16 v[144:147], v[36:39], v[60:63], v[144:147]
    ds_read_b64_tr_b16 v[76:77], v242 offset:14336
    v_mfma_f32_16x16x32_bf16 v[148:151], v[36:39], v[64:67], v[148:151]
    ds_read_b64_tr_b16 v[78:79], v242 offset:16128
    v_mfma_f32_16x16x32_bf16 v[152:155], v[36:39], v[68:71], v[152:155]
    ds_read_b64_tr_b16 v[80:81], v243 offset:14368
    v_mfma_f32_16x16x32_bf16 v[156:159], v[36:39], v[72:75], v[156:159]
    ds_read_b64_tr_b16 v[82:83], v243 offset:16160
    v_mfma_f32_16x16x32_bf16 v[160:163], v[40:43], v[60:63], v[160:163]
    ds_read_b64_tr_b16 v[84:85], v242 offset:14400
    v_mfma_f32_16x16x32_bf16 v[164:167], v[40:43], v[64:67], v[164:167]
    ds_read_b64_tr_b16 v[86:87], v242 offset:16192
    v_mfma_f32_16x16x32_bf16 v[168:171], v[40:43], v[68:71], v[168:171]
    ds_read_b64_tr_b16 v[88:89], v243 offset:14432
    v_mfma_f32_16x16x32_bf16 v[172:175], v[40:43], v[72:75], v[172:175]
    ds_read_b64_tr_b16 v[90:91], v243 offset:16224
    v_mfma_f32_16x16x32_bf16 v[176:179], v[44:47], v[60:63], v[176:179]
    ds_read_b64_tr_b16 v[92:93], v242 offset:14464
    v_mfma_f32_16x16x32_bf16 v[180:183], v[44:47], v[64:67], v[180:183]
    ds_read_b64_tr_b16 v[94:95], v242 offset:16256
    v_mfma_f32_16x16x32_bf16 v[184:187], v[44:47], v[68:71], v[184:187]
    ds_read_b64_tr_b16 v[96:97], v243 offset:14496
    v_mfma_f32_16x16x32_bf16 v[188:191], v[44:47], v[72:75], v[188:191]
    ds_read_b64_tr_b16 v[98:99], v243 offset:16288
    v_mfma_f32_16x16x32_bf16 v[192:195], v[48:51], v[60:63], v[192:195]
    ds_read_b64_tr_b16 v[100:101], v242 offset:14528
    v_mfma_f32_16x16x32_bf16 v[196:199], v[48:51], v[64:67], v[196:199]
    ds_read_b64_tr_b16 v[102:103], v242 offset:16320
    v_mfma_f32_16x16x32_bf16 v[200:203], v[48:51], v[68:71], v[200:203]
    v_mfma_f32_16x16x32_bf16 v[204:207], v[48:51], v[72:75], v[204:207]
    v_mfma_f32_16x16x32_bf16 v[208:211], v[52:55], v[60:63], v[208:211]
    v_mfma_f32_16x16x32_bf16 v[212:215], v[52:55], v[64:67], v[212:215]
    v_mfma_f32_16x16x32_bf16 v[216:219], v[52:55], v[68:71], v[216:219]
    v_mfma_f32_16x16x32_bf16 v[220:223], v[52:55], v[72:75], v[220:223]
    v_mfma_f32_16x16x32_bf16 v[224:227], v[56:59], v[60:63], v[224:227]
    v_mfma_f32_16x16x32_bf16 v[228:231], v[56:59], v[64:67], v[228:231]
    v_mfma_f32_16x16x32_bf16 v[232:235], v[56:59], v[68:71], v[232:235]
    v_mfma_f32_16x16x32_bf16 v[236:239], v[56:59], v[72:75], v[236:239]
    s_waitcnt lgkmcnt(0)
    v_mfma_f32_16x16x32_bf16 v[128:131], v[76:79], v[104:107], v[128:131]
    v_mfma_f32_16x16x32_bf16 v[132:135], v[76:79], v[108:111], v[132:135]
    v_mfma_f32_16x16x32_bf16 v[136:139], v[76:79], v[112:115], v[136:139]
    s_waitcnt vmcnt(0)
    s_mov_b32 s58, 200000
np_9:
    v_readfirstlane_b32 s57, v28
    s_nop 0
    s_cmp_lg_u32 s57, 0
    s_cbranch_scc1 npx_10
    s_sleep 1
    global_load_dwordx2 v[28:29], v26, s[30:31] sc1
    s_waitcnt vmcnt(0)
    s_sub_u32 s58, s58, 1
    s_cmp_lg_u32 s58, 0
    s_cbranch_scc1 np_9
npx_10:
    buffer_store_dwordx2 v[28:29], v16, s[44:47], s76 offen offset:32 sc1
    s_barrier
    ds_read_b128 v[60:63], v250 offset:0
    v_mfma_f32_16x16x32_bf16 v[140:143], v[76:79], v[116:119], v[140:143]
    ds_read_b128 v[64:67], v250 offset:2048
    v_mfma_f32_16x16x32_bf16 v[144:147], v[80:83], v[104:107], v[144:147]
    ds_read_b128 v[68:71], v250 offset:4096
    v_mfma_f32_16x16x32_bf16 v[148:151], v[80:83], v[108:111], v[148:151]
    ds_read_b128 v[72:75], v250 offset:6144
    v_mfma_f32_16x16x32_bf16 v[152:155], v[80:83], v[112:115], v[152:155]
    ds_read_b64_tr_b16 v[32:33], v244 offset:0
    v_mfma_f32_16x16x32_bf16 v[156:159], v[80:83], v[116:119], v[156:159]
    ds_read_b64_tr_b16 v[34:35], v244 offset:1792
    v_mfma_f32_16x16x32_bf16 v[160:163], v[84:87], v[104:107], v[160:163]
    ds_read_b64_tr_b16 v[36:37], v245 offset:32
    v_mfma_f32_16x16x32_bf16 v[164:167], v[84:87], v[108:111], v[164:167]
    ds_read_b64_tr_b16 v[38:39], v245 offset:1824
    v_mfma_f32_16x16x32_bf16 v[168:171], v[84:87], v[112:115], v[168:171]
    ds_read_b64_tr_b16 v[40:41], v244 offset:64
    v_mfma_f32_16x16x32_bf16 v[172:175], v[84:87], v[116:119], v[172:175]
    ds_read_b64_tr_b16 v[42:43], v244 offset:1856
    v_mfma_f32_16x16x32_bf16 v[176:179], v[88:91], v[104:107], v[176:179]
    ds_read_b64_tr_b16 v[44:45], v245 offset:96
    v_mfma_f32_16x16x32_bf16 v[180:183], v[88:91], v[108:111], v[180:183]
    ds_read_b64_tr_b16 v[46:47], v245 offset:1888
    v_mfma_f32_16x16x32_bf16 v[184:187], v[88:91], v[112:115], v[184:187]
    ds_read_b64_tr_b16 v[48:49], v244 offset:128
    v_mfma_f32_16x16x32_bf16 v[188:191], v[88:91], v[116:119], v[188:191]
    ds_read_b64_tr_b16 v[50:51], v244 offset:1920
    v_mfma_f32_16x16x32_bf16 v[192:195], v[92:95], v[104:107], v[192:195]
    ds_read_b64_tr_b16 v[52:53], v245 offset:160
    v_mfma_f32_16x16x32_bf16 v[196:199], v[92:95], v[108:111], v[196:199]
    ds_read_b64_tr_b16 v[54:55], v245 offset:1952
    v_mfma_f32_16x16x32_bf16 v[200:203], v[92:95], v[112:115], v[200:203]
    ds_read_b64_tr_b16 v[56:57], v244 offset:192
    v_mfma_f32_16x16x32_bf16 v[204:207], v[92:95], v[116:119], v[204:207]
    ds_read_b64_tr_b16 v[58:59], v244 offset:1984
    v_mfma_f32_16x16x32_bf16 v[208:211], v[96:99], v[104:107], v[208:211]
    v_mfma_f32_16x16x32_bf16 v[212:215], v[96:99], v[108:111], v[212:215]
    v_mfma_f32_16x16x32_bf16 v[216:219], v[96:99], v[112:115], v[216:219]
    v_mfma_f32_16x16x32_bf16 v[220:223], v[96:99], v[116:119], v[220:223]
    v_mfma_f32_16x16x32_bf16 v[224:227], v[100:103], v[104:107], v[224:227]
    v_mfma_f32_16x16x32_bf16 v[228:231], v[100:103], v[108:111], v[228:231]
    v_mfma_f32_16x16x32_bf16 v[232:235], v[100:103], v[112:115], v[232:235]
    v_mfma_f32_16x16x32_bf16 v[236:239], v[100:103], v[116:119], v[236:239]
    s_waitcnt lgkmcnt(0)
    v_mfma_f32_16x16x32_bf16 v[128:131], v[32:35], v[60:63], v[128:131]
    ds_read_b128 v[104:107], v251 offset:0
    v_mfma_f32_16x16x32_bf16 v[132:135], v[32:35], v[64:67], v[132:135]
    ds_read_b128 v[108:111], v251 offset:2048
    v_mfma_f32_16x16x32_bf16 v[136:139], v[32:35], v[68:71], v[136:139]
    ds_read_b128 v[112:115], v251 offset:4096
    v_mfma_f32_16x16x32_bf16 v[140:143], v[32:35], v[72:75], v[140:143]
    ds_read_b128 v[116:119], v251 offset:6144
    v_mfma_f32_16x16x32_bf16 v[144:147], v[36:39], v[60:63], v[144:147]
    ds_read_b64_tr_b16 v[76:77], v244 offset:14336
    v_mfma_f32_16x16x32_bf16 v[148:151], v[36:39], v[64:67], v[148:151]
    ds_read_b64_tr_b16 v[78:79], v244 offset:16128
    v_mfma_f32_16x16x32_bf16 v[152:155], v[36:39], v[68:71], v[152:155]
    ds_read_b64_tr_b16 v[80:81], v245 offset:14368
    v_mfma_f32_16x16x32_bf16 v[156:159], v[36:39], v[72:75], v[156:159]
    ds_read_b64_tr_b16 v[82:83], v245 offset:16160
    v_mfma_f32_16x16x32_bf16 v[160:163], v[40:43], v[60:63], v[160:163]
    ds_read_b64_tr_b16 v[84:85], v244 offset:14400
    v_mfma_f32_16x16x32_bf16 v[164:167], v[40:43], v[64:67], v[164:167]
    ds_read_b64_tr_b16 v[86:87], v244 offset:16192
    v_mfma_f32_16x16x32_bf16 v[168:171], v[40:43], v[68:71], v[168:171]
    ds_read_b64_tr_b16 v[88:89], v245 offset:14432
    v_mfma_f32_16x16x32_bf16 v[172:175], v[40:43], v[72:75], v[172:175]
    ds_read_b64_tr_b16 v[90:91], v245 offset:16224
    v_mfma_f32_16x16x32_bf16 v[176:179], v[44:47], v[60:63], v[176:179]
    ds_read_b64_tr_b16 v[92:93], v244 offset:14464
    v_mfma_f32_16x16x32_bf16 v[180:183], v[44:47], v[64:67], v[180:183]
    ds_read_b64_tr_b16 v[94:95], v244 offset:16256
    v_mfma_f32_16x16x32_bf16 v[184:187], v[44:47], v[68:71], v[184:187]
    ds_read_b64_tr_b16 v[96:97], v245 offset:14496
    v_mfma_f32_16x16x32_bf16 v[188:191], v[44:47], v[72:75], v[188:191]
    ds_read_b64_tr_b16 v[98:99], v245 offset:16288
    v_mfma_f32_16x16x32_bf16 v[192:195], v[48:51], v[60:63], v[192:195]
    ds_read_b64_tr_b16 v[100:101], v244 offset:14528
    v_mfma_f32_16x16x32_bf16 v[196:199], v[48:51], v[64:67], v[196:199]
    ds_read_b64_tr_b16 v[102:103], v244 offset:16320
    v_mfma_f32_16x16x32_bf16 v[200:203], v[48:51], v[68:71], v[200:203]
    v_mfma_f32_16x16x32_bf16 v[204:207], v[48:51], v[72:75], v[204:207]
    v_mfma_f32_16x16x32_bf16 v[208:211], v[52:55], v[60:63], v[208:211]
    v_mfma_f32_16x16x32_bf16 v[212:215], v[52:55], v[64:67], v[212:215]
    v_mfma_f32_16x16x32_bf16 v[216:219], v[52:55], v[68:71], v[216:219]
    v_mfma_f32_16x16x32_bf16 v[220:223], v[52:55], v[72:75], v[220:223]
    v_mfma_f32_16x16x32_bf16 v[224:227], v[56:59], v[60:63], v[224:227]
    v_mfma_f32_16x16x32_bf16 v[228:231], v[56:59], v[64:67], v[228:231]
    v_mfma_f32_16x16x32_bf16 v[232:235], v[56:59], v[68:71], v[232:235]
    v_mfma_f32_16x16x32_bf16 v[236:239], v[56:59], v[72:75], v[236:239]
    s_waitcnt lgkmcnt(0)
    v_mfma_f32_16x16x32_bf16 v[128:131], v[76:79], v[104:107], v[128:131]
    v_mfma_f32_16x16x32_bf16 v[132:135], v[76:79], v[108:111], v[132:135]
    v_mfma_f32_16x16x32_bf16 v[136:139], v[76:79], v[112:115], v[136:139]
    ds_read_b128 v[120:123], v13 offset:2048
    s_waitcnt lgkmcnt(0)
    buffer_store_dwordx4 v[120:123], v12, s[44:47], s62 offen sc1
    s_barrier
    ds_read_b128 v[60:63], v246 offset:0
    v_mfma_f32_16x16x32_bf16 v[140:143], v[76:79], v[116:119], v[140:143]
    ds_read_b128 v[64:67], v246 offset:2048
    v_mfma_f32_16x16x32_bf16 v[144:147], v[80:83], v[104:107], v[144:147]
    ds_read_b128 v[68:71], v246 offset:4096
    v_mfma_f32_16x16x32_bf16 v[148:151], v[80:83], v[108:111], v[148:151]
    ds_read_b128 v[72:75], v246 offset:6144
    v_mfma_f32_16x16x32_bf16 v[152:155], v[80:83], v[112:115], v[152:155]
    ds_read_b64_tr_b16 v[32:33], v240 offset:0
    v_mfma_f32_16x16x32_bf16 v[156:159], v[80:83], v[116:119], v[156:159]
    ds_read_b64_tr_b16 v[34:35], v240 offset:1792
    v_mfma_f32_16x16x32_bf16 v[160:163], v[84:87], v[104:107], v[160:163]
    ds_read_b64_tr_b16 v[36:37], v241 offset:32
    v_mfma_f32_16x16x32_bf16 v[164:167], v[84:87], v[108:111], v[164:167]
    ds_read_b64_tr_b16 v[38:39], v241 offset:1824
    v_mfma_f32_16x16x32_bf16 v[168:171], v[84:87], v[112:115], v[168:171]
    ds_read_b64_tr_b16 v[40:41], v240 offset:64
    v_mfma_f32_16x16x32_bf16 v[172:175], v[84:87], v[116:119], v[172:175]
    ds_read_b64_tr_b16 v[42:43], v240 offset:1856
    v_mfma_f32_16x16x32_bf16 v[176:179], v[88:91], v[104:107], v[176:179]
    ds_read_b64_tr_b16 v[44:45], v241 offset:96
    v_mfma_f32_16x16x32_bf16 v[180:183], v[88:91], v[108:111], v[180:183]
    ds_read_b64_tr_b16 v[46:47], v241 offset:1888
    v_mfma_f32_16x16x32_bf16 v[184:187], v[88:91], v[112:115], v[184:187]
    ds_read_b64_tr_b16 v[48:49], v240 offset:128
    v_mfma_f32_16x16x32_bf16 v[188:191], v[88:91], v[116:119], v[188:191]
    ds_read_b64_tr_b16 v[50:51], v240 offset:1920
    v_mfma_f32_16x16x32_bf16 v[192:195], v[92:95], v[104:107], v[192:195]
    ds_read_b64_tr_b16 v[52:53], v241 offset:160
    v_mfma_f32_16x16x32_bf16 v[196:199], v[92:95], v[108:111], v[196:199]
    ds_read_b64_tr_b16 v[54:55], v241 offset:1952
    v_mfma_f32_16x16x32_bf16 v[200:203], v[92:95], v[112:115], v[200:203]
    ds_read_b64_tr_b16 v[56:57], v240 offset:192
    v_mfma_f32_16x16x32_bf16 v[204:207], v[92:95], v[116:119], v[204:207]
    ds_read_b64_tr_b16 v[58:59], v240 offset:1984
    v_mfma_f32_16x16x32_bf16 v[208:211], v[96:99], v[104:107], v[208:211]
    v_mfma_f32_16x16x32_bf16 v[212:215], v[96:99], v[108:111], v[212:215]
    v_mfma_f32_16x16x32_bf16 v[216:219], v[96:99], v[112:115], v[216:219]
    v_mfma_f32_16x16x32_bf16 v[220:223], v[96:99], v[116:119], v[220:223]
    v_mfma_f32_16x16x32_bf16 v[224:227], v[100:103], v[104:107], v[224:227]
    v_mfma_f32_16x16x32_bf16 v[228:231], v[100:103], v[108:111], v[228:231]
    v_mfma_f32_16x16x32_bf16 v[232:235], v[100:103], v[112:115], v[232:235]
    v_mfma_f32_16x16x32_bf16 v[236:239], v[100:103], v[116:119], v[236:239]
    s_waitcnt lgkmcnt(0)
    v_mfma_f32_16x16x32_bf16 v[128:131], v[32:35], v[60:63], v[128:131]
    ds_read_b128 v[104:107], v247 offset:0
    v_mfma_f32_16x16x32_bf16 v[132:135], v[32:35], v[64:67], v[132:135]
    ds_read_b128 v[108:111], v247 offset:2048
    v_mfma_f32_16x16x32_bf16 v[136:139], v[32:35], v[68:71], v[136:139]
    ds_read_b128 v[112:115], v247 offset:4096
    v_mfma_f32_16x16x32_bf16 v[140:143], v[32:35], v[72:75], v[140:143]
    ds_read_b128 v[116:119], v247 offset:6144
    v_mfma_f32_16x16x32_bf16 v[144:147], v[36:39], v[60:63], v[144:147]
    ds_read_b64_tr_b16 v[76:77], v240 offset:14336
    v_mfma_f32_16x16x32_bf16 v[148:151], v[36:39], v[64:67], v[148:151]
    ds_read_b64_tr_b16 v[78:79], v240 offset:16128
    v_mfma_f32_16x16x32_bf16 v[152:155], v[36:39], v[68:71], v[152:155]
    ds_read_b64_tr_b16 v[80:81], v241 offset:14368
    v_mfma_f32_16x16x32_bf16 v[156:159], v[36:39], v[72:75], v[156:159]
    ds_read_b64_tr_b16 v[82:83], v241 offset:16160
    v_mfma_f32_16x16x32_bf16 v[160:163], v[40:43], v[60:63], v[160:163]
    ds_read_b64_tr_b16 v[84:85], v240 offset:14400
    v_mfma_f32_16x16x32_bf16 v[164:167], v[40:43], v[64:67], v[164:167]
    ds_read_b64_tr_b16 v[86:87], v240 offset:16192
    v_mfma_f32_16x16x32_bf16 v[168:171], v[40:43], v[68:71], v[168:171]
    ds_read_b64_tr_b16 v[88:89], v241 offset:14432
    v_mfma_f32_16x16x32_bf16 v[172:175], v[40:43], v[72:75], v[172:175]
    ds_read_b64_tr_b16 v[90:91], v241 offset:16224
    v_mfma_f32_16x16x32_bf16 v[176:179], v[44:47], v[60:63], v[176:179]
    ds_read_b64_tr_b16 v[92:93], v240 offset:14464
    v_mfma_f32_16x16x32_bf16 v[180:183], v[44:47], v[64:67], v[180:183]
    ds_read_b64_tr_b16 v[94:95], v240 offset:16256
    v_mfma_f32_16x16x32_bf16 v[184:187], v[44:47], v[68:71], v[184:187]
    ds_read_b64_tr_b16 v[96:97], v241 offset:14496
    v_mfma_f32_16x16x32_bf16 v[188:191], v[44:47], v[72:75], v[188:191]
    ds_read_b64_tr_b16 v[98:99], v241 offset:16288
    v_mfma_f32_16x16x32_bf16 v[192:195], v[48:51], v[60:63], v[192:195]
    ds_read_b64_tr_b16 v[100:101], v240 offset:14528
    v_mfma_f32_16x16x32_bf16 v[196:199], v[48:51], v[64:67], v[196:199]
    ds_read_b64_tr_b16 v[102:103], v240 offset:16320
    v_mfma_f32_16x16x32_bf16 v[200:203], v[48:51], v[68:71], v[200:203]
    v_mfma_f32_16x16x32_bf16 v[204:207], v[48:51], v[72:75], v[204:207]
    v_mfma_f32_16x16x32_bf16 v[208:211], v[52:55], v[60:63], v[208:211]
    v_mfma_f32_16x16x32_bf16 v[212:215], v[52:55], v[64:67], v[212:215]
    v_mfma_f32_16x16x32_bf16 v[216:219], v[52:55], v[68:71], v[216:219]
    v_mfma_f32_16x16x32_bf16 v[220:223], v[52:55], v[72:75], v[220:223]
    v_mfma_f32_16x16x32_bf16 v[224:227], v[56:59], v[60:63], v[224:227]
    v_mfma_f32_16x16x32_bf16 v[228:231], v[56:59], v[64:67], v[228:231]
    v_mfma_f32_16x16x32_bf16 v[232:235], v[56:59], v[68:71], v[232:235]
    v_mfma_f32_16x16x32_bf16 v[236:239], v[56:59], v[72:75], v[236:239]
    s_waitcnt lgkmcnt(0)
    v_mfma_f32_16x16x32_bf16 v[128:131], v[76:79], v[104:107], v[128:131]
    v_mfma_f32_16x16x32_bf16 v[132:135], v[76:79], v[108:111], v[132:135]
    v_mfma_f32_16x16x32_bf16 v[136:139], v[76:79], v[112:115], v[136:139]
    s_barrier
    ds_read_b128 v[60:63], v248 offset:0
    v_mfma_f32_16x16x32_bf16 v[140:143], v[76:79], v[116:119], v[140:143]
    ds_read_b128 v[64:67], v248 offset:2048
    v_mfma_f32_16x16x32_bf16 v[144:147], v[80:83], v[104:107], v[144:147]
    ds_read_b128 v[68:71], v248 offset:4096
    v_mfma_f32_16x16x32_bf16 v[148:151], v[80:83], v[108:111], v[148:151]
    ds_read_b128 v[72:75], v248 offset:6144
    v_mfma_f32_16x16x32_bf16 v[152:155], v[80:83], v[112:115], v[152:155]
    ds_read_b64_tr_b16 v[32:33], v242 offset:0
    v_mfma_f32_16x16x32_bf16 v[156:159], v[80:83], v[116:119], v[156:159]
    ds_read_b64_tr_b16 v[34:35], v242 offset:1792
    v_mfma_f32_16x16x32_bf16 v[160:163], v[84:87], v[104:107], v[160:163]
    ds_read_b64_tr_b16 v[36:37], v243 offset:32
    v_mfma_f32_16x16x32_bf16 v[164:167], v[84:87], v[108:111], v[164:167]
    ds_read_b64_tr_b16 v[38:39], v243 offset:1824
    v_mfma_f32_16x16x32_bf16 v[168:171], v[84:87], v[112:115], v[168:171]
    ds_read_b64_tr_b16 v[40:41], v242 offset:64
    v_mfma_f32_16x16x32_bf16 v[172:175], v[84:87], v[116:119], v[172:175]
    ds_read_b64_tr_b16 v[42:43], v242 offset:1856
    v_mfma_f32_16x16x32_bf16 v[176:179], v[88:91], v[104:107], v[176:179]
    ds_read_b64_tr_b16 v[44:45], v243 offset:96
    v_mfma_f32_16x16x32_bf16 v[180:183], v[88:91], v[108:111], v[180:183]
    ds_read_b64_tr_b16 v[46:47], v243 offset:1888
    v_mfma_f32_16x16x32_bf16 v[184:187], v[88:91], v[112:115], v[184:187]
    ds_read_b64_tr_b16 v[48:49], v242 offset:128
    v_mfma_f32_16x16x32_bf16 v[188:191], v[88:91], v[116:119], v[188:191]
    ds_read_b64_tr_b16 v[50:51], v242 offset:1920
    v_mfma_f32_16x16x32_bf16 v[192:195], v[92:95], v[104:107], v[192:195]
    ds_read_b64_tr_b16 v[52:53], v243 offset:160
    v_mfma_f32_16x16x32_bf16 v[196:199], v[92:95], v[108:111], v[196:199]
    ds_read_b64_tr_b16 v[54:55], v243 offset:1952
    v_mfma_f32_16x16x32_bf16 v[200:203], v[92:95], v[112:115], v[200:203]
    ds_read_b64_tr_b16 v[56:57], v242 offset:192
    v_mfma_f32_16x16x32_bf16 v[204:207], v[92:95], v[116:119], v[204:207]
    ds_read_b64_tr_b16 v[58:59], v242 offset:1984
    v_mfma_f32_16x16x32_bf16 v[208:211], v[96:99], v[104:107], v[208:211]
    v_mfma_f32_16x16x32_bf16 v[212:215], v[96:99], v[108:111], v[212:215]
    v_mfma_f32_16x16x32_bf16 v[216:219], v[96:99], v[112:115], v[216:219]
    v_mfma_f32_16x16x32_bf16 v[220:223], v[96:99], v[116:119], v[220:223]
    v_mfma_f32_16x16x32_bf16 v[224:227], v[100:103], v[104:107], v[224:227]
    v_mfma_f32_16x16x32_bf16 v[228:231], v[100:103], v[108:111], v[228:231]
    v_mfma_f32_16x16x32_bf16 v[232:235], v[100:103], v[112:115], v[232:235]
    v_mfma_f32_16x16x32_bf16 v[236:239], v[100:103], v[116:119], v[236:239]
    s_waitcnt lgkmcnt(0)
    v_mfma_f32_16x16x32_bf16 v[128:131], v[32:35], v[60:63], v[128:131]
    ds_read_b128 v[104:107], v249 offset:0
    v_mfma_f32_16x16x32_bf16 v[132:135], v[32:35], v[64:67], v[132:135]
    ds_read_b128 v[108:111], v249 offset:2048
    v_mfma_f32_16x16x32_bf16 v[136:139], v[32:35], v[68:71], v[136:139]
    ds_read_b128 v[112:115], v249 offset:4096
    v_mfma_f32_16x16x32_bf16 v[140:143], v[32:35], v[72:75], v[140:143]
    ds_read_b128 v[116:119], v249 offset:6144
    v_mfma_f32_16x16x32_bf16 v[144:147], v[36:39], v[60:63], v[144:147]
    ds_read_b64_tr_b16 v[76:77], v242 offset:14336
    v_mfma_f32_16x16x32_bf16 v[148:151], v[36:39], v[64:67], v[148:151]
    ds_read_b64_tr_b16 v[78:79], v242 offset:16128
    v_mfma_f32_16x16x32_bf16 v[152:155], v[36:39], v[68:71], v[152:155]
    ds_read_b64_tr_b16 v[80:81], v243 offset:14368
    v_mfma_f32_16x16x32_bf16 v[156:159], v[36:39], v[72:75], v[156:159]
    ds_read_b64_tr_b16 v[82:83], v243 offset:16160
    v_mfma_f32_16x16x32_bf16 v[160:163], v[40:43], v[60:63], v[160:163]
    ds_read_b64_tr_b16 v[84:85], v242 offset:14400
    v_mfma_f32_16x16x32_bf16 v[164:167], v[40:43], v[64:67], v[164:167]
    ds_read_b64_tr_b16 v[86:87], v242 offset:16192
    v_mfma_f32_16x16x32_bf16 v[168:171], v[40:43], v[68:71], v[168:171]
    ds_read_b64_tr_b16 v[88:89], v243 offset:14432
    v_mfma_f32_16x16x32_bf16 v[172:175], v[40:43], v[72:75], v[172:175]
    ds_read_b64_tr_b16 v[90:91], v243 offset:16224
    v_mfma_f32_16x16x32_bf16 v[176:179], v[44:47], v[60:63], v[176:179]
    ds_read_b64_tr_b16 v[92:93], v242 offset:14464
    v_mfma_f32_16x16x32_bf16 v[180:183], v[44:47], v[64:67], v[180:183]
    ds_read_b64_tr_b16 v[94:95], v242 offset:16256
    v_mfma_f32_16x16x32_bf16 v[184:187], v[44:47], v[68:71], v[184:187]
    ds_read_b64_tr_b16 v[96:97], v243 offset:14496
    v_mfma_f32_16x16x32_bf16 v[188:191], v[44:47], v[72:75], v[188:191]
    ds_read_b64_tr_b16 v[98:99], v243 offset:16288
    v_mfma_f32_16x16x32_bf16 v[192:195], v[48:51], v[60:63], v[192:195]
    ds_read_b64_tr_b16 v[100:101], v242 offset:14528
    v_mfma_f32_16x16x32_bf16 v[196:199], v[48:51], v[64:67], v[196:199]
    ds_read_b64_tr_b16 v[102:103], v242 offset:16320
    v_mfma_f32_16x16x32_bf16 v[200:203], v[48:51], v[68:71], v[200:203]
    v_mfma_f32_16x16x32_bf16 v[204:207], v[48:51], v[72:75], v[204:207]
    v_mfma_f32_16x16x32_bf16 v[208:211], v[52:55], v[60:63], v[208:211]
    v_mfma_f32_16x16x32_bf16 v[212:215], v[52:55], v[64:67], v[212:215]
    v_mfma_f32_16x16x32_bf16 v[216:219], v[52:55], v[68:71], v[216:219]
    v_mfma_f32_16x16x32_bf16 v[220:223], v[52:55], v[72:75], v[220:223]
    v_mfma_f32_16x16x32_bf16 v[224:227], v[56:59], v[60:63], v[224:227]
    v_mfma_f32_16x16x32_bf16 v[228:231], v[56:59], v[64:67], v[228:231]
    v_mfma_f32_16x16x32_bf16 v[232:235], v[56:59], v[68:71], v[232:235]
    v_mfma_f32_16x16x32_bf16 v[236:239], v[56:59], v[72:75], v[236:239]
    s_waitcnt lgkmcnt(0)
    v_mfma_f32_16x16x32_bf16 v[128:131], v[76:79], v[104:107], v[128:131]
    v_mfma_f32_16x16x32_bf16 v[132:135], v[76:79], v[108:111], v[132:135]
    v_mfma_f32_16x16x32_bf16 v[136:139], v[76:79], v[112:115], v[136:139]
    s_waitcnt vmcnt(0)
    buffer_store_dwordx2 v[28:29], v16, s[44:47], s76 offen sc1
    s_barrier
    ds_read_b128 v[60:63], v250 offset:0
    v_mfma_f32_16x16x32_bf16 v[140:143], v[76:79], v[116:119], v[140:143]
    ds_read_b128 v[64:67], v250 offset:2048
    v_mfma_f32_16x16x32_bf16 v[144:147], v[80:83], v[104:107], v[144:147]
    ds_read_b128 v[68:71], v250 offset:4096
    v_mfma_f32_16x16x32_bf16 v[148:151], v[80:83], v[108:111], v[148:151]
    ds_read_b128 v[72:75], v250 offset:6144
    v_mfma_f32_16x16x32_bf16 v[152:155], v[80:83], v[112:115], v[152:155]
    ds_read_b64_tr_b16 v[32:33], v244 offset:0
    v_mfma_f32_16x16x32_bf16 v[156:159], v[80:83], v[116:119], v[156:159]
    ds_read_b64_tr_b16 v[34:35], v244 offset:1792
    v_mfma_f32_16x16x32_bf16 v[160:163], v[84:87], v[104:107], v[160:163]
    ds_read_b64_tr_b16 v[36:37], v245 offset:32
    v_mfma_f32_16x16x32_bf16 v[164:167], v[84:87], v[108:111], v[164:167]
    ds_read_b64_tr_b16 v[38:39], v245 offset:1824
    v_mfma_f32_16x16x32_bf16 v[168:171], v[84:87], v[112:115], v[168:171]
    ds_read_b64_tr_b16 v[40:41], v244 offset:64
    v_mfma_f32_16x16x32_bf16 v[172:175], v[84:87], v[116:119], v[172:175]
    ds_read_b64_tr_b16 v[42:43], v244 offset:1856
    v_mfma_f32_16x16x32_bf16 v[176:179], v[88:91], v[104:107], v[176:179]
    ds_read_b64_tr_b16 v[44:45], v245 offset:96
    v_mfma_f32_16x16x32_bf16 v[180:183], v[88:91], v[108:111], v[180:183]
    ds_read_b64_tr_b16 v[46:47], v245 offset:1888
    v_mfma_f32_16x16x32_bf16 v[184:187], v[88:91], v[112:115], v[184:187]
    ds_read_b64_tr_b16 v[48:49], v244 offset:128
    v_mfma_f32_16x16x32_bf16 v[188:191], v[88:91], v[116:119], v[188:191]
    ds_read_b64_tr_b16 v[50:51], v244 offset:1920
    v_mfma_f32_16x16x32_bf16 v[192:195], v[92:95], v[104:107], v[192:195]
    ds_read_b64_tr_b16 v[52:53], v245 offset:160
    v_mfma_f32_16x16x32_bf16 v[196:199], v[92:95], v[108:111], v[196:199]
    ds_read_b64_tr_b16 v[54:55], v245 offset:1952
    v_mfma_f32_16x16x32_bf16 v[200:203], v[92:95], v[112:115], v[200:203]
    ds_read_b64_tr_b16 v[56:57], v244 offset:192
    v_mfma_f32_16x16x32_bf16 v[204:207], v[92:95], v[116:119], v[204:207]
    ds_read_b64_tr_b16 v[58:59], v244 offset:1984
    v_mfma_f32_16x16x32_bf16 v[208:211], v[96:99], v[104:107], v[208:211]
    v_mfma_f32_16x16x32_bf16 v[212:215], v[96:99], v[108:111], v[212:215]
    v_mfma_f32_16x16x32_bf16 v[216:219], v[96:99], v[112:115], v[216:219]
    v_mfma_f32_16x16x32_bf16 v[220:223], v[96:99], v[116:119], v[220:223]
    v_mfma_f32_16x16x32_bf16 v[224:227], v[100:103], v[104:107], v[224:227]
    v_mfma_f32_16x16x32_bf16 v[228:231], v[100:103], v[108:111], v[228:231]
    v_mfma_f32_16x16x32_bf16 v[232:235], v[100:103], v[112:115], v[232:235]
    v_mfma_f32_16x16x32_bf16 v[236:239], v[100:103], v[116:119], v[236:239]
    s_waitcnt lgkmcnt(0)
    v_mfma_f32_16x16x32_bf16 v[128:131], v[32:35], v[60:63], v[128:131]
    ds_read_b128 v[104:107], v251 offset:0
    v_mfma_f32_16x16x32_bf16 v[132:135], v[32:35], v[64:67], v[132:135]
    ds_read_b128 v[108:111], v251 offset:2048
    v_mfma_f32_16x16x32_bf16 v[136:139], v[32:35], v[68:71], v[136:139]
    ds_read_b128 v[112:115], v251 offset:4096
    v_mfma_f32_16x16x32_bf16 v[140:143], v[32:35], v[72:75], v[140:143]
    ds_read_b128 v[116:119], v251 offset:6144
    v_mfma_f32_16x16x32_bf16 v[144:147], v[36:39], v[60:63], v[144:147]
    ds_read_b64_tr_b16 v[76:77], v244 offset:14336
    v_mfma_f32_16x16x32_bf16 v[148:151], v[36:39], v[64:67], v[148:151]
    ds_read_b64_tr_b16 v[78:79], v244 offset:16128
    v_mfma_f32_16x16x32_bf16 v[152:155], v[36:39], v[68:71], v[152:155]
    ds_read_b64_tr_b16 v[80:81], v245 offset:14368
    v_mfma_f32_16x16x32_bf16 v[156:159], v[36:39], v[72:75], v[156:159]
    ds_read_b64_tr_b16 v[82:83], v245 offset:16160
    v_mfma_f32_16x16x32_bf16 v[160:163], v[40:43], v[60:63], v[160:163]
    ds_read_b64_tr_b16 v[84:85], v244 offset:14400
    v_mfma_f32_16x16x32_bf16 v[164:167], v[40:43], v[64:67], v[164:167]
    ds_read_b64_tr_b16 v[86:87], v244 offset:16192
    v_mfma_f32_16x16x32_bf16 v[168:171], v[40:43], v[68:71], v[168:171]
    ds_read_b64_tr_b16 v[88:89], v245 offset:14432
    v_mfma_f32_16x16x32_bf16 v[172:175], v[40:43], v[72:75], v[172:175]
    ds_read_b64_tr_b16 v[90:91], v245 offset:16224
    v_mfma_f32_16x16x32_bf16 v[176:179], v[44:47], v[60:63], v[176:179]
    ds_read_b64_tr_b16 v[92:93], v244 offset:14464
    v_mfma_f32_16x16x32_bf16 v[180:183], v[44:47], v[64:67], v[180:183]
    ds_read_b64_tr_b16 v[94:95], v244 offset:16256
    v_mfma_f32_16x16x32_bf16 v[184:187], v[44:47], v[68:71], v[184:187]
    ds_read_b64_tr_b16 v[96:97], v245 offset:14496
    v_mfma_f32_16x16x32_bf16 v[188:191], v[44:47], v[72:75], v[188:191]
    ds_read_b64_tr_b16 v[98:99], v245 offset:16288
    v_mfma_f32_16x16x32_bf16 v[192:195], v[48:51], v[60:63], v[192:195]
    ds_read_b64_tr_b16 v[100:101], v244 offset:14528
    v_mfma_f32_16x16x32_bf16 v[196:199], v[48:51], v[64:67], v[196:199]
    ds_read_b64_tr_b16 v[102:103], v244 offset:16320
    v_mfma_f32_16x16x32_bf16 v[200:203], v[48:51], v[68:71], v[200:203]
    v_mfma_f32_16x16x32_bf16 v[204:207], v[48:51], v[72:75], v[204:207]
    v_mfma_f32_16x16x32_bf16 v[208:211], v[52:55], v[60:63], v[208:211]
    v_mfma_f32_16x16x32_bf16 v[212:215], v[52:55], v[64:67], v[212:215]
    v_mfma_f32_16x16x32_bf16 v[216:219], v[52:55], v[68:71], v[216:219]
    v_mfma_f32_16x16x32_bf16 v[220:223], v[52:55], v[72:75], v[220:223]
    v_mfma_f32_16x16x32_bf16 v[224:227], v[56:59], v[60:63], v[224:227]
    v_mfma_f32_16x16x32_bf16 v[228:231], v[56:59], v[64:67], v[228:231]
    v_mfma_f32_16x16x32_bf16 v[232:235], v[56:59], v[68:71], v[232:235]
    v_mfma_f32_16x16x32_bf16 v[236:239], v[56:59], v[72:75], v[236:239]
    s_waitcnt lgkmcnt(0)
    v_mfma_f32_16x16x32_bf16 v[128:131], v[76:79], v[104:107], v[128:131]
    v_mfma_f32_16x16x32_bf16 v[132:135], v[76:79], v[108:111], v[132:135]
    v_mfma_f32_16x16x32_bf16 v[136:139], v[76:79], v[112:115], v[136:139]
    s_barrier
    ds_read_b128 v[60:63], v246 offset:0
    v_mfma_f32_16x16x32_bf16 v[140:143], v[76:79], v[116:119], v[140:143]
    ds_read_b128 v[64:67], v246 offset:2048
    v_mfma_f32_16x16x32_bf16 v[144:147], v[80:83], v[104:107], v[144:147]
    ds_read_b128 v[68:71], v246 offset:4096
    v_mfma_f32_16x16x32_bf16 v[148:151], v[80:83], v[108:111], v[148:151]
    ds_read_b128 v[72:75], v246 offset:6144
    v_mfma_f32_16x16x32_bf16 v[152:155], v[80:83], v[112:115], v[152:155]
    ds_read_b64_tr_b16 v[32:33], v240 offset:0
    v_mfma_f32_16x16x32_bf16 v[156:159], v[80:83], v[116:119], v[156:159]
    ds_read_b64_tr_b16 v[34:35], v240 offset:1792
    v_mfma_f32_16x16x32_bf16 v[160:163], v[84:87], v[104:107], v[160:163]
    ds_read_b64_tr_b16 v[36:37], v241 offset:32
    v_mfma_f32_16x16x32_bf16 v[164:167], v[84:87], v[108:111], v[164:167]
    ds_read_b64_tr_b16 v[38:39], v241 offset:1824
    v_mfma_f32_16x16x32_bf16 v[168:171], v[84:87], v[112:115], v[168:171]
    ds_read_b64_tr_b16 v[40:41], v240 offset:64
    v_mfma_f32_16x16x32_bf16 v[172:175], v[84:87], v[116:119], v[172:175]
    ds_read_b64_tr_b16 v[42:43], v240 offset:1856
    v_mfma_f32_16x16x32_bf16 v[176:179], v[88:91], v[104:107], v[176:179]
    ds_read_b64_tr_b16 v[44:45], v241 offset:96
    v_mfma_f32_16x16x32_bf16 v[180:183], v[88:91], v[108:111], v[180:183]
    ds_read_b64_tr_b16 v[46:47], v241 offset:1888
    v_mfma_f32_16x16x32_bf16 v[184:187], v[88:91], v[112:115], v[184:187]
    ds_read_b64_tr_b16 v[48:49], v240 offset:128
    v_mfma_f32_16x16x32_bf16 v[188:191], v[88:91], v[116:119], v[188:191]
    ds_read_b64_tr_b16 v[50:51], v240 offset:1920
    v_mfma_f32_16x16x32_bf16 v[192:195], v[92:95], v[104:107], v[192:195]
    ds_read_b64_tr_b16 v[52:53], v241 offset:160
    v_mfma_f32_16x16x32_bf16 v[196:199], v[92:95], v[108:111], v[196:199]
    ds_read_b64_tr_b16 v[54:55], v241 offset:1952
    v_mfma_f32_16x16x32_bf16 v[200:203], v[92:95], v[112:115], v[200:203]
    ds_read_b64_tr_b16 v[56:57], v240 offset:192
    v_mfma_f32_16x16x32_bf16 v[204:207], v[92:95], v[116:119], v[204:207]
    ds_read_b64_tr_b16 v[58:59], v240 offset:1984
    v_mfma_f32_16x16x32_bf16 v[208:211], v[96:99], v[104:107], v[208:211]
    v_mfma_f32_16x16x32_bf16 v[212:215], v[96:99], v[108:111], v[212:215]
    v_mfma_f32_16x16x32_bf16 v[216:219], v[96:99], v[112:115], v[216:219]
    v_mfma_f32_16x16x32_bf16 v[220:223], v[96:99], v[116:119], v[220:223]
    v_mfma_f32_16x16x32_bf16 v[224:227], v[100:103], v[104:107], v[224:227]
    v_mfma_f32_16x16x32_bf16 v[228:231], v[100:103], v[108:111], v[228:231]
    v_mfma_f32_16x16x32_bf16 v[232:235], v[100:103], v[112:115], v[232:235]
    v_mfma_f32_16x16x32_bf16 v[236:239], v[100:103], v[116:119], v[236:239]
    s_waitcnt lgkmcnt(0)
    v_mfma_f32_16x16x32_bf16 v[128:131], v[32:35], v[60:63], v[128:131]
    ds_read_b128 v[104:107], v247 offset:0
    v_mfma_f32_16x16x32_bf16 v[132:135], v[32:35], v[64:67], v[132:135]
    ds_read_b128 v[108:111], v247 offset:2048
    v_mfma_f32_16x16x32_bf16 v[136:139], v[32:35], v[68:71], v[136:139]
    ds_read_b128 v[112:115], v247 offset:4096
    v_mfma_f32_16x16x32_bf16 v[140:143], v[32:35], v[72:75], v[140:143]
    ds_read_b128 v[116:119], v247 offset:6144
    v_mfma_f32_16x16x32_bf16 v[144:147], v[36:39], v[60:63], v[144:147]
    ds_read_b64_tr_b16 v[76:77], v240 offset:14336
    v_mfma_f32_16x16x32_bf16 v[148:151], v[36:39], v[64:67], v[148:151]
    ds_read_b64_tr_b16 v[78:79], v240 offset:16128
    v_mfma_f32_16x16x32_bf16 v[152:155], v[36:39], v[68:71], v[152:155]
    ds_read_b64_tr_b16 v[80:81], v241 offset:14368
    v_mfma_f32_16x16x32_bf16 v[156:159], v[36:39], v[72:75], v[156:159]
    ds_read_b64_tr_b16 v[82:83], v241 offset:16160
    v_mfma_f32_16x16x32_bf16 v[160:163], v[40:43], v[60:63], v[160:163]
    ds_read_b64_tr_b16 v[84:85], v240 offset:14400
    v_mfma_f32_16x16x32_bf16 v[164:167], v[40:43], v[64:67], v[164:167]
    ds_read_b64_tr_b16 v[86:87], v240 offset:16192
    v_mfma_f32_16x16x32_bf16 v[168:171], v[40:43], v[68:71], v[168:171]
    ds_read_b64_tr_b16 v[88:89], v241 offset:14432
    v_mfma_f32_16x16x32_bf16 v[172:175], v[40:43], v[72:75], v[172:175]
    ds_read_b64_tr_b16 v[90:91], v241 offset:16224
    v_mfma_f32_16x16x32_bf16 v[176:179], v[44:47], v[60:63], v[176:179]
    ds_read_b64_tr_b16 v[92:93], v240 offset:14464
    v_mfma_f32_16x16x32_bf16 v[180:183], v[44:47], v[64:67], v[180:183]
    ds_read_b64_tr_b16 v[94:95], v240 offset:16256
    v_mfma_f32_16x16x32_bf16 v[184:187], v[44:47], v[68:71], v[184:187]
    ds_read_b64_tr_b16 v[96:97], v241 offset:14496
    v_mfma_f32_16x16x32_bf16 v[188:191], v[44:47], v[72:75], v[188:191]
    ds_read_b64_tr_b16 v[98:99], v241 offset:16288
    v_mfma_f32_16x16x32_bf16 v[192:195], v[48:51], v[60:63], v[192:195]
    ds_read_b64_tr_b16 v[100:101], v240 offset:14528
    v_mfma_f32_16x16x32_bf16 v[196:199], v[48:51], v[64:67], v[196:199]
    ds_read_b64_tr_b16 v[102:103], v240 offset:16320
    v_mfma_f32_16x16x32_bf16 v[200:203], v[48:51], v[68:71], v[200:203]
    v_mfma_f32_16x16x32_bf16 v[204:207], v[48:51], v[72:75], v[204:207]
    v_mfma_f32_16x16x32_bf16 v[208:211], v[52:55], v[60:63], v[208:211]
    v_mfma_f32_16x16x32_bf16 v[212:215], v[52:55], v[64:67], v[212:215]
    v_mfma_f32_16x16x32_bf16 v[216:219], v[52:55], v[68:71], v[216:219]
    v_mfma_f32_16x16x32_bf16 v[220:223], v[52:55], v[72:75], v[220:223]
    v_mfma_f32_16x16x32_bf16 v[224:227], v[56:59], v[60:63], v[224:227]
    v_mfma_f32_16x16x32_bf16 v[228:231], v[56:59], v[64:67], v[228:231]
    v_mfma_f32_16x16x32_bf16 v[232:235], v[56:59], v[68:71], v[232:235]
    v_mfma_f32_16x16x32_bf16 v[236:239], v[56:59], v[72:75], v[236:239]
    s_waitcnt lgkmcnt(0)
    v_mfma_f32_16x16x32_bf16 v[128:131], v[76:79], v[104:107], v[128:131]
    v_mfma_f32_16x16x32_bf16 v[132:135], v[76:79], v[108:111], v[132:135]
    v_mfma_f32_16x16x32_bf16 v[136:139], v[76:79], v[112:115], v[136:139]
    s_barrier
    ds_read_b128 v[60:63], v248 offset:0
    v_mfma_f32_16x16x32_bf16 v[140:143], v[76:79], v[116:119], v[140:143]
    ds_read_b128 v[64:67], v248 offset:2048
    v_mfma_f32_16x16x32_bf16 v[144:147], v[80:83], v[104:107], v[144:147]
    ds_read_b128 v[68:71], v248 offset:4096
    v_mfma_f32_16x16x32_bf16 v[148:151], v[80:83], v[108:111], v[148:151]
    ds_read_b128 v[72:75], v248 offset:6144
    v_mfma_f32_16x16x32_bf16 v[152:155], v[80:83], v[112:115], v[152:155]
    ds_read_b64_tr_b16 v[32:33], v242 offset:0
    v_mfma_f32_16x16x32_bf16 v[156:159], v[80:83], v[116:119], v[156:159]
    ds_read_b64_tr_b16 v[34:35], v242 offset:1792
    v_mfma_f32_16x16x32_bf16 v[160:163], v[84:87], v[104:107], v[160:163]
    ds_read_b64_tr_b16 v[36:37], v243 offset:32
    v_mfma_f32_16x16x32_bf16 v[164:167], v[84:87], v[108:111], v[164:167]
    ds_read_b64_tr_b16 v[38:39], v243 offset:1824
    v_mfma_f32_16x16x32_bf16 v[168:171], v[84:87], v[112:115], v[168:171]
    ds_read_b64_tr_b16 v[40:41], v242 offset:64
    v_mfma_f32_16x16x32_bf16 v[172:175], v[84:87], v[116:119], v[172:175]
    ds_read_b64_tr_b16 v[42:43], v242 offset:1856
    v_mfma_f32_16x16x32_bf16 v[176:179], v[88:91], v[104:107], v[176:179]
    ds_read_b64_tr_b16 v[44:45], v243 offset:96
    v_mfma_f32_16x16x32_bf16 v[180:183], v[88:91], v[108:111], v[180:183]
    ds_read_b64_tr_b16 v[46:47], v243 offset:1888
    v_mfma_f32_16x16x32_bf16 v[184:187], v[88:91], v[112:115], v[184:187]
    ds_read_b64_tr_b16 v[48:49], v242 offset:128
    v_mfma_f32_16x16x32_bf16 v[188:191], v[88:91], v[116:119], v[188:191]
    ds_read_b64_tr_b16 v[50:51], v242 offset:1920
    v_mfma_f32_16x16x32_bf16 v[192:195], v[92:95], v[104:107], v[192:195]
    ds_read_b64_tr_b16 v[52:53], v243 offset:160
    v_mfma_f32_16x16x32_bf16 v[196:199], v[92:95], v[108:111], v[196:199]
    ds_read_b64_tr_b16 v[54:55], v243 offset:1952
    v_mfma_f32_16x16x32_bf16 v[200:203], v[92:95], v[112:115], v[200:203]
    ds_read_b64_tr_b16 v[56:57], v242 offset:192
    v_mfma_f32_16x16x32_bf16 v[204:207], v[92:95], v[116:119], v[204:207]
    ds_read_b64_tr_b16 v[58:59], v242 offset:1984
    v_mfma_f32_16x16x32_bf16 v[208:211], v[96:99], v[104:107], v[208:211]
    v_mfma_f32_16x16x32_bf16 v[212:215], v[96:99], v[108:111], v[212:215]
    v_mfma_f32_16x16x32_bf16 v[216:219], v[96:99], v[112:115], v[216:219]
    v_mfma_f32_16x16x32_bf16 v[220:223], v[96:99], v[116:119], v[220:223]
    v_mfma_f32_16x16x32_bf16 v[224:227], v[100:103], v[104:107], v[224:227]
    v_mfma_f32_16x16x32_bf16 v[228:231], v[100:103], v[108:111], v[228:231]
    v_mfma_f32_16x16x32_bf16 v[232:235], v[100:103], v[112:115], v[232:235]
    v_mfma_f32_16x16x32_bf16 v[236:239], v[100:103], v[116:119], v[236:239]
    s_waitcnt lgkmcnt(0)
    v_mfma_f32_16x16x32_bf16 v[128:131], v[32:35], v[60:63], v[128:131]
    ds_read_b128 v[104:107], v249 offset:0
    v_mfma_f32_16x16x32_bf16 v[132:135], v[32:35], v[64:67], v[132:135]
    ds_read_b128 v[108:111], v249 offset:2048
    v_mfma_f32_16x16x32_bf16 v[136:139], v[32:35], v[68:71], v[136:139]
    ds_read_b128 v[112:115], v249 offset:4096
    v_mfma_f32_16x16x32_bf16 v[140:143], v[32:35], v[72:75], v[140:143]
    ds_read_b128 v[116:119], v249 offset:6144
    v_mfma_f32_16x16x32_bf16 v[144:147], v[36:39], v[60:63], v[144:147]
    ds_read_b64_tr_b16 v[76:77], v242 offset:14336
    v_mfma_f32_16x16x32_bf16 v[148:151], v[36:39], v[64:67], v[148:151]
    ds_read_b64_tr_b16 v[78:79], v242 offset:16128
    v_mfma_f32_16x16x32_bf16 v[152:155], v[36:39], v[68:71], v[152:155]
    ds_read_b64_tr_b16 v[80:81], v243 offset:14368
    v_mfma_f32_16x16x32_bf16 v[156:159], v[36:39], v[72:75], v[156:159]
    ds_read_b64_tr_b16 v[82:83], v243 offset:16160
    v_mfma_f32_16x16x32_bf16 v[160:163], v[40:43], v[60:63], v[160:163]
    ds_read_b64_tr_b16 v[84:85], v242 offset:14400
    v_mfma_f32_16x16x32_bf16 v[164:167], v[40:43], v[64:67], v[164:167]
    ds_read_b64_tr_b16 v[86:87], v242 offset:16192
    v_mfma_f32_16x16x32_bf16 v[168:171], v[40:43], v[68:71], v[168:171]
    ds_read_b64_tr_b16 v[88:89], v243 offset:14432
    v_mfma_f32_16x16x32_bf16 v[172:175], v[40:43], v[72:75], v[172:175]
    ds_read_b64_tr_b16 v[90:91], v243 offset:16224
    v_mfma_f32_16x16x32_bf16 v[176:179], v[44:47], v[60:63], v[176:179]
    ds_read_b64_tr_b16 v[92:93], v242 offset:14464
    v_mfma_f32_16x16x32_bf16 v[180:183], v[44:47], v[64:67], v[180:183]
    ds_read_b64_tr_b16 v[94:95], v242 offset:16256
    v_mfma_f32_16x16x32_bf16 v[184:187], v[44:47], v[68:71], v[184:187]
    ds_read_b64_tr_b16 v[96:97], v243 offset:14496
    v_mfma_f32_16x16x32_bf16 v[188:191], v[44:47], v[72:75], v[188:191]
    ds_read_b64_tr_b16 v[98:99], v243 offset:16288
    v_mfma_f32_16x16x32_bf16 v[192:195], v[48:51], v[60:63], v[192:195]
    ds_read_b64_tr_b16 v[100:101], v242 offset:14528
    v_mfma_f32_16x16x32_bf16 v[196:199], v[48:51], v[64:67], v[196:199]
    ds_read_b64_tr_b16 v[102:103], v242 offset:16320
    v_mfma_f32_16x16x32_bf16 v[200:203], v[48:51], v[68:71], v[200:203]
    v_mfma_f32_16x16x32_bf16 v[204:207], v[48:51], v[72:75], v[204:207]
    v_mfma_f32_16x16x32_bf16 v[208:211], v[52:55], v[60:63], v[208:211]
    v_mfma_f32_16x16x32_bf16 v[212:215], v[52:55], v[64:67], v[212:215]
    v_mfma_f32_16x16x32_bf16 v[216:219], v[52:55], v[68:71], v[216:219]
    v_mfma_f32_16x16x32_bf16 v[220:223], v[52:55], v[72:75], v[220:223]
    v_mfma_f32_16x16x32_bf16 v[224:227], v[56:59], v[60:63], v[224:227]
    v_mfma_f32_16x16x32_bf16 v[228:231], v[56:59], v[64:67], v[228:231]
    v_mfma_f32_16x16x32_bf16 v[232:235], v[56:59], v[68:71], v[232:235]
    v_mfma_f32_16x16x32_bf16 v[236:239], v[56:59], v[72:75], v[236:239]
    s_waitcnt lgkmcnt(0)
    v_mfma_f32_16x16x32_bf16 v[128:131], v[76:79], v[104:107], v[128:131]
    v_mfma_f32_16x16x32_bf16 v[132:135], v[76:79], v[108:111], v[132:135]
    v_mfma_f32_16x16x32_bf16 v[136:139], v[76:79], v[112:115], v[136:139]
    s_barrier
    ds_read_b128 v[60:63], v250 offset:0
    v_mfma_f32_16x16x32_bf16 v[140:143], v[76:79], v[116:119], v[140:143]
    ds_read_b128 v[64:67], v250 offset:2048
    v_mfma_f32_16x16x32_bf16 v[144:147], v[80:83], v[104:107], v[144:147]
    ds_read_b128 v[68:71], v250 offset:4096
    v_mfma_f32_16x16x32_bf16 v[148:151], v[80:83], v[108:111], v[148:151]
    ds_read_b128 v[72:75], v250 offset:6144
    v_mfma_f32_16x16x32_bf16 v[152:155], v[80:83], v[112:115], v[152:155]
    ds_read_b64_tr_b16 v[32:33], v244 offset:0
    v_mfma_f32_16x16x32_bf16 v[156:159], v[80:83], v[116:119], v[156:159]
    ds_read_b64_tr_b16 v[34:35], v244 offset:1792
    v_mfma_f32_16x16x32_bf16 v[160:163], v[84:87], v[104:107], v[160:163]
    ds_read_b64_tr_b16 v[36:37], v245 offset:32
    v_mfma_f32_16x16x32_bf16 v[164:167], v[84:87], v[108:111], v[164:167]
    ds_read_b64_tr_b16 v[38:39], v245 offset:1824
    v_mfma_f32_16x16x32_bf16 v[168:171], v[84:87], v[112:115], v[168:171]
    ds_read_b64_tr_b16 v[40:41], v244 offset:64
    v_mfma_f32_16x16x32_bf16 v[172:175], v[84:87], v[116:119], v[172:175]
    ds_read_b64_tr_b16 v[42:43], v244 offset:1856
    v_mfma_f32_16x16x32_bf16 v[176:179], v[88:91], v[104:107], v[176:179]
    ds_read_b64_tr_b16 v[44:45], v245 offset:96
    v_mfma_f32_16x16x32_bf16 v[180:183], v[88:91], v[108:111], v[180:183]
    ds_read_b64_tr_b16 v[46:47], v245 offset:1888
    v_mfma_f32_16x16x32_bf16 v[184:187], v[88:91], v[112:115], v[184:187]
    ds_read_b64_tr_b16 v[48:49], v244 offset:128
    v_mfma_f32_16x16x32_bf16 v[188:191], v[88:91], v[116:119], v[188:191]
    ds_read_b64_tr_b16 v[50:51], v244 offset:1920
    v_mfma_f32_16x16x32_bf16 v[192:195], v[92:95], v[104:107], v[192:195]
    ds_read_b64_tr_b16 v[52:53], v245 offset:160
    v_mfma_f32_16x16x32_bf16 v[196:199], v[92:95], v[108:111], v[196:199]
    ds_read_b64_tr_b16 v[54:55], v245 offset:1952
    v_mfma_f32_16x16x32_bf16 v[200:203], v[92:95], v[112:115], v[200:203]
    ds_read_b64_tr_b16 v[56:57], v244 offset:192
    v_mfma_f32_16x16x32_bf16 v[204:207], v[92:95], v[116:119], v[204:207]
    ds_read_b64_tr_b16 v[58:59], v244 offset:1984
    v_mfma_f32_16x16x32_bf16 v[208:211], v[96:99], v[104:107], v[208:211]
    v_mfma_f32_16x16x32_bf16 v[212:215], v[96:99], v[108:111], v[212:215]
    v_mfma_f32_16x16x32_bf16 v[216:219], v[96:99], v[112:115], v[216:219]
    v_mfma_f32_16x16x32_bf16 v[220:223], v[96:99], v[116:119], v[220:223]
    v_mfma_f32_16x16x32_bf16 v[224:227], v[100:103], v[104:107], v[224:227]
    v_mfma_f32_16x16x32_bf16 v[228:231], v[100:103], v[108:111], v[228:231]
    v_mfma_f32_16x16x32_bf16 v[232:235], v[100:103], v[112:115], v[232:235]
    v_mfma_f32_16x16x32_bf16 v[236:239], v[100:103], v[116:119], v[236:239]
    s_waitcnt lgkmcnt(0)
    v_mfma_f32_16x16x32_bf16 v[128:131], v[32:35], v[60:63], v[128:131]
    ds_read_b128 v[104:107], v251 offset:0
    v_mfma_f32_16x16x32_bf16 v[132:135], v[32:35], v[64:67], v[132:135]
    ds_read_b128 v[108:111], v251 offset:2048
    v_mfma_f32_16x16x32_bf16 v[136:139], v[32:35], v[68:71], v[136:139]
    ds_read_b128 v[112:115], v251 offset:4096
    v_mfma_f32_16x16x32_bf16 v[140:143], v[32:35], v[72:75], v[140:143]
    ds_read_b128 v[116:119], v251 offset:6144
    v_mfma_f32_16x16x32_bf16 v[144:147], v[36:39], v[60:63], v[144:147]
    ds_read_b64_tr_b16 v[76:77], v244 offset:14336
    v_mfma_f32_16x16x32_bf16 v[148:151], v[36:39], v[64:67], v[148:151]
    ds_read_b64_tr_b16 v[78:79], v244 offset:16128
    v_mfma_f32_16x16x32_bf16 v[152:155], v[36:39], v[68:71], v[152:155]
    ds_read_b64_tr_b16 v[80:81], v245 offset:14368
    v_mfma_f32_16x16x32_bf16 v[156:159], v[36:39], v[72:75], v[156:159]
    ds_read_b64_tr_b16 v[82:83], v245 offset:16160
    v_mfma_f32_16x16x32_bf16 v[160:163], v[40:43], v[60:63], v[160:163]
    ds_read_b64_tr_b16 v[84:85], v244 offset:14400
    v_mfma_f32_16x16x32_bf16 v[164:167], v[40:43], v[64:67], v[164:167]
    ds_read_b64_tr_b16 v[86:87], v244 offset:16192
    v_mfma_f32_16x16x32_bf16 v[168:171], v[40:43], v[68:71], v[168:171]
    ds_read_b64_tr_b16 v[88:89], v245 offset:14432
    v_mfma_f32_16x16x32_bf16 v[172:175], v[40:43], v[72:75], v[172:175]
    ds_read_b64_tr_b16 v[90:91], v245 offset:16224
    v_mfma_f32_16x16x32_bf16 v[176:179], v[44:47], v[60:63], v[176:179]
    ds_read_b64_tr_b16 v[92:93], v244 offset:14464
    v_mfma_f32_16x16x32_bf16 v[180:183], v[44:47], v[64:67], v[180:183]
    ds_read_b64_tr_b16 v[94:95], v244 offset:16256
    v_mfma_f32_16x16x32_bf16 v[184:187], v[44:47], v[68:71], v[184:187]
    ds_read_b64_tr_b16 v[96:97], v245 offset:14496
    v_mfma_f32_16x16x32_bf16 v[188:191], v[44:47], v[72:75], v[188:191]
    ds_read_b64_tr_b16 v[98:99], v245 offset:16288
    v_mfma_f32_16x16x32_bf16 v[192:195], v[48:51], v[60:63], v[192:195]
    ds_read_b64_tr_b16 v[100:101], v244 offset:14528
    v_mfma_f32_16x16x32_bf16 v[196:199], v[48:51], v[64:67], v[196:199]
    ds_read_b64_tr_b16 v[102:103], v244 offset:16320
    v_mfma_f32_16x16x32_bf16 v[200:203], v[48:51], v[68:71], v[200:203]
    v_mfma_f32_16x16x32_bf16 v[204:207], v[48:51], v[72:75], v[204:207]
    v_mfma_f32_16x16x32_bf16 v[208:211], v[52:55], v[60:63], v[208:211]
    v_mfma_f32_16x16x32_bf16 v[212:215], v[52:55], v[64:67], v[212:215]
    v_mfma_f32_16x16x32_bf16 v[216:219], v[52:55], v[68:71], v[216:219]
    v_mfma_f32_16x16x32_bf16 v[220:223], v[52:55], v[72:75], v[220:223]
    v_mfma_f32_16x16x32_bf16 v[224:227], v[56:59], v[60:63], v[224:227]
    v_mfma_f32_16x16x32_bf16 v[228:231], v[56:59], v[64:67], v[228:231]
    v_mfma_f32_16x16x32_bf16 v[232:235], v[56:59], v[68:71], v[232:235]
    v_mfma_f32_16x16x32_bf16 v[236:239], v[56:59], v[72:75], v[236:239]
    s_waitcnt lgkmcnt(0)
    v_mfma_f32_16x16x32_bf16 v[128:131], v[76:79], v[104:107], v[128:131]
    v_mfma_f32_16x16x32_bf16 v[132:135], v[76:79], v[108:111], v[132:135]
    v_mfma_f32_16x16x32_bf16 v[136:139], v[76:79], v[112:115], v[136:139]
    s_barrier
    ds_read_b128 v[60:63], v246 offset:0
    v_mfma_f32_16x16x32_bf16 v[140:143], v[76:79], v[116:119], v[140:143]
    ds_read_b128 v[64:67], v246 offset:2048
    v_mfma_f32_16x16x32_bf16 v[144:147], v[80:83], v[104:107], v[144:147]
    ds_read_b128 v[68:71], v246 offset:4096
    v_mfma_f32_16x16x32_bf16 v[148:151], v[80:83], v[108:111], v[148:151]
    ds_read_b128 v[72:75], v246 offset:6144
    v_mfma_f32_16x16x32_bf16 v[152:155], v[80:83], v[112:115], v[152:155]
    ds_read_b64_tr_b16 v[32:33], v240 offset:0
    v_mfma_f32_16x16x32_bf16 v[156:159], v[80:83], v[116:119], v[156:159]
    ds_read_b64_tr_b16 v[34:35], v240 offset:1792
    v_mfma_f32_16x16x32_bf16 v[160:163], v[84:87], v[104:107], v[160:163]
    ds_read_b64_tr_b16 v[36:37], v241 offset:32
    v_mfma_f32_16x16x32_bf16 v[164:167], v[84:87], v[108:111], v[164:167]
    ds_read_b64_tr_b16 v[38:39], v241 offset:1824
    v_mfma_f32_16x16x32_bf16 v[168:171], v[84:87], v[112:115], v[168:171]
    ds_read_b64_tr_b16 v[40:41], v240 offset:64
    v_mfma_f32_16x16x32_bf16 v[172:175], v[84:87], v[116:119], v[172:175]
    ds_read_b64_tr_b16 v[42:43], v240 offset:1856
    v_mfma_f32_16x16x32_bf16 v[176:179], v[88:91], v[104:107], v[176:179]
    ds_read_b64_tr_b16 v[44:45], v241 offset:96
    v_mfma_f32_16x16x32_bf16 v[180:183], v[88:91], v[108:111], v[180:183]
    ds_read_b64_tr_b16 v[46:47], v241 offset:1888
    v_mfma_f32_16x16x32_bf16 v[184:187], v[88:91], v[112:115], v[184:187]
    ds_read_b64_tr_b16 v[48:49], v240 offset:128
    v_mfma_f32_16x16x32_bf16 v[188:191], v[88:91], v[116:119], v[188:191]
    ds_read_b64_tr_b16 v[50:51], v240 offset:1920
    v_mfma_f32_16x16x32_bf16 v[192:195], v[92:95], v[104:107], v[192:195]
    ds_read_b64_tr_b16 v[52:53], v241 offset:160
    v_mfma_f32_16x16x32_bf16 v[196:199], v[92:95], v[108:111], v[196:199]
    ds_read_b64_tr_b16 v[54:55], v241 offset:1952
    v_mfma_f32_16x16x32_bf16 v[200:203], v[92:95], v[112:115], v[200:203]
    ds_read_b64_tr_b16 v[56:57], v240 offset:192
    v_mfma_f32_16x16x32_bf16 v[204:207], v[92:95], v[116:119], v[204:207]
    ds_read_b64_tr_b16 v[58:59], v240 offset:1984
    v_mfma_f32_16x16x32_bf16 v[208:211], v[96:99], v[104:107], v[208:211]
    v_mfma_f32_16x16x32_bf16 v[212:215], v[96:99], v[108:111], v[212:215]
    v_mfma_f32_16x16x32_bf16 v[216:219], v[96:99], v[112:115], v[216:219]
    v_mfma_f32_16x16x32_bf16 v[220:223], v[96:99], v[116:119], v[220:223]
    v_mfma_f32_16x16x32_bf16 v[224:227], v[100:103], v[104:107], v[224:227]
    v_mfma_f32_16x16x32_bf16 v[228:231], v[100:103], v[108:111], v[228:231]
    v_mfma_f32_16x16x32_bf16 v[232:235], v[100:103], v[112:115], v[232:235]
    v_mfma_f32_16x16x32_bf16 v[236:239], v[100:103], v[116:119], v[236:239]
    s_waitcnt lgkmcnt(0)
    v_mfma_f32_16x16x32_bf16 v[128:131], v[32:35], v[60:63], v[128:131]
    ds_read_b128 v[104:107], v247 offset:0
    v_mfma_f32_16x16x32_bf16 v[132:135], v[32:35], v[64:67], v[132:135]
    ds_read_b128 v[108:111], v247 offset:2048
    v_mfma_f32_16x16x32_bf16 v[136:139], v[32:35], v[68:71], v[136:139]
    ds_read_b128 v[112:115], v247 offset:4096
    v_mfma_f32_16x16x32_bf16 v[140:143], v[32:35], v[72:75], v[140:143]
    ds_read_b128 v[116:119], v247 offset:6144
    v_mfma_f32_16x16x32_bf16 v[144:147], v[36:39], v[60:63], v[144:147]
    ds_read_b64_tr_b16 v[76:77], v240 offset:14336
    v_mfma_f32_16x16x32_bf16 v[148:151], v[36:39], v[64:67], v[148:151]
    ds_read_b64_tr_b16 v[78:79], v240 offset:16128
    v_mfma_f32_16x16x32_bf16 v[152:155], v[36:39], v[68:71], v[152:155]
    ds_read_b64_tr_b16 v[80:81], v241 offset:14368
    v_mfma_f32_16x16x32_bf16 v[156:159], v[36:39], v[72:75], v[156:159]
    ds_read_b64_tr_b16 v[82:83], v241 offset:16160
    v_mfma_f32_16x16x32_bf16 v[160:163], v[40:43], v[60:63], v[160:163]
    ds_read_b64_tr_b16 v[84:85], v240 offset:14400
    v_mfma_f32_16x16x32_bf16 v[164:167], v[40:43], v[64:67], v[164:167]
    ds_read_b64_tr_b16 v[86:87], v240 offset:16192
    v_mfma_f32_16x16x32_bf16 v[168:171], v[40:43], v[68:71], v[168:171]
    ds_read_b64_tr_b16 v[88:89], v241 offset:14432
    v_mfma_f32_16x16x32_bf16 v[172:175], v[40:43], v[72:75], v[172:175]
    ds_read_b64_tr_b16 v[90:91], v241 offset:16224
    v_mfma_f32_16x16x32_bf16 v[176:179], v[44:47], v[60:63], v[176:179]
    ds_read_b64_tr_b16 v[92:93], v240 offset:14464
    v_mfma_f32_16x16x32_bf16 v[180:183], v[44:47], v[64:67], v[180:183]
    ds_read_b64_tr_b16 v[94:95], v240 offset:16256
    v_mfma_f32_16x16x32_bf16 v[184:187], v[44:47], v[68:71], v[184:187]
    ds_read_b64_tr_b16 v[96:97], v241 offset:14496
    v_mfma_f32_16x16x32_bf16 v[188:191], v[44:47], v[72:75], v[188:191]
    ds_read_b64_tr_b16 v[98:99], v241 offset:16288
    v_mfma_f32_16x16x32_bf16 v[192:195], v[48:51], v[60:63], v[192:195]
    ds_read_b64_tr_b16 v[100:101], v240 offset:14528
    v_mfma_f32_16x16x32_bf16 v[196:199], v[48:51], v[64:67], v[196:199]
    ds_read_b64_tr_b16 v[102:103], v240 offset:16320
    v_mfma_f32_16x16x32_bf16 v[200:203], v[48:51], v[68:71], v[200:203]
    v_mfma_f32_16x16x32_bf16 v[204:207], v[48:51], v[72:75], v[204:207]
    v_mfma_f32_16x16x32_bf16 v[208:211], v[52:55], v[60:63], v[208:211]
    v_mfma_f32_16x16x32_bf16 v[212:215], v[52:55], v[64:67], v[212:215]
    v_mfma_f32_16x16x32_bf16 v[216:219], v[52:55], v[68:71], v[216:219]
    v_mfma_f32_16x16x32_bf16 v[220:223], v[52:55], v[72:75], v[220:223]
    v_mfma_f32_16x16x32_bf16 v[224:227], v[56:59], v[60:63], v[224:227]
    v_mfma_f32_16x16x32_bf16 v[228:231], v[56:59], v[64:67], v[228:231]
    v_mfma_f32_16x16x32_bf16 v[232:235], v[56:59], v[68:71], v[232:235]
    v_mfma_f32_16x16x32_bf16 v[236:239], v[56:59], v[72:75], v[236:239]
    s_waitcnt lgkmcnt(0)
    v_mfma_f32_16x16x32_bf16 v[128:131], v[76:79], v[104:107], v[128:131]
    v_mfma_f32_16x16x32_bf16 v[132:135], v[76:79], v[108:111], v[132:135]
    v_mfma_f32_16x16x32_bf16 v[136:139], v[76:79], v[112:115], v[136:139]
    v_mfma_f32_16x16x32_bf16 v[140:143], v[76:79], v[116:119], v[140:143]
    v_mfma_f32_16x16x32_bf16 v[144:147], v[80:83], v[104:107], v[144:147]
    v_mfma_f32_16x16x32_bf16 v[148:151], v[80:83], v[108:111], v[148:151]
    v_mfma_f32_16x16x32_bf16 v[152:155], v[80:83], v[112:115], v[152:155]
    v_mfma_f32_16x16x32_bf16 v[156:159], v[80:83], v[116:119], v[156:159]
    v_mfma_f32_16x16x32_bf16 v[160:163], v[84:87], v[104:107], v[160:163]
    v_mfma_f32_16x16x32_bf16 v[164:167], v[84:87], v[108:111], v[164:167]
    v_mfma_f32_16x16x32_bf16 v[168:171], v[84:87], v[112:115], v[168:171]
    v_mfma_f32_16x16x32_bf16 v[172:175], v[84:87], v[116:119], v[172:175]
    v_mfma_f32_16x16x32_bf16 v[176:179], v[88:91], v[104:107], v[176:179]
    v_mfma_f32_16x16x32_bf16 v[180:183], v[88:91], v[108:111], v[180:183]
    v_mfma_f32_16x16x32_bf16 v[184:187], v[88:91], v[112:115], v[184:187]
    v_mfma_f32_16x16x32_bf16 v[188:191], v[88:91], v[116:119], v[188:191]
    v_mfma_f32_16x16x32_bf16 v[192:195], v[92:95], v[104:107], v[192:195]
    v_mfma_f32_16x16x32_bf16 v[196:199], v[92:95], v[108:111], v[196:199]
    v_mfma_f32_16x16x32_bf16 v[200:203], v[92:95], v[112:115], v[200:203]
    v_mfma_f32_16x16x32_bf16 v[204:207], v[92:95], v[116:119], v[204:207]
    v_mfma_f32_16x16x32_bf16 v[208:211], v[96:99], v[104:107], v[208:211]
    v_mfma_f32_16x16x32_bf16 v[212:215], v[96:99], v[108:111], v[212:215]
    v_mfma_f32_16x16x32_bf16 v[216:219], v[96:99], v[112:115], v[216:219]
    v_mfma_f32_16x16x32_bf16 v[220:223], v[96:99], v[116:119], v[220:223]
    v_mfma_f32_16x16x32_bf16 v[224:227], v[100:103], v[104:107], v[224:227]
    v_mfma_f32_16x16x32_bf16 v[228:231], v[100:103], v[108:111], v[228:231]
    v_mfma_f32_16x16x32_bf16 v[232:235], v[100:103], v[112:115], v[232:235]
    v_mfma_f32_16x16x32_bf16 v[236:239], v[100:103], v[116:119], v[236:239]
    s_waitcnt vmcnt(0)
    s_barrier
    s_lshl_b32 s57, s53, 10
    v_lshlrev_b32 v17, 6, v6
    v_add_u32 v17, s57, v17
    ds_read_b64 v[32:33], v17 offset:0
    ds_read_b64 v[34:35], v17 offset:16
    ds_read_b64 v[36:37], v17 offset:32
    ds_read_b64 v[38:39], v17 offset:48
    s_mul_i32 s57, s52, 448
    v_lshlrev_b32 v18, 4, v5
    v_add_u32 v18, s57, v18
    ds_read_b128 v[40:43], v18 offset:2048
    ds_read_b128 v[44:47], v18 offset:2112
    ds_read_b128 v[48:51], v18 offset:2176
    ds_read_b128 v[52:55], v18 offset:2240
    ds_read_b128 v[56:59], v18 offset:2304
    ds_read_b128 v[60:63], v18 offset:2368
    ds_read_b128 v[64:67], v18 offset:2432
    s_lshr_b32 s57, s54, 1
    s_mul_i32 s58, s50, 54
    s_add_u32 s57, s57, s58
    s_lshl_b32 s57, s57, 3
    s_lshl_b32 s58, s53, 2
    s_add_u32 s57, s57, s58
    s_lshl_b32 s57, s57, 10
    s_add_u32 s65, s57, 12582912
    v_lshlrev_b32 v17, 4, v0
    s_lshl_b32 s57, s53, 11
    s_add_u32 s57, s57, 157184
    v_lshlrev_b32 v19, 3, v0
    v_add_u32 v19, s57, v19
    s_waitcnt lgkmcnt(0)
    s_cmp_lg_u32 s52, 0
    s_cbranch_scc1 ep1_11
    v_pk_fma_f32 v[224:225], v[64:65], v[32:33], v[224:225] op_sel:[0,0,0] op_sel_hi:[1,0,1] neg_lo:[1,0,0] neg_hi:[1,0,0]
    v_pk_fma_f32 v[226:227], v[66:67], v[32:33], v[226:227] op_sel:[0,0,0] op_sel_hi:[1,0,1] neg_lo:[1,0,0] neg_hi:[1,0,0]
    v_pk_mul_f32 v[224:225], v[224:225], v[32:33] op_sel:[0,1] op_sel_hi:[1,1]
    v_pk_mul_f32 v[226:227], v[226:227], v[32:33] op_sel:[0,1] op_sel_hi:[1,1]
    v_cvt_pk_bf16_f32 v72, v224, v225
    v_cvt_pk_bf16_f32 v73, v226, v227
    v_pk_max_i16 v72, v72, 0
    v_pk_max_i16 v73, v73, 0
    ds_write_b64 v19, v[72:73] offset:0
    v_pk_fma_f32 v[228:229], v[64:65], v[34:35], v[228:229] op_sel:[0,0,0] op_sel_hi:[1,0,1] neg_lo:[1,0,0] neg_hi:[1,0,0]
    v_pk_fma_f32 v[230:231], v[66:67], v[34:35], v[230:231] op_sel:[0,0,0] op_sel_hi:[1,0,1] neg_lo:[1,0,0] neg_hi:[1,0,0]
    v_pk_mul_f32 v[228:229], v[228:229], v[34:35] op_sel:[0,1] op_sel_hi:[1,1]
    v_pk_mul_f32 v[230:231], v[230:231], v[34:35] op_sel:[0,1] op_sel_hi:[1,1]
    v_cvt_pk_bf16_f32 v74, v228, v229
    v_cvt_pk_bf16_f32 v75, v230, v231
    v_pk_max_i16 v74, v74, 0
    v_pk_max_i16 v75, v75, 0
    ds_write_b64 v19, v[74:75] offset:512
    v_pk_fma_f32 v[232:233], v[64:65], v[36:37], v[232:233] op_sel:[0,0,0] op_sel_hi:[1,0,1] neg_lo:[1,0,0] neg_hi:[1,0,0]
    v_pk_fma_f32 v[234:235], v[66:67], v[36:37], v[234:235] op_sel:[0,0,0] op_sel_hi:[1,0,1] neg_lo:[1,0,0] neg_hi:[1,0,0]
    v_pk_mul_f32 v[232:233], v[232:233], v[36:37] op_sel:[0,1] op_sel_hi:[1,1]
    v_pk_mul_f32 v[234:235], v[234:235], v[36:37] op_sel:[0,1] op_sel_hi:[1,1]
    v_cvt_pk_bf16_f32 v76, v232, v233
    v_cvt_pk_bf16_f32 v77, v234, v235
    v_pk_max_i16 v76, v76, 0
    v_pk_max_i16 v77, v77, 0
    ds_write_b64 v19, v[76:77] offset:1024
    v_pk_fma_f32 v[236:237], v[64:65], v[38:39], v[236:237] op_sel:[0,0,0] op_sel_hi:[1,0,1] neg_lo:[1,0,0] neg_hi:[1,0,0]
    v_pk_fma_f32 v[238:239], v[66:67], v[38:39], v[238:239] op_sel:[0,0,0] op_sel_hi:[1,0,1] neg_lo:[1,0,0] neg_hi:[1,0,0]
    v_pk_mul_f32 v[236:237], v[236:237], v[38:39] op_sel:[0,1] op_sel_hi:[1,1]
    v_pk_mul_f32 v[238:239], v[238:239], v[38:39] op_sel:[0,1] op_sel_hi:[1,1]
    v_cvt_pk_bf16_f32 v78, v236, v237
    v_cvt_pk_bf16_f32 v79, v238, v239
    v_pk_max_i16 v78, v78, 0
    v_pk_max_i16 v79, v79, 0
    ds_write_b64 v19, v[78:79] offset:1536
    s_waitcnt lgkmcnt(0)
    s_barrier
    s_add_u32 s57, s65, 0
    v_pk_fma_f32 v[128:129], v[40:41], v[32:33], v[128:129] op_sel:[0,0,0] op_sel_hi:[1,0,1] neg_lo:[1,0,0] neg_hi:[1,0,0]
    v_pk_fma_f32 v[130:131], v[42:43], v[32:33], v[130:131] op_sel:[0,0,0] op_sel_hi:[1,0,1] neg_lo:[1,0,0] neg_hi:[1,0,0]
    v_pk_mul_f32 v[128:129], v[128:129], v[32:33] op_sel:[0,1] op_sel_hi:[1,1]
    v_pk_mul_f32 v[130:131], v[130:131], v[32:33] op_sel:[0,1] op_sel_hi:[1,1]
    v_cvt_pk_bf16_f32 v80, v128, v129
    v_cvt_pk_bf16_f32 v81, v130, v131
    v_pk_max_i16 v80, v80, 0
    v_pk_max_i16 v81, v81, 0
    v_pk_fma_f32 v[144:145], v[44:45], v[32:33], v[144:145] op_sel:[0,0,0] op_sel_hi:[1,0,1] neg_lo:[1,0,0] neg_hi:[1,0,0]
    v_pk_fma_f32 v[146:147], v[46:47], v[32:33], v[146:147] op_sel:[0,0,0] op_sel_hi:[1,0,1] neg_lo:[1,0,0] neg_hi:[1,0,0]
    v_pk_mul_f32 v[144:145], v[144:145], v[32:33] op_sel:[0,1] op_sel_hi:[1,1]
    v_pk_mul_f32 v[146:147], v[146:147], v[32:33] op_sel:[0,1] op_sel_hi:[1,1]
    v_cvt_pk_bf16_f32 v82, v144, v145
    v_cvt_pk_bf16_f32 v83, v146, v147
    v_pk_max_i16 v82, v82, 0
    v_pk_max_i16 v83, v83, 0
    buffer_store_dwordx4 v[80:83], v17, s[44:47], s57 offen offset:0 sc1
    v_pk_fma_f32 v[132:133], v[40:41], v[34:35], v[132:133] op_sel:[0,0,0] op_sel_hi:[1,0,1] neg_lo:[1,0,0] neg_hi:[1,0,0]
    v_pk_fma_f32 v[134:135], v[42:43], v[34:35], v[134:135] op_sel:[0,0,0] op_sel_hi:[1,0,1] neg_lo:[1,0,0] neg_hi:[1,0,0]
    v_pk_mul_f32 v[132:133], v[132:133], v[34:35] op_sel:[0,1] op_sel_hi:[1,1]
    v_pk_mul_f32 v[134:135], v[134:135], v[34:35] op_sel:[0,1] op_sel_hi:[1,1]
    v_cvt_pk_bf16_f32 v84, v132, v133
    v_cvt_pk_bf16_f32 v85, v134, v135
    v_pk_max_i16 v84, v84, 0
    v_pk_max_i16 v85, v85, 0
    v_pk_fma_f32 v[148:149], v[44:45], v[34:35], v[148:149] op_sel:[0,0,0] op_sel_hi:[1,0,1] neg_lo:[1,0,0] neg_hi:[1,0,0]
    v_pk_fma_f32 v[150:151], v[46:47], v[34:35], v[150:151] op_sel:[0,0,0] op_sel_hi:[1,0,1] neg_lo:[1,0,0] neg_hi:[1,0,0]
    v_pk_mul_f32 v[148:149], v[148:149], v[34:35] op_sel:[0,1] op_sel_hi:[1,1]
    v_pk_mul_f32 v[150:151], v[150:151], v[34:35] op_sel:[0,1] op_sel_hi:[1,1]
    v_cvt_pk_bf16_f32 v86, v148, v149
    v_cvt_pk_bf16_f32 v87, v150, v151
    v_pk_max_i16 v86, v86, 0
    v_pk_max_i16 v87, v87, 0
    buffer_store_dwordx4 v[84:87], v17, s[44:47], s57 offen offset:1024 sc1
    v_pk_fma_f32 v[136:137], v[40:41], v[36:37], v[136:137] op_sel:[0,0,0] op_sel_hi:[1,0,1] neg_lo:[1,0,0] neg_hi:[1,0,0]
    v_pk_fma_f32 v[138:139], v[42:43], v[36:37], v[138:139] op_sel:[0,0,0] op_sel_hi:[1,0,1] neg_lo:[1,0,0] neg_hi:[1,0,0]
    v_pk_mul_f32 v[136:137], v[136:137], v[36:37] op_sel:[0,1] op_sel_hi:[1,1]
    v_pk_mul_f32 v[138:139], v[138:139], v[36:37] op_sel:[0,1] op_sel_hi:[1,1]
    v_cvt_pk_bf16_f32 v88, v136, v137
    v_cvt_pk_bf16_f32 v89, v138, v139
    v_pk_max_i16 v88, v88, 0
    v_pk_max_i16 v89, v89, 0
    v_pk_fma_f32 v[152:153], v[44:45], v[36:37], v[152:153] op_sel:[0,0,0] op_sel_hi:[1,0,1] neg_lo:[1,0,0] neg_hi:[1,0,0]
    v_pk_fma_f32 v[154:155], v[46:47], v[36:37], v[154:155] op_sel:[0,0,0] op_sel_hi:[1,0,1] neg_lo:[1,0,0] neg_hi:[1,0,0]
    v_pk_mul_f32 v[152:153], v[152:153], v[36:37] op_sel:[0,1] op_sel_hi:[1,1]
    v_pk_mul_f32 v[154:155], v[154:155], v[36:37] op_sel:[0,1] op_sel_hi:[1,1]
    v_cvt_pk_bf16_f32 v90, v152, v153
    v_cvt_pk_bf16_f32 v91, v154, v155
    v_pk_max_i16 v90, v90, 0
    v_pk_max_i16 v91, v91, 0
    buffer_store_dwordx4 v[88:91], v17, s[44:47], s57 offen offset:2048 sc1
    v_pk_fma_f32 v[140:141], v[40:41], v[38:39], v[140:141] op_sel:[0,0,0] op_sel_hi:[1,0,1] neg_lo:[1,0,0] neg_hi:[1,0,0]
    v_pk_fma_f32 v[142:143], v[42:43], v[38:39], v[142:143] op_sel:[0,0,0] op_sel_hi:[1,0,1] neg_lo:[1,0,0] neg_hi:[1,0,0]
    v_pk_mul_f32 v[140:141], v[140:141], v[38:39] op_sel:[0,1] op_sel_hi:[1,1]
    v_pk_mul_f32 v[142:143], v[142:143], v[38:39] op_sel:[0,1] op_sel_hi:[1,1]
    v_cvt_pk_bf16_f32 v92, v140, v141
    v_cvt_pk_bf16_f32 v93, v142, v143
    v_pk_max_i16 v92, v92, 0
    v_pk_max_i16 v93, v93, 0
    v_pk_fma_f32 v[156:157], v[44:45], v[38:39], v[156:157] op_sel:[0,0,0] op_sel_hi:[1,0,1] neg_lo:[1,0,0] neg_hi:[1,0,0]
    v_pk_fma_f32 v[158:159], v[46:47], v[38:39], v[158:159] op_sel:[0,0,0] op_sel_hi:[1,0,1] neg_lo:[1,0,0] neg_hi:[1,0,0]
    v_pk_mul_f32 v[156:157], v[156:157], v[38:39] op_sel:[0,1] op_sel_hi:[1,1]
    v_pk_mul_f32 v[158:159], v[158:159], v[38:39] op_sel:[0,1] op_sel_hi:[1,1]
    v_cvt_pk_bf16_f32 v94, v156, v157
    v_cvt_pk_bf16_f32 v95, v158, v159
    v_pk_max_i16 v94, v94, 0
    v_pk_max_i16 v95, v95, 0
    buffer_store_dwordx4 v[92:95], v17, s[44:47], s57 offen offset:3072 sc1
    s_add_u32 s57, s65, 8192
    v_pk_fma_f32 v[160:161], v[48:49], v[32:33], v[160:161] op_sel:[0,0,0] op_sel_hi:[1,0,1] neg_lo:[1,0,0] neg_hi:[1,0,0]
    v_pk_fma_f32 v[162:163], v[50:51], v[32:33], v[162:163] op_sel:[0,0,0] op_sel_hi:[1,0,1] neg_lo:[1,0,0] neg_hi:[1,0,0]
    v_pk_mul_f32 v[160:161], v[160:161], v[32:33] op_sel:[0,1] op_sel_hi:[1,1]
    v_pk_mul_f32 v[162:163], v[162:163], v[32:33] op_sel:[0,1] op_sel_hi:[1,1]
    v_cvt_pk_bf16_f32 v80, v160, v161
    v_cvt_pk_bf16_f32 v81, v162, v163
    v_pk_max_i16 v80, v80, 0
    v_pk_max_i16 v81, v81, 0
    v_pk_fma_f32 v[176:177], v[52:53], v[32:33], v[176:177] op_sel:[0,0,0] op_sel_hi:[1,0,1] neg_lo:[1,0,0] neg_hi:[1,0,0]
    v_pk_fma_f32 v[178:179], v[54:55], v[32:33], v[178:179] op_sel:[0,0,0] op_sel_hi:[1,0,1] neg_lo:[1,0,0] neg_hi:[1,0,0]
    v_pk_mul_f32 v[176:177], v[176:177], v[32:33] op_sel:[0,1] op_sel_hi:[1,1]
    v_pk_mul_f32 v[178:179], v[178:179], v[32:33] op_sel:[0,1] op_sel_hi:[1,1]
    v_cvt_pk_bf16_f32 v82, v176, v177
    v_cvt_pk_bf16_f32 v83, v178, v179
    v_pk_max_i16 v82, v82, 0
    v_pk_max_i16 v83, v83, 0
    buffer_store_dwordx4 v[80:83], v17, s[44:47], s57 offen offset:0 sc1
    v_pk_fma_f32 v[164:165], v[48:49], v[34:35], v[164:165] op_sel:[0,0,0] op_sel_hi:[1,0,1] neg_lo:[1,0,0] neg_hi:[1,0,0]
    v_pk_fma_f32 v[166:167], v[50:51], v[34:35], v[166:167] op_sel:[0,0,0] op_sel_hi:[1,0,1] neg_lo:[1,0,0] neg_hi:[1,0,0]
    v_pk_mul_f32 v[164:165], v[164:165], v[34:35] op_sel:[0,1] op_sel_hi:[1,1]
    v_pk_mul_f32 v[166:167], v[166:167], v[34:35] op_sel:[0,1] op_sel_hi:[1,1]
    v_cvt_pk_bf16_f32 v84, v164, v165
    v_cvt_pk_bf16_f32 v85, v166, v167
    v_pk_max_i16 v84, v84, 0
    v_pk_max_i16 v85, v85, 0
    v_pk_fma_f32 v[180:181], v[52:53], v[34:35], v[180:181] op_sel:[0,0,0] op_sel_hi:[1,0,1] neg_lo:[1,0,0] neg_hi:[1,0,0]
    v_pk_fma_f32 v[182:183], v[54:55], v[34:35], v[182:183] op_sel:[0,0,0] op_sel_hi:[1,0,1] neg_lo:[1,0,0] neg_hi:[1,0,0]
    v_pk_mul_f32 v[180:181], v[180:181], v[34:35] op_sel:[0,1] op_sel_hi:[1,1]
    v_pk_mul_f32 v[182:183], v[182:183], v[34:35] op_sel:[0,1] op_sel_hi:[1,1]
    v_cvt_pk_bf16_f32 v86, v180, v181
    v_cvt_pk_bf16_f32 v87, v182, v183
    v_pk_max_i16 v86, v86, 0
    v_pk_max_i16 v87, v87, 0
    buffer_store_dwordx4 v[84:87], v17, s[44:47], s57 offen offset:1024 sc1
    v_pk_fma_f32 v[168:169], v[48:49], v[36:37], v[168:169] op_sel:[0,0,0] op_sel_hi:[1,0,1] neg_lo:[1,0,0] neg_hi:[1,0,0]
    v_pk_fma_f32 v[170:171], v[50:51], v[36:37], v[170:171] op_sel:[0,0,0] op_sel_hi:[1,0,1] neg_lo:[1,0,0] neg_hi:[1,0,0]
    v_pk_mul_f32 v[168:169], v[168:169], v[36:37] op_sel:[0,1] op_sel_hi:[1,1]
    v_pk_mul_f32 v[170:171], v[170:171], v[36:37] op_sel:[0,1] op_sel_hi:[1,1]
    v_cvt_pk_bf16_f32 v88, v168, v169
    v_cvt_pk_bf16_f32 v89, v170, v171
    v_pk_max_i16 v88, v88, 0
    v_pk_max_i16 v89, v89, 0
    v_pk_fma_f32 v[184:185], v[52:53], v[36:37], v[184:185] op_sel:[0,0,0] op_sel_hi:[1,0,1] neg_lo:[1,0,0] neg_hi:[1,0,0]
    v_pk_fma_f32 v[186:187], v[54:55], v[36:37], v[186:187] op_sel:[0,0,0] op_sel_hi:[1,0,1] neg_lo:[1,0,0] neg_hi:[1,0,0]
    v_pk_mul_f32 v[184:185], v[184:185], v[36:37] op_sel:[0,1] op_sel_hi:[1,1]
    v_pk_mul_f32 v[186:187], v[186:187], v[36:37] op_sel:[0,1] op_sel_hi:[1,1]
    v_cvt_pk_bf16_f32 v90, v184, v185
    v_cvt_pk_bf16_f32 v91, v186, v187
    v_pk_max_i16 v90, v90, 0
    v_pk_max_i16 v91, v91, 0
    buffer_store_dwordx4 v[88:91], v17, s[44:47], s57 offen offset:2048 sc1
    v_pk_fma_f32 v[172:173], v[48:49], v[38:39], v[172:173] op_sel:[0,0,0] op_sel_hi:[1,0,1] neg_lo:[1,0,0] neg_hi:[1,0,0]
    v_pk_fma_f32 v[174:175], v[50:51], v[38:39], v[174:175] op_sel:[0,0,0] op_sel_hi:[1,0,1] neg_lo:[1,0,0] neg_hi:[1,0,0]
    v_pk_mul_f32 v[172:173], v[172:173], v[38:39] op_sel:[0,1] op_sel_hi:[1,1]
    v_pk_mul_f32 v[174:175], v[174:175], v[38:39] op_sel:[0,1] op_sel_hi:[1,1]
    v_cvt_pk_bf16_f32 v92, v172, v173
    v_cvt_pk_bf16_f32 v93, v174, v175
    v_pk_max_i16 v92, v92, 0
    v_pk_max_i16 v93, v93, 0
    v_pk_fma_f32 v[188:189], v[52:53], v[38:39], v[188:189] op_sel:[0,0,0] op_sel_hi:[1,0,1] neg_lo:[1,0,0] neg_hi:[1,0,0]
    v_pk_fma_f32 v[190:191], v[54:55], v[38:39], v[190:191] op_sel:[0,0,0] op_sel_hi:[1,0,1] neg_lo:[1,0,0] neg_hi:[1,0,0]
    v_pk_mul_f32 v[188:189], v[188:189], v[38:39] op_sel:[0,1] op_sel_hi:[1,1]
    v_pk_mul_f32 v[190:191], v[190:191], v[38:39] op_sel:[0,1] op_sel_hi:[1,1]
    v_cvt_pk_bf16_f32 v94, v188, v189
    v_cvt_pk_bf16_f32 v95, v190, v191
    v_pk_max_i16 v94, v94, 0
    v_pk_max_i16 v95, v95, 0
    buffer_store_dwordx4 v[92:95], v17, s[44:47], s57 offen offset:3072 sc1
    s_add_u32 s57, s65, 16384
    v_pk_fma_f32 v[192:193], v[56:57], v[32:33], v[192:193] op_sel:[0,0,0] op_sel_hi:[1,0,1] neg_lo:[1,0,0] neg_hi:[1,0,0]
    v_pk_fma_f32 v[194:195], v[58:59], v[32:33], v[194:195] op_sel:[0,0,0] op_sel_hi:[1,0,1] neg_lo:[1,0,0] neg_hi:[1,0,0]
    v_pk_mul_f32 v[192:193], v[192:193], v[32:33] op_sel:[0,1] op_sel_hi:[1,1]
    v_pk_mul_f32 v[194:195], v[194:195], v[32:33] op_sel:[0,1] op_sel_hi:[1,1]
    v_cvt_pk_bf16_f32 v80, v192, v193
    v_cvt_pk_bf16_f32 v81, v194, v195
    v_pk_max_i16 v80, v80, 0
    v_pk_max_i16 v81, v81, 0
    v_pk_fma_f32 v[208:209], v[60:61], v[32:33], v[208:209] op_sel:[0,0,0] op_sel_hi:[1,0,1] neg_lo:[1,0,0] neg_hi:[1,0,0]
    v_pk_fma_f32 v[210:211], v[62:63], v[32:33], v[210:211] op_sel:[0,0,0] op_sel_hi:[1,0,1] neg_lo:[1,0,0] neg_hi:[1,0,0]
    v_pk_mul_f32 v[208:209], v[208:209], v[32:33] op_sel:[0,1] op_sel_hi:[1,1]
    v_pk_mul_f32 v[210:211], v[210:211], v[32:33] op_sel:[0,1] op_sel_hi:[1,1]
    v_cvt_pk_bf16_f32 v82, v208, v209
    v_cvt_pk_bf16_f32 v83, v210, v211
    v_pk_max_i16 v82, v82, 0
    v_pk_max_i16 v83, v83, 0
    buffer_store_dwordx4 v[80:83], v17, s[44:47], s57 offen offset:0 sc1
    v_pk_fma_f32 v[196:197], v[56:57], v[34:35], v[196:197] op_sel:[0,0,0] op_sel_hi:[1,0,1] neg_lo:[1,0,0] neg_hi:[1,0,0]
    v_pk_fma_f32 v[198:199], v[58:59], v[34:35], v[198:199] op_sel:[0,0,0] op_sel_hi:[1,0,1] neg_lo:[1,0,0] neg_hi:[1,0,0]
    v_pk_mul_f32 v[196:197], v[196:197], v[34:35] op_sel:[0,1] op_sel_hi:[1,1]
    v_pk_mul_f32 v[198:199], v[198:199], v[34:35] op_sel:[0,1] op_sel_hi:[1,1]
    v_cvt_pk_bf16_f32 v84, v196, v197
    v_cvt_pk_bf16_f32 v85, v198, v199
    v_pk_max_i16 v84, v84, 0
    v_pk_max_i16 v85, v85, 0
    v_pk_fma_f32 v[212:213], v[60:61], v[34:35], v[212:213] op_sel:[0,0,0] op_sel_hi:[1,0,1] neg_lo:[1,0,0] neg_hi:[1,0,0]
    v_pk_fma_f32 v[214:215], v[62:63], v[34:35], v[214:215] op_sel:[0,0,0] op_sel_hi:[1,0,1] neg_lo:[1,0,0] neg_hi:[1,0,0]
    v_pk_mul_f32 v[212:213], v[212:213], v[34:35] op_sel:[0,1] op_sel_hi:[1,1]
    v_pk_mul_f32 v[214:215], v[214:215], v[34:35] op_sel:[0,1] op_sel_hi:[1,1]
    v_cvt_pk_bf16_f32 v86, v212, v213
    v_cvt_pk_bf16_f32 v87, v214, v215
    v_pk_max_i16 v86, v86, 0
    v_pk_max_i16 v87, v87, 0
    buffer_store_dwordx4 v[84:87], v17, s[44:47], s57 offen offset:1024 sc1
    v_pk_fma_f32 v[200:201], v[56:57], v[36:37], v[200:201] op_sel:[0,0,0] op_sel_hi:[1,0,1] neg_lo:[1,0,0] neg_hi:[1,0,0]
    v_pk_fma_f32 v[202:203], v[58:59], v[36:37], v[202:203] op_sel:[0,0,0] op_sel_hi:[1,0,1] neg_lo:[1,0,0] neg_hi:[1,0,0]
    v_pk_mul_f32 v[200:201], v[200:201], v[36:37] op_sel:[0,1] op_sel_hi:[1,1]
    v_pk_mul_f32 v[202:203], v[202:203], v[36:37] op_sel:[0,1] op_sel_hi:[1,1]
    v_cvt_pk_bf16_f32 v88, v200, v201
    v_cvt_pk_bf16_f32 v89, v202, v203
    v_pk_max_i16 v88, v88, 0
    v_pk_max_i16 v89, v89, 0
    v_pk_fma_f32 v[216:217], v[60:61], v[36:37], v[216:217] op_sel:[0,0,0] op_sel_hi:[1,0,1] neg_lo:[1,0,0] neg_hi:[1,0,0]
    v_pk_fma_f32 v[218:219], v[62:63], v[36:37], v[218:219] op_sel:[0,0,0] op_sel_hi:[1,0,1] neg_lo:[1,0,0] neg_hi:[1,0,0]
    v_pk_mul_f32 v[216:217], v[216:217], v[36:37] op_sel:[0,1] op_sel_hi:[1,1]
    v_pk_mul_f32 v[218:219], v[218:219], v[36:37] op_sel:[0,1] op_sel_hi:[1,1]
    v_cvt_pk_bf16_f32 v90, v216, v217
    v_cvt_pk_bf16_f32 v91, v218, v219
    v_pk_max_i16 v90, v90, 0
    v_pk_max_i16 v91, v91, 0
    buffer_store_dwordx4 v[88:91], v17, s[44:47], s57 offen offset:2048 sc1
    v_pk_fma_f32 v[204:205], v[56:57], v[38:39], v[204:205] op_sel:[0,0,0] op_sel_hi:[1,0,1] neg_lo:[1,0,0] neg_hi:[1,0,0]
    v_pk_fma_f32 v[206:207], v[58:59], v[38:39], v[206:207] op_sel:[0,0,0] op_sel_hi:[1,0,1] neg_lo:[1,0,0] neg_hi:[1,0,0]
    v_pk_mul_f32 v[204:205], v[204:205], v[38:39] op_sel:[0,1] op_sel_hi:[1,1]
    v_pk_mul_f32 v[206:207], v[206:207], v[38:39] op_sel:[0,1] op_sel_hi:[1,1]
    v_cvt_pk_bf16_f32 v92, v204, v205
    v_cvt_pk_bf16_f32 v93, v206, v207
    v_pk_max_i16 v92, v92, 0
    v_pk_max_i16 v93, v93, 0
    v_pk_fma_f32 v[220:221], v[60:61], v[38:39], v[220:221] op_sel:[0,0,0] op_sel_hi:[1,0,1] neg_lo:[1,0,0] neg_hi:[1,0,0]
    v_pk_fma_f32 v[222:223], v[62:63], v[38:39], v[222:223] op_sel:[0,0,0] op_sel_hi:[1,0,1] neg_lo:[1,0,0] neg_hi:[1,0,0]
    v_pk_mul_f32 v[220:221], v[220:221], v[38:39] op_sel:[0,1] op_sel_hi:[1,1]
    v_pk_mul_f32 v[222:223], v[222:223], v[38:39] op_sel:[0,1] op_sel_hi:[1,1]
    v_cvt_pk_bf16_f32 v94, v220, v221
    v_cvt_pk_bf16_f32 v95, v222, v223
    v_pk_max_i16 v94, v94, 0
    v_pk_max_i16 v95, v95, 0
    buffer_store_dwordx4 v[92:95], v17, s[44:47], s57 offen offset:3072 sc1
    s_branch epx_12
ep1_11:
    v_pk_fma_f32 v[128:129], v[40:41], v[32:33], v[128:129] op_sel:[0,0,0] op_sel_hi:[1,0,1] neg_lo:[1,0,0] neg_hi:[1,0,0]
    v_pk_fma_f32 v[130:131], v[42:43], v[32:33], v[130:131] op_sel:[0,0,0] op_sel_hi:[1,0,1] neg_lo:[1,0,0] neg_hi:[1,0,0]
    v_pk_mul_f32 v[128:129], v[128:129], v[32:33] op_sel:[0,1] op_sel_hi:[1,1]
    v_pk_mul_f32 v[130:131], v[130:131], v[32:33] op_sel:[0,1] op_sel_hi:[1,1]
    v_cvt_pk_bf16_f32 v98, v128, v129
    v_cvt_pk_bf16_f32 v99, v130, v131
    v_pk_max_i16 v98, v98, 0
    v_pk_max_i16 v99, v99, 0
    v_pk_fma_f32 v[132:133], v[40:41], v[34:35], v[132:133] op_sel:[0,0,0] op_sel_hi:[1,0,1] neg_lo:[1,0,0] neg_hi:[1,0,0]
    v_pk_fma_f32 v[134:135], v[42:43], v[34:35], v[134:135] op_sel:[0,0,0] op_sel_hi:[1,0,1] neg_lo:[1,0,0] neg_hi:[1,0,0]
    v_pk_mul_f32 v[132:133], v[132:133], v[34:35] op_sel:[0,1] op_sel_hi:[1,1]
    v_pk_mul_f32 v[134:135], v[134:135], v[34:35] op_sel:[0,1] op_sel_hi:[1,1]
    v_cvt_pk_bf16_f32 v102, v132, v133
    v_cvt_pk_bf16_f32 v103, v134, v135
    v_pk_max_i16 v102, v102, 0
    v_pk_max_i16 v103, v103, 0
    v_pk_fma_f32 v[136:137], v[40:41], v[36:37], v[136:137] op_sel:[0,0,0] op_sel_hi:[1,0,1] neg_lo:[1,0,0] neg_hi:[1,0,0]
    v_pk_fma_f32 v[138:139], v[42:43], v[36:37], v[138:139] op_sel:[0,0,0] op_sel_hi:[1,0,1] neg_lo:[1,0,0] neg_hi:[1,0,0]
    v_pk_mul_f32 v[136:137], v[136:137], v[36:37] op_sel:[0,1] op_sel_hi:[1,1]
    v_pk_mul_f32 v[138:139], v[138:139], v[36:37] op_sel:[0,1] op_sel_hi:[1,1]
    v_cvt_pk_bf16_f32 v106, v136, v137
    v_cvt_pk_bf16_f32 v107, v138, v139
    v_pk_max_i16 v106, v106, 0
    v_pk_max_i16 v107, v107, 0
    v_pk_fma_f32 v[140:141], v[40:41], v[38:39], v[140:141] op_sel:[0,0,0] op_sel_hi:[1,0,1] neg_lo:[1,0,0] neg_hi:[1,0,0]
    v_pk_fma_f32 v[142:143], v[42:43], v[38:39], v[142:143] op_sel:[0,0,0] op_sel_hi:[1,0,1] neg_lo:[1,0,0] neg_hi:[1,0,0]
    v_pk_mul_f32 v[140:141], v[140:141], v[38:39] op_sel:[0,1] op_sel_hi:[1,1]
    v_pk_mul_f32 v[142:143], v[142:143], v[38:39] op_sel:[0,1] op_sel_hi:[1,1]
    v_cvt_pk_bf16_f32 v110, v140, v141
    v_cvt_pk_bf16_f32 v111, v142, v143
    v_pk_max_i16 v110, v110, 0
    v_pk_max_i16 v111, v111, 0
    s_barrier
    ds_read_b64 v[96:97], v19 offset:0
    ds_read_b64 v[100:101], v19 offset:512
    ds_read_b64 v[104:105], v19 offset:1024
    ds_read_b64 v[108:109], v19 offset:1536
    s_add_u32 s57, s65, 32768
    v_pk_fma_f32 v[144:145], v[44:45], v[32:33], v[144:145] op_sel:[0,0,0] op_sel_hi:[1,0,1] neg_lo:[1,0,0] neg_hi:[1,0,0]
    v_pk_fma_f32 v[146:147], v[46:47], v[32:33], v[146:147] op_sel:[0,0,0] op_sel_hi:[1,0,1] neg_lo:[1,0,0] neg_hi:[1,0,0]
    v_pk_mul_f32 v[144:145], v[144:145], v[32:33] op_sel:[0,1] op_sel_hi:[1,1]
    v_pk_mul_f32 v[146:147], v[146:147], v[32:33] op_sel:[0,1] op_sel_hi:[1,1]
    v_cvt_pk_bf16_f32 v80, v144, v145
    v_cvt_pk_bf16_f32 v81, v146, v147
    v_pk_max_i16 v80, v80, 0
    v_pk_max_i16 v81, v81, 0
    v_pk_fma_f32 v[160:161], v[48:49], v[32:33], v[160:161] op_sel:[0,0,0] op_sel_hi:[1,0,1] neg_lo:[1,0,0] neg_hi:[1,0,0]
    v_pk_fma_f32 v[162:163], v[50:51], v[32:33], v[162:163] op_sel:[0,0,0] op_sel_hi:[1,0,1] neg_lo:[1,0,0] neg_hi:[1,0,0]
    v_pk_mul_f32 v[160:161], v[160:161], v[32:33] op_sel:[0,1] op_sel_hi:[1,1]
    v_pk_mul_f32 v[162:163], v[162:163], v[32:33] op_sel:[0,1] op_sel_hi:[1,1]
    v_cvt_pk_bf16_f32 v82, v160, v161
    v_cvt_pk_bf16_f32 v83, v162, v163
    v_pk_max_i16 v82, v82, 0
    v_pk_max_i16 v83, v83, 0
    buffer_store_dwordx4 v[80:83], v17, s[44:47], s57 offen offset:0 sc1
    v_pk_fma_f32 v[148:149], v[44:45], v[34:35], v[148:149] op_sel:[0,0,0] op_sel_hi:[1,0,1] neg_lo:[1,0,0] neg_hi:[1,0,0]
    v_pk_fma_f32 v[150:151], v[46:47], v[34:35], v[150:151] op_sel:[0,0,0] op_sel_hi:[1,0,1] neg_lo:[1,0,0] neg_hi:[1,0,0]
    v_pk_mul_f32 v[148:149], v[148:149], v[34:35] op_sel:[0,1] op_sel_hi:[1,1]
    v_pk_mul_f32 v[150:151], v[150:151], v[34:35] op_sel:[0,1] op_sel_hi:[1,1]
    v_cvt_pk_bf16_f32 v84, v148, v149
    v_cvt_pk_bf16_f32 v85, v150, v151
    v_pk_max_i16 v84, v84, 0
    v_pk_max_i16 v85, v85, 0
    v_pk_fma_f32 v[164:165], v[48:49], v[34:35], v[164:165] op_sel:[0,0,0] op_sel_hi:[1,0,1] neg_lo:[1,0,0] neg_hi:[1,0,0]
    v_pk_fma_f32 v[166:167], v[50:51], v[34:35], v[166:167] op_sel:[0,0,0] op_sel_hi:[1,0,1] neg_lo:[1,0,0] neg_hi:[1,0,0]
    v_pk_mul_f32 v[164:165], v[164:165], v[34:35] op_sel:[0,1] op_sel_hi:[1,1]
    v_pk_mul_f32 v[166:167], v[166:167], v[34:35] op_sel:[0,1] op_sel_hi:[1,1]
    v_cvt_pk_bf16_f32 v86, v164, v165
    v_cvt_pk_bf16_f32 v87, v166, v167
    v_pk_max_i16 v86, v86, 0
    v_pk_max_i16 v87, v87, 0
    buffer_store_dwordx4 v[84:87], v17, s[44:47], s57 offen offset:1024 sc1
    v_pk_fma_f32 v[152:153], v[44:45], v[36:37], v[152:153] op_sel:[0,0,0] op_sel_hi:[1,0,1] neg_lo:[1,0,0] neg_hi:[1,0,0]
    v_pk_fma_f32 v[154:155], v[46:47], v[36:37], v[154:155] op_sel:[0,0,0] op_sel_hi:[1,0,1] neg_lo:[1,0,0] neg_hi:[1,0,0]
    v_pk_mul_f32 v[152:153], v[152:153], v[36:37] op_sel:[0,1] op_sel_hi:[1,1]
    v_pk_mul_f32 v[154:155], v[154:155], v[36:37] op_sel:[0,1] op_sel_hi:[1,1]
    v_cvt_pk_bf16_f32 v88, v152, v153
    v_cvt_pk_bf16_f32 v89, v154, v155
    v_pk_max_i16 v88, v88, 0
    v_pk_max_i16 v89, v89, 0
    v_pk_fma_f32 v[168:169], v[48:49], v[36:37], v[168:169] op_sel:[0,0,0] op_sel_hi:[1,0,1] neg_lo:[1,0,0] neg_hi:[1,0,0]
    v_pk_fma_f32 v[170:171], v[50:51], v[36:37], v[170:171] op_sel:[0,0,0] op_sel_hi:[1,0,1] neg_lo:[1,0,0] neg_hi:[1,0,0]
    v_pk_mul_f32 v[168:169], v[168:169], v[36:37] op_sel:[0,1] op_sel_hi:[1,1]
    v_pk_mul_f32 v[170:171], v[170:171], v[36:37] op_sel:[0,1] op_sel_hi:[1,1]
    v_cvt_pk_bf16_f32 v90, v168, v169
    v_cvt_pk_bf16_f32 v91, v170, v171
    v_pk_max_i16 v90, v90, 0
    v_pk_max_i16 v91, v91, 0
    buffer_store_dwordx4 v[88:91], v17, s[44:47], s57 offen offset:2048 sc1
    v_pk_fma_f32 v[156:157], v[44:45], v[38:39], v[156:157] op_sel:[0,0,0] op_sel_hi:[1,0,1] neg_lo:[1,0,0] neg_hi:[1,0,0]
    v_pk_fma_f32 v[158:159], v[46:47], v[38:39], v[158:159] op_sel:[0,0,0] op_sel_hi:[1,0,1] neg_lo:[1,0,0] neg_hi:[1,0,0]
    v_pk_mul_f32 v[156:157], v[156:157], v[38:39] op_sel:[0,1] op_sel_hi:[1,1]
    v_pk_mul_f32 v[158:159], v[158:159], v[38:39] op_sel:[0,1] op_sel_hi:[1,1]
    v_cvt_pk_bf16_f32 v92, v156, v157
    v_cvt_pk_bf16_f32 v93, v158, v159
    v_pk_max_i16 v92, v92, 0
    v_pk_max_i16 v93, v93, 0
    v_pk_fma_f32 v[172:173], v[48:49], v[38:39], v[172:173] op_sel:[0,0,0] op_sel_hi:[1,0,1] neg_lo:[1,0,0] neg_hi:[1,0,0]
    v_pk_fma_f32 v[174:175], v[50:51], v[38:39], v[174:175] op_sel:[0,0,0] op_sel_hi:[1,0,1] neg_lo:[1,0,0] neg_hi:[1,0,0]
    v_pk_mul_f32 v[172:173], v[172:173], v[38:39] op_sel:[0,1] op_sel_hi:[1,1]
    v_pk_mul_f32 v[174:175], v[174:175], v[38:39] op_sel:[0,1] op_sel_hi:[1,1]
    v_cvt_pk_bf16_f32 v94, v172, v173
    v_cvt_pk_bf16_f32 v95, v174, v175
    v_pk_max_i16 v94, v94, 0
    v_pk_max_i16 v95, v95, 0
    buffer_store_dwordx4 v[92:95], v17, s[44:47], s57 offen offset:3072 sc1
    s_add_u32 s57, s65, 24576
    s_waitcnt lgkmcnt(0)
    buffer_store_dwordx4 v[96:99], v17, s[44:47], s57 offen offset:0 sc1
    buffer_store_dwordx4 v[100:103], v17, s[44:47], s57 offen offset:1024 sc1
    buffer_store_dwordx4 v[104:107], v17, s[44:47], s57 offen offset:2048 sc1
    buffer_store_dwordx4 v[108:111], v17, s[44:47], s57 offen offset:3072 sc1
    s_add_u32 s57, s65, 40960
    v_pk_fma_f32 v[176:177], v[52:53], v[32:33], v[176:177] op_sel:[0,0,0] op_sel_hi:[1,0,1] neg_lo:[1,0,0] neg_hi:[1,0,0]
    v_pk_fma_f32 v[178:179], v[54:55], v[32:33], v[178:179] op_sel:[0,0,0] op_sel_hi:[1,0,1] neg_lo:[1,0,0] neg_hi:[1,0,0]
    v_pk_mul_f32 v[176:177], v[176:177], v[32:33] op_sel:[0,1] op_sel_hi:[1,1]
    v_pk_mul_f32 v[178:179], v[178:179], v[32:33] op_sel:[0,1] op_sel_hi:[1,1]
    v_cvt_pk_bf16_f32 v80, v176, v177
    v_cvt_pk_bf16_f32 v81, v178, v179
    v_pk_max_i16 v80, v80, 0
    v_pk_max_i16 v81, v81, 0
    v_pk_fma_f32 v[192:193], v[56:57], v[32:33], v[192:193] op_sel:[0,0,0] op_sel_hi:[1,0,1] neg_lo:[1,0,0] neg_hi:[1,0,0]
    v_pk_fma_f32 v[194:195], v[58:59], v[32:33], v[194:195] op_sel:[0,0,0] op_sel_hi:[1,0,1] neg_lo:[1,0,0] neg_hi:[1,0,0]
    v_pk_mul_f32 v[192:193], v[192:193], v[32:33] op_sel:[0,1] op_sel_hi:[1,1]
    v_pk_mul_f32 v[194:195], v[194:195], v[32:33] op_sel:[0,1] op_sel_hi:[1,1]
    v_cvt_pk_bf16_f32 v82, v192, v193
    v_cvt_pk_bf16_f32 v83, v194, v195
    v_pk_max_i16 v82, v82, 0
    v_pk_max_i16 v83, v83, 0
    buffer_store_dwordx4 v[80:83], v17, s[44:47], s57 offen offset:0 sc1
    v_pk_fma_f32 v[180:181], v[52:53], v[34:35], v[180:181] op_sel:[0,0,0] op_sel_hi:[1,0,1] neg_lo:[1,0,0] neg_hi:[1,0,0]
    v_pk_fma_f32 v[182:183], v[54:55], v[34:35], v[182:183] op_sel:[0,0,0] op_sel_hi:[1,0,1] neg_lo:[1,0,0] neg_hi:[1,0,0]
    v_pk_mul_f32 v[180:181], v[180:181], v[34:35] op_sel:[0,1] op_sel_hi:[1,1]
    v_pk_mul_f32 v[182:183], v[182:183], v[34:35] op_sel:[0,1] op_sel_hi:[1,1]
    v_cvt_pk_bf16_f32 v84, v180, v181
    v_cvt_pk_bf16_f32 v85, v182, v183
    v_pk_max_i16 v84, v84, 0
    v_pk_max_i16 v85, v85, 0
    v_pk_fma_f32 v[196:197], v[56:57], v[34:35], v[196:197] op_sel:[0,0,0] op_sel_hi:[1,0,1] neg_lo:[1,0,0] neg_hi:[1,0,0]
    v_pk_fma_f32 v[198:199], v[58:59], v[34:35], v[198:199] op_sel:[0,0,0] op_sel_hi:[1,0,1] neg_lo:[1,0,0] neg_hi:[1,0,0]
    v_pk_mul_f32 v[196:197], v[196:197], v[34:35] op_sel:[0,1] op_sel_hi:[1,1]
    v_pk_mul_f32 v[198:199], v[198:199], v[34:35] op_sel:[0,1] op_sel_hi:[1,1]
    v_cvt_pk_bf16_f32 v86, v196, v197
    v_cvt_pk_bf16_f32 v87, v198, v199
    v_pk_max_i16 v86, v86, 0
    v_pk_max_i16 v87, v87, 0
    buffer_store_dwordx4 v[84:87], v17, s[44:47], s57 offen offset:1024 sc1
    v_pk_fma_f32 v[184:185], v[52:53], v[36:37], v[184:185] op_sel:[0,0,0] op_sel_hi:[1,0,1] neg_lo:[1,0,0] neg_hi:[1,0,0]
    v_pk_fma_f32 v[186:187], v[54:55], v[36:37], v[186:187] op_sel:[0,0,0] op_sel_hi:[1,0,1] neg_lo:[1,0,0] neg_hi:[1,0,0]
    v_pk_mul_f32 v[184:185], v[184:185], v[36:37] op_sel:[0,1] op_sel_hi:[1,1]
    v_pk_mul_f32 v[186:187], v[186:187], v[36:37] op_sel:[0,1] op_sel_hi:[1,1]
    v_cvt_pk_bf16_f32 v88, v184, v185
    v_cvt_pk_bf16_f32 v89, v186, v187
    v_pk_max_i16 v88, v88, 0
    v_pk_max_i16 v89, v89, 0
    v_pk_fma_f32 v[200:201], v[56:57], v[36:37], v[200:201] op_sel:[0,0,0] op_sel_hi:[1,0,1] neg_lo:[1,0,0] neg_hi:[1,0,0]
    v_pk_fma_f32 v[202:203], v[58:59], v[36:37], v[202:203] op_sel:[0,0,0] op_sel_hi:[1,0,1] neg_lo:[1,0,0] neg_hi:[1,0,0]
    v_pk_mul_f32 v[200:201], v[200:201], v[36:37] op_sel:[0,1] op_sel_hi:[1,1]
    v_pk_mul_f32 v[202:203], v[202:203], v[36:37] op_sel:[0,1] op_sel_hi:[1,1]
    v_cvt_pk_bf16_f32 v90, v200, v201
    v_cvt_pk_bf16_f32 v91, v202, v203
    v_pk_max_i16 v90, v90, 0
    v_pk_max_i16 v91, v91, 0
    buffer_store_dwordx4 v[88:91], v17, s[44:47], s57 offen offset:2048 sc1
    v_pk_fma_f32 v[188:189], v[52:53], v[38:39], v[188:189] op_sel:[0,0,0] op_sel_hi:[1,0,1] neg_lo:[1,0,0] neg_hi:[1,0,0]
    v_pk_fma_f32 v[190:191], v[54:55], v[38:39], v[190:191] op_sel:[0,0,0] op_sel_hi:[1,0,1] neg_lo:[1,0,0] neg_hi:[1,0,0]
    v_pk_mul_f32 v[188:189], v[188:189], v[38:39] op_sel:[0,1] op_sel_hi:[1,1]
    v_pk_mul_f32 v[190:191], v[190:191], v[38:39] op_sel:[0,1] op_sel_hi:[1,1]
    v_cvt_pk_bf16_f32 v92, v188, v189
    v_cvt_pk_bf16_f32 v93, v190, v191
    v_pk_max_i16 v92, v92, 0
    v_pk_max_i16 v93, v93, 0
    v_pk_fma_f32 v[204:205], v[56:57], v[38:39], v[204:205] op_sel:[0,0,0] op_sel_hi:[1,0,1] neg_lo:[1,0,0] neg_hi:[1,0,0]
    v_pk_fma_f32 v[206:207], v[58:59], v[38:39], v[206:207] op_sel:[0,0,0] op_sel_hi:[1,0,1] neg_lo:[1,0,0] neg_hi:[1,0,0]
    v_pk_mul_f32 v[204:205], v[204:205], v[38:39] op_sel:[0,1] op_sel_hi:[1,1]
    v_pk_mul_f32 v[206:207], v[206:207], v[38:39] op_sel:[0,1] op_sel_hi:[1,1]
    v_cvt_pk_bf16_f32 v94, v204, v205
    v_cvt_pk_bf16_f32 v95, v206, v207
    v_pk_max_i16 v94, v94, 0
    v_pk_max_i16 v95, v95, 0
    buffer_store_dwordx4 v[92:95], v17, s[44:47], s57 offen offset:3072 sc1
    s_add_u32 s57, s65, 49152
    s_cmp_lt_u32 s51, 6
    s_cselect_b32 s57, s57, 2147483632
    v_pk_fma_f32 v[208:209], v[60:61], v[32:33], v[208:209] op_sel:[0,0,0] op_sel_hi:[1,0,1] neg_lo:[1,0,0] neg_hi:[1,0,0]
    v_pk_fma_f32 v[210:211], v[62:63], v[32:33], v[210:211] op_sel:[0,0,0] op_sel_hi:[1,0,1] neg_lo:[1,0,0] neg_hi:[1,0,0]
    v_pk_mul_f32 v[208:209], v[208:209], v[32:33] op_sel:[0,1] op_sel_hi:[1,1]
    v_pk_mul_f32 v[210:211], v[210:211], v[32:33] op_sel:[0,1] op_sel_hi:[1,1]
    v_cvt_pk_bf16_f32 v80, v208, v209
    v_cvt_pk_bf16_f32 v81, v210, v211
    v_pk_max_i16 v80, v80, 0
    v_pk_max_i16 v81, v81, 0
    v_pk_fma_f32 v[224:225], v[64:65], v[32:33], v[224:225] op_sel:[0,0,0] op_sel_hi:[1,0,1] neg_lo:[1,0,0] neg_hi:[1,0,0]
    v_pk_fma_f32 v[226:227], v[66:67], v[32:33], v[226:227] op_sel:[0,0,0] op_sel_hi:[1,0,1] neg_lo:[1,0,0] neg_hi:[1,0,0]
    v_pk_mul_f32 v[224:225], v[224:225], v[32:33] op_sel:[0,1] op_sel_hi:[1,1]
    v_pk_mul_f32 v[226:227], v[226:227], v[32:33] op_sel:[0,1] op_sel_hi:[1,1]
    v_cvt_pk_bf16_f32 v82, v224, v225
    v_cvt_pk_bf16_f32 v83, v226, v227
    v_pk_max_i16 v82, v82, 0
    v_pk_max_i16 v83, v83, 0
    buffer_store_dwordx4 v[80:83], v17, s[44:47], s57 offen offset:0 sc1
    v_pk_fma_f32 v[212:213], v[60:61], v[34:35], v[212:213] op_sel:[0,0,0] op_sel_hi:[1,0,1] neg_lo:[1,0,0] neg_hi:[1,0,0]
    v_pk_fma_f32 v[214:215], v[62:63], v[34:35], v[214:215] op_sel:[0,0,0] op_sel_hi:[1,0,1] neg_lo:[1,0,0] neg_hi:[1,0,0]
    v_pk_mul_f32 v[212:213], v[212:213], v[34:35] op_sel:[0,1] op_sel_hi:[1,1]
    v_pk_mul_f32 v[214:215], v[214:215], v[34:35] op_sel:[0,1] op_sel_hi:[1,1]
    v_cvt_pk_bf16_f32 v84, v212, v213
    v_cvt_pk_bf16_f32 v85, v214, v215
    v_pk_max_i16 v84, v84, 0
    v_pk_max_i16 v85, v85, 0
    v_pk_fma_f32 v[228:229], v[64:65], v[34:35], v[228:229] op_sel:[0,0,0] op_sel_hi:[1,0,1] neg_lo:[1,0,0] neg_hi:[1,0,0]
    v_pk_fma_f32 v[230:231], v[66:67], v[34:35], v[230:231] op_sel:[0,0,0] op_sel_hi:[1,0,1] neg_lo:[1,0,0] neg_hi:[1,0,0]
    v_pk_mul_f32 v[228:229], v[228:229], v[34:35] op_sel:[0,1] op_sel_hi:[1,1]
    v_pk_mul_f32 v[230:231], v[230:231], v[34:35] op_sel:[0,1] op_sel_hi:[1,1]
    v_cvt_pk_bf16_f32 v86, v228, v229
    v_cvt_pk_bf16_f32 v87, v230, v231
    v_pk_max_i16 v86, v86, 0
    v_pk_max_i16 v87, v87, 0
    buffer_store_dwordx4 v[84:87], v17, s[44:47], s57 offen offset:1024 sc1
    v_pk_fma_f32 v[216:217], v[60:61], v[36:37], v[216:217] op_sel:[0,0,0] op_sel_hi:[1,0,1] neg_lo:[1,0,0] neg_hi:[1,0,0]
    v_pk_fma_f32 v[218:219], v[62:63], v[36:37], v[218:219] op_sel:[0,0,0] op_sel_hi:[1,0,1] neg_lo:[1,0,0] neg_hi:[1,0,0]
    v_pk_mul_f32 v[216:217], v[216:217], v[36:37] op_sel:[0,1] op_sel_hi:[1,1]
    v_pk_mul_f32 v[218:219], v[218:219], v[36:37] op_sel:[0,1] op_sel_hi:[1,1]
    v_cvt_pk_bf16_f32 v88, v216, v217
    v_cvt_pk_bf16_f32 v89, v218, v219
    v_pk_max_i16 v88, v88, 0
    v_pk_max_i16 v89, v89, 0
    v_pk_fma_f32 v[232:233], v[64:65], v[36:37], v[232:233] op_sel:[0,0,0] op_sel_hi:[1,0,1] neg_lo:[1,0,0] neg_hi:[1,0,0]
    v_pk_fma_f32 v[234:235], v[66:67], v[36:37], v[234:235] op_sel:[0,0,0] op_sel_hi:[1,0,1] neg_lo:[1,0,0] neg_hi:[1,0,0]
    v_pk_mul_f32 v[232:233], v[232:233], v[36:37] op_sel:[0,1] op_sel_hi:[1,1]
    v_pk_mul_f32 v[234:235], v[234:235], v[36:37] op_sel:[0,1] op_sel_hi:[1,1]
    v_cvt_pk_bf16_f32 v90, v232, v233
    v_cvt_pk_bf16_f32 v91, v234, v235
    v_pk_max_i16 v90, v90, 0
    v_pk_max_i16 v91, v91, 0
    buffer_store_dwordx4 v[88:91], v17, s[44:47], s57 offen offset:2048 sc1
    v_pk_fma_f32 v[220:221], v[60:61], v[38:39], v[220:221] op_sel:[0,0,0] op_sel_hi:[1,0,1] neg_lo:[1,0,0] neg_hi:[1,0,0]
    v_pk_fma_f32 v[222:223], v[62:63], v[38:39], v[222:223] op_sel:[0,0,0] op_sel_hi:[1,0,1] neg_lo:[1,0,0] neg_hi:[1,0,0]
    v_pk_mul_f32 v[220:221], v[220:221], v[38:39] op_sel:[0,1] op_sel_hi:[1,1]
    v_pk_mul_f32 v[222:223], v[222:223], v[38:39] op_sel:[0,1] op_sel_hi:[1,1]
    v_cvt_pk_bf16_f32 v92, v220, v221
    v_cvt_pk_bf16_f32 v93, v222, v223
    v_pk_max_i16 v92, v92, 0
    v_pk_max_i16 v93, v93, 0
    v_pk_fma_f32 v[236:237], v[64:65], v[38:39], v[236:237] op_sel:[0,0,0] op_sel_hi:[1,0,1] neg_lo:[1,0,0] neg_hi:[1,0,0]
    v_pk_fma_f32 v[238:239], v[66:67], v[38:39], v[238:239] op_sel:[0,0,0] op_sel_hi:[1,0,1] neg_lo:[1,0,0] neg_hi:[1,0,0]
    v_pk_mul_f32 v[236:237], v[236:237], v[38:39] op_sel:[0,1] op_sel_hi:[1,1]
    v_pk_mul_f32 v[238:239], v[238:239], v[38:39] op_sel:[0,1] op_sel_hi:[1,1]
    v_cvt_pk_bf16_f32 v94, v236, v237
    v_cvt_pk_bf16_f32 v95, v238, v239
    v_pk_max_i16 v94, v94, 0
    v_pk_max_i16 v95, v95, 0
    buffer_store_dwordx4 v[92:95], v17, s[44:47], s57 offen offset:3072 sc1
epx_12:
p2_comp:
    v_mov_b32 v26, 0
    ds_read_b64 v[22:23], v26 offset:3008
    s_lshl_b32 s57, s49, 7
    s_lshl_b32 s58, s50, 3
    s_add_u32 s57, s57, s58
    s_add_u32 s57, s57, s51
    s_lshl_b32 s57, s57, 7
    s_lshl_b32 s58, s48, 3
    s_add_u32 s57, s57, s58
    s_add_u32 s77, s57, 524288
    s_mov_b32 s78, s49
    s_and_b32 s57, s2, 3
    s_bfe_u32 s58, s2, 0x10002
    s_lshr_b32 s59, s35, 2
    s_lshl_b32 s50, s57, 2
    s_lshr_b32 s57, s59, 1
    s_add_u32 s50, s50, s57
    s_and_b32 s49, s59, 1
    s_lshl_b32 s51, s58, 2
    s_and_b32 s57, s35, 3
    s_add_u32 s51, s51, s57
    v_lshlrev_b32 v10, 4, v0
    s_mov_b32 s72, s4
    s_and_b32 s73, s5, 0xffff
    s_mov_b32 s74, 2621440
    s_mov_b32 s75, 0x20000
    s_mov_b32 s84, s28
    s_and_b32 s85, s29, 0xffff
    s_mov_b32 s86, 5242880
    s_mov_b32 s87, 0x20000
    v_cmp_eq_u32 vcc, 0, v0
    v_mov_b32 v24, 2147483632
    s_nop 0
    v_cndmask_b32 v24, v24, v26, vcc
    s_cmp_eq_u32 s78, 0
    s_cbranch_scc1 nof_13
    s_waitcnt vmcnt(0) lgkmcnt(0)
    buffer_store_dwordx2 v[22:23], v24, s[44:47], s77 offen sc1
nof_13:
    s_lshl_b32 s57, s50, 7
    s_lshl_b32 s58, s49, 6
    s_add_u32 s57, s57, s58
    s_add_u32 s57, s57, s48
    v_lshl_add_u32 v17, v6, 2, s57
    v_mul_u32_u24 v18, 1280, v17
    v_lshl_add_u32 v18, v5, 3, v18
    s_mul_i32 s58, s51, 160
    buffer_load_dwordx2 v[68:69], v18, s[72:75], s58 offen offset:0
    buffer_load_dwordx2 v[70:71], v18, s[72:75], s58 offen offset:32
    buffer_load_dwordx2 v[72:73], v18, s[72:75], s58 offen offset:64
    buffer_load_dwordx2 v[74:75], v18, s[72:75], s58 offen offset:96
    buffer_load_dwordx2 v[76:77], v18, s[72:75], s58 offen offset:128
    v_lshlrev_b32 v25, 4, v17
    s_mov_b32 s62, 0
    v_lshlrev_b32 v26, 3, v5
    v_add_u32 v26, s58, v26
    global_load_dwordx2 v[82:83], v26, s[20:21] offset:0
    global_load_dwordx2 v[84:85], v26, s[20:21] offset:32
    global_load_dwordx2 v[86:87], v26, s[20:21] offset:64
    global_load_dwordx2 v[88:89], v26, s[20:21] offset:96
    global_load_dwordx2 v[90:91], v26, s[20:21] offset:128
    s_lshl_b32 s57, s48, 10
    s_add_u32 s57, s57, 97792
    v_add_u32 v20, s57, v10
    v_add_u32 v21, 56832, v10
    v_add_u32 v19, 26112, v10
    v_mov_b32 v28, 0
    v_mov_b32 v29, 0
    v_mov_b32 v30, 0
    v_mov_b32 v31, 0
    v_mov_b32 v32, 0
    v_mov_b32 v33, 0
    v_mov_b32 v34, 0
    v_mov_b32 v35, 0
    v_mov_b32 v36, 0
    v_mov_b32 v37, 0
    v_mov_b32 v38, 0
    v_mov_b32 v39, 0
    v_mov_b32 v40, 0
    v_mov_b32 v41, 0
    v_mov_b32 v42, 0
    v_mov_b32 v43, 0
    v_mov_b32 v44, 0
    v_mov_b32 v45, 0
    v_mov_b32 v46, 0
    v_mov_b32 v47, 0
    v_mov_b32 v48, 0
    v_mov_b32 v49, 0
    v_mov_b32 v50, 0
    v_mov_b32 v51, 0
    v_mov_b32 v52, 0
    v_mov_b32 v53, 0
    v_mov_b32 v54, 0
    v_mov_b32 v55, 0
    v_mov_b32 v56, 0
    v_mov_b32 v57, 0
    v_mov_b32 v58, 0
    v_mov_b32 v59, 0
    v_mov_b32 v60, 0
    v_mov_b32 v61, 0
    v_mov_b32 v62, 0
    v_mov_b32 v63, 0
    v_mov_b32 v64, 0
    v_mov_b32 v65, 0
    v_mov_b32 v66, 0
    v_mov_b32 v67, 0
    s_barrier
    buffer_load_dwordx4 v[78:81], v25, s[44:47], s62 offen sc1
    ds_read_b128 v[132:135], v20 offset:0
    ds_read_b128 v[112:115], v19 offset:0
    ds_read_b128 v[116:119], v19 offset:1024
    ds_read_b128 v[120:123], v19 offset:2048
    ds_read_b128 v[124:127], v19 offset:3072
    ds_read_b128 v[128:131], v19 offset:4096
    ds_read_b128 v[156:159], v20 offset:4096
    ds_read_b128 v[136:139], v19 offset:5120
    ds_read_b128 v[140:143], v19 offset:6144
    ds_read_b128 v[144:147], v19 offset:7168
    ds_read_b128 v[148:151], v19 offset:8192
    ds_read_b128 v[152:155], v19 offset:9216
    s_barrier
    ds_read_b128 v[180:183], v20 offset:8192
    ds_read_b128 v[160:163], v19 offset:10240
    ds_read_b128 v[164:167], v19 offset:11264
    ds_read_b128 v[168:171], v19 offset:12288
    ds_read_b128 v[172:175], v19 offset:13312
    ds_read_b128 v[176:179], v19 offset:14336
    ds_read_b128 v[204:207], v20 offset:12288
    ds_read_b128 v[184:187], v19 offset:15360
    ds_read_b128 v[188:191], v19 offset:16384
    ds_read_b128 v[192:195], v19 offset:17408
    ds_read_b128 v[196:199], v19 offset:18432
    ds_read_b128 v[200:203], v19 offset:19456
    s_waitcnt lgkmcnt(12)
    v_mfma_f32_16x16x32_bf16 v[48:51], v[112:115], v[132:135], v[48:51]
    v_mfma_f32_16x16x32_bf16 v[52:55], v[116:119], v[132:135], v[52:55]
    s_barrier
    ds_read_b128 v[228:231], v20 offset:16384
    v_mfma_f32_16x16x32_bf16 v[56:59], v[120:123], v[132:135], v[56:59]
    ds_read_b128 v[208:211], v19 offset:20480
    ds_read_b128 v[212:215], v19 offset:21504
    v_mfma_f32_16x16x32_bf16 v[60:63], v[124:127], v[132:135], v[60:63]
    ds_read_b128 v[216:219], v19 offset:22528
    v_mfma_f32_16x16x32_bf16 v[64:67], v[128:131], v[132:135], v[64:67]
    ds_read_b128 v[220:223], v19 offset:23552
    ds_read_b128 v[224:227], v19 offset:24576
    v_mfma_f32_16x16x32_bf16 v[48:51], v[136:139], v[156:159], v[48:51]
    ds_read_b128 v[252:255], v20 offset:20480
    v_mfma_f32_16x16x32_bf16 v[52:55], v[140:143], v[156:159], v[52:55]
    ds_read_b128 v[232:235], v19 offset:25600
    ds_read_b128 v[236:239], v19 offset:26624
    v_mfma_f32_16x16x32_bf16 v[56:59], v[144:147], v[156:159], v[56:59]
    ds_read_b128 v[240:243], v19 offset:27648
    v_mfma_f32_16x16x32_bf16 v[60:63], v[148:151], v[156:159], v[60:63]
    ds_read_b128 v[244:247], v19 offset:28672
    ds_read_b128 v[248:251], v19 offset:29696
    v_mfma_f32_16x16x32_bf16 v[64:67], v[152:155], v[156:159], v[64:67]
    s_waitcnt lgkmcnt(12)
    v_mfma_f32_16x16x32_bf16 v[48:51], v[160:163], v[180:183], v[48:51]
    v_mfma_f32_16x16x32_bf16 v[52:55], v[164:167], v[180:183], v[52:55]
    s_barrier
    ds_read_b128 v[132:135], v20 offset:24576
    v_mfma_f32_16x16x32_bf16 v[56:59], v[168:171], v[180:183], v[56:59]
    ds_read_b128 v[112:115], v21 offset:0
    ds_read_b128 v[116:119], v21 offset:1024
    v_mfma_f32_16x16x32_bf16 v[60:63], v[172:175], v[180:183], v[60:63]
    ds_read_b128 v[120:123], v21 offset:2048
    v_mfma_f32_16x16x32_bf16 v[64:67], v[176:179], v[180:183], v[64:67]
    ds_read_b128 v[124:127], v21 offset:3072
    ds_read_b128 v[128:131], v21 offset:4096
    v_mfma_f32_16x16x32_bf16 v[48:51], v[184:187], v[204:207], v[48:51]
    ds_read_b128 v[156:159], v20 offset:28672
    v_mfma_f32_16x16x32_bf16 v[52:55], v[188:191], v[204:207], v[52:55]
    ds_read_b128 v[136:139], v21 offset:5120
    ds_read_b128 v[140:143], v21 offset:6144
    v_mfma_f32_16x16x32_bf16 v[56:59], v[192:195], v[204:207], v[56:59]
    ds_read_b128 v[144:147], v21 offset:7168
    v_mfma_f32_16x16x32_bf16 v[60:63], v[196:199], v[204:207], v[60:63]
    ds_read_b128 v[148:151], v21 offset:8192
    ds_read_b128 v[152:155], v21 offset:9216
    v_mfma_f32_16x16x32_bf16 v[64:67], v[200:203], v[204:207], v[64:67]
    s_waitcnt lgkmcnt(12)
    v_mfma_f32_16x16x32_bf16 v[48:51], v[208:211], v[228:231], v[48:51]
    v_mfma_f32_16x16x32_bf16 v[52:55], v[212:215], v[228:231], v[52:55]
    s_barrier
    ds_read_b128 v[180:183], v20 offset:32768
    v_mfma_f32_16x16x32_bf16 v[56:59], v[216:219], v[228:231], v[56:59]
    ds_read_b128 v[160:163], v21 offset:10240
    ds_read_b128 v[164:167], v21 offset:11264
    v_mfma_f32_16x16x32_bf16 v[60:63], v[220:223], v[228:231], v[60:63]
    ds_read_b128 v[168:171], v21 offset:12288
    v_mfma_f32_16x16x32_bf16 v[64:67], v[224:227], v[228:231], v[64:67]
    ds_read_b128 v[172:175], v21 offset:13312
    ds_read_b128 v[176:179], v21 offset:14336
    v_mfma_f32_16x16x32_bf16 v[48:51], v[232:235], v[252:255], v[48:51]
    ds_read_b128 v[204:207], v20 offset:36864
    v_mfma_f32_16x16x32_bf16 v[52:55], v[236:239], v[252:255], v[52:55]
    ds_read_b128 v[184:187], v21 offset:15360
    ds_read_b128 v[188:191], v21 offset:16384
    v_mfma_f32_16x16x32_bf16 v[56:59], v[240:243], v[252:255], v[56:59]
    ds_read_b128 v[192:195], v21 offset:17408
    v_mfma_f32_16x16x32_bf16 v[60:63], v[244:247], v[252:255], v[60:63]
    ds_read_b128 v[196:199], v21 offset:18432
    ds_read_b128 v[200:203], v21 offset:19456
    v_mfma_f32_16x16x32_bf16 v[64:67], v[248:251], v[252:255], v[64:67]
    s_waitcnt lgkmcnt(12)
    v_mfma_f32_16x16x32_bf16 v[48:51], v[112:115], v[132:135], v[48:51]
    v_mfma_f32_16x16x32_bf16 v[52:55], v[116:119], v[132:135], v[52:55]
    s_barrier
    ds_read_b128 v[228:231], v20 offset:40960
    v_mfma_f32_16x16x32_bf16 v[56:59], v[120:123], v[132:135], v[56:59]
    ds_read_b128 v[208:211], v21 offset:20480
    ds_read_b128 v[212:215], v21 offset:21504
    v_mfma_f32_16x16x32_bf16 v[60:63], v[124:127], v[132:135], v[60:63]
    ds_read_b128 v[216:219], v21 offset:22528
    v_mfma_f32_16x16x32_bf16 v[64:67], v[128:131], v[132:135], v[64:67]
    ds_read_b128 v[220:223], v21 offset:23552
    ds_read_b128 v[224:227], v21 offset:24576
    v_mfma_f32_16x16x32_bf16 v[48:51], v[136:139], v[156:159], v[48:51]
    ds_read_b128 v[252:255], v20 offset:45056
    v_mfma_f32_16x16x32_bf16 v[52:55], v[140:143], v[156:159], v[52:55]
    ds_read_b128 v[232:235], v21 offset:25600
    ds_read_b128 v[236:239], v21 offset:26624
    v_mfma_f32_16x16x32_bf16 v[56:59], v[144:147], v[156:159], v[56:59]
    ds_read_b128 v[240:243], v21 offset:27648
    v_mfma_f32_16x16x32_bf16 v[60:63], v[148:151], v[156:159], v[60:63]
    ds_read_b128 v[244:247], v21 offset:28672
    ds_read_b128 v[248:251], v21 offset:29696
    v_mfma_f32_16x16x32_bf16 v[64:67], v[152:155], v[156:159], v[64:67]
    s_waitcnt lgkmcnt(12)
    v_mfma_f32_16x16x32_bf16 v[48:51], v[160:163], v[180:183], v[48:51]
    v_mfma_f32_16x16x32_bf16 v[52:55], v[164:167], v[180:183], v[52:55]
    s_barrier
    ds_read_b128 v[132:135], v20 offset:49152
    v_mfma_f32_16x16x32_bf16 v[56:59], v[168:171], v[180:183], v[56:59]
    ds_read_b128 v[112:115], v21 offset:30720
    ds_read_b128 v[116:119], v21 offset:31744
    v_mfma_f32_16x16x32_bf16 v[60:63], v[172:175], v[180:183], v[60:63]
    ds_read_b128 v[120:123], v21 offset:32768
    v_mfma_f32_16x16x32_bf16 v[64:67], v[176:179], v[180:183], v[64:67]
    ds_read_b128 v[124:127], v21 offset:33792
    ds_read_b128 v[128:131], v21 offset:34816
    v_mfma_f32_16x16x32_bf16 v[48:51], v[184:187], v[204:207], v[48:51]
    ds_read_b128 v[156:159], v20 offset:53248
    v_mfma_f32_16x16x32_bf16 v[52:55], v[188:191], v[204:207], v[52:55]
    ds_read_b128 v[136:139], v21 offset:35840
    ds_read_b128 v[140:143], v21 offset:36864
    v_mfma_f32_16x16x32_bf16 v[56:59], v[192:195], v[204:207], v[56:59]
    ds_read_b128 v[144:147], v21 offset:37888
    v_mfma_f32_16x16x32_bf16 v[60:63], v[196:199], v[204:207], v[60:63]
    ds_read_b128 v[148:151], v21 offset:38912
    ds_read_b128 v[152:155], v21 offset:39936
    v_mfma_f32_16x16x32_bf16 v[64:67], v[200:203], v[204:207], v[64:67]
    s_waitcnt lgkmcnt(12)
    v_mfma_f32_16x16x32_bf16 v[48:51], v[208:211], v[228:231], v[48:51]
    v_mfma_f32_16x16x32_bf16 v[52:55], v[212:215], v[228:231], v[52:55]
    s_barrier
    ds_read_b128 v[180:183], v20 offset:0
    v_mfma_f32_16x16x32_bf16 v[56:59], v[216:219], v[228:231], v[56:59]
    ds_read_b128 v[160:163], v19 offset:0
    ds_read_b128 v[164:167], v19 offset:1024
    v_mfma_f32_16x16x32_bf16 v[60:63], v[220:223], v[228:231], v[60:63]
    ds_read_b128 v[168:171], v19 offset:2048
    v_mfma_f32_16x16x32_bf16 v[64:67], v[224:227], v[228:231], v[64:67]
    ds_read_b128 v[172:175], v19 offset:3072
    ds_read_b128 v[176:179], v19 offset:4096
    v_mfma_f32_16x16x32_bf16 v[48:51], v[232:235], v[252:255], v[48:51]
    ds_read_b128 v[204:207], v20 offset:4096
    v_mfma_f32_16x16x32_bf16 v[52:55], v[236:239], v[252:255], v[52:55]
    ds_read_b128 v[184:187], v19 offset:5120
    ds_read_b128 v[188:191], v19 offset:6144
    v_mfma_f32_16x16x32_bf16 v[56:59], v[240:243], v[252:255], v[56:59]
    ds_read_b128 v[192:195], v19 offset:7168
    v_mfma_f32_16x16x32_bf16 v[60:63], v[244:247], v[252:255], v[60:63]
    ds_read_b128 v[196:199], v19 offset:8192
    ds_read_b128 v[200:203], v19 offset:9216
    v_mfma_f32_16x16x32_bf16 v[64:67], v[248:251], v[252:255], v[64:67]
    s_waitcnt lgkmcnt(12)
    v_mfma_f32_16x16x32_bf16 v[48:51], v[112:115], v[132:135], v[48:51]
    v_mfma_f32_16x16x32_bf16 v[52:55], v[116:119], v[132:135], v[52:55]
    s_barrier
    ds_read_b128 v[228:231], v20 offset:8192
    v_mfma_f32_16x16x32_bf16 v[56:59], v[120:123], v[132:135], v[56:59]
    ds_read_b128 v[208:211], v19 offset:10240
    ds_read_b128 v[212:215], v19 offset:11264
    v_mfma_f32_16x16x32_bf16 v[60:63], v[124:127], v[132:135], v[60:63]
    ds_read_b128 v[216:219], v19 offset:12288
    v_mfma_f32_16x16x32_bf16 v[64:67], v[128:131], v[132:135], v[64:67]
    ds_read_b128 v[220:223], v19 offset:13312
    ds_read_b128 v[224:227], v19 offset:14336
    v_mfma_f32_16x16x32_bf16 v[48:51], v[136:139], v[156:159], v[48:51]
    ds_read_b128 v[252:255], v20 offset:12288
    v_mfma_f32_16x16x32_bf16 v[52:55], v[140:143], v[156:159], v[52:55]
    ds_read_b128 v[232:235], v19 offset:15360
    ds_read_b128 v[236:239], v19 offset:16384
    v_mfma_f32_16x16x32_bf16 v[56:59], v[144:147], v[156:159], v[56:59]
    ds_read_b128 v[240:243], v19 offset:17408
    v_mfma_f32_16x16x32_bf16 v[60:63], v[148:151], v[156:159], v[60:63]
    ds_read_b128 v[244:247], v19 offset:18432
    ds_read_b128 v[248:251], v19 offset:19456
    v_mfma_f32_16x16x32_bf16 v[64:67], v[152:155], v[156:159], v[64:67]
    s_waitcnt lgkmcnt(12)
    v_mfma_f32_16x16x32_bf16 v[48:51], v[160:163], v[180:183], v[48:51]
    v_mfma_f32_16x16x32_bf16 v[52:55], v[164:167], v[180:183], v[52:55]
    s_barrier
    ds_read_b128 v[132:135], v20 offset:16384
    v_mfma_f32_16x16x32_bf16 v[56:59], v[168:171], v[180:183], v[56:59]
    ds_read_b128 v[112:115], v19 offset:20480
    ds_read_b128 v[116:119], v19 offset:21504
    v_mfma_f32_16x16x32_bf16 v[60:63], v[172:175], v[180:183], v[60:63]
    ds_read_b128 v[120:123], v19 offset:22528
    v_mfma_f32_16x16x32_bf16 v[64:67], v[176:179], v[180:183], v[64:67]
    ds_read_b128 v[124:127], v19 offset:23552
    ds_read_b128 v[128:131], v19 offset:24576
    v_mfma_f32_16x16x32_bf16 v[48:51], v[184:187], v[204:207], v[48:51]
    ds_read_b128 v[156:159], v20 offset:20480
    v_mfma_f32_16x16x32_bf16 v[52:55], v[188:191], v[204:207], v[52:55]
    ds_read_b128 v[136:139], v19 offset:25600
    ds_read_b128 v[140:143], v19 offset:26624
    v_mfma_f32_16x16x32_bf16 v[56:59], v[192:195], v[204:207], v[56:59]
    ds_read_b128 v[144:147], v19 offset:27648
    v_mfma_f32_16x16x32_bf16 v[60:63], v[196:199], v[204:207], v[60:63]
    ds_read_b128 v[148:151], v19 offset:28672
    ds_read_b128 v[152:155], v19 offset:29696
    v_mfma_f32_16x16x32_bf16 v[64:67], v[200:203], v[204:207], v[64:67]
    s_waitcnt lgkmcnt(12)
    v_mfma_f32_16x16x32_bf16 v[48:51], v[208:211], v[228:231], v[48:51]
    v_mfma_f32_16x16x32_bf16 v[52:55], v[212:215], v[228:231], v[52:55]
    s_waitcnt vmcnt(0)
    s_cmp_lg_u32 s78, 0
    s_cbranch_scc1 noy_14
    buffer_store_dwordx2 v[22:23], v24, s[44:47], s77 offen sc1
noy_14:
    s_barrier
    ds_read_b128 v[180:183], v20 offset:24576
    v_mfma_f32_16x16x32_bf16 v[56:59], v[216:219], v[228:231], v[56:59]
    v_lshlrev_b32 v2, 16, v68
    v_and_b32 v3, 0xffff0000, v68
    ds_read_b128 v[160:163], v21 offset:0
    ds_read_b128 v[164:167], v21 offset:1024
    v_mfma_f32_16x16x32_bf16 v[60:63], v[220:223], v[228:231], v[60:63]
    v_lshlrev_b32 v4, 16, v69
    v_and_b32 v5, 0xffff0000, v69
    ds_read_b128 v[168:171], v21 offset:2048
    v_mfma_f32_16x16x32_bf16 v[64:67], v[224:227], v[228:231], v[64:67]
    v_sub_f32 v2, v2, v78
    v_sub_f32 v3, v3, v78
    ds_read_b128 v[172:175], v21 offset:3072
    ds_read_b128 v[176:179], v21 offset:4096
    v_mfma_f32_16x16x32_bf16 v[48:51], v[232:235], v[252:255], v[48:51]
    v_sub_f32 v4, v4, v78
    v_sub_f32 v5, v5, v78
    ds_read_b128 v[204:207], v20 offset:28672
    v_mfma_f32_16x16x32_bf16 v[52:55], v[236:239], v[252:255], v[52:55]
    v_cvt_pk_bf16_f32 v6, v2, v3
    v_cvt_pk_bf16_f32 v7, v4, v5
    ds_read_b128 v[184:187], v21 offset:5120
    ds_read_b128 v[188:191], v21 offset:6144
    v_mfma_f32_16x16x32_bf16 v[56:59], v[240:243], v[252:255], v[56:59]
    v_lshlrev_b32 v2, 16, v6
    v_and_b32 v3, 0xffff0000, v6
    ds_read_b128 v[192:195], v21 offset:7168
    v_mfma_f32_16x16x32_bf16 v[60:63], v[244:247], v[252:255], v[60:63]
    v_lshlrev_b32 v4, 16, v7
    v_and_b32 v5, 0xffff0000, v7
    ds_read_b128 v[196:199], v21 offset:8192
    ds_read_b128 v[200:203], v21 offset:9216
    v_mfma_f32_16x16x32_bf16 v[64:67], v[248:251], v[252:255], v[64:67]
    v_mul_f32 v6, v2, v79
    v_mul_f32 v7, v3, v79
    s_waitcnt lgkmcnt(12)
    v_mfma_f32_16x16x32_bf16 v[48:51], v[112:115], v[132:135], v[48:51]
    v_mfma_f32_16x16x32_bf16 v[52:55], v[116:119], v[132:135], v[52:55]
    s_barrier
    ds_read_b128 v[228:231], v20 offset:32768
    v_mfma_f32_16x16x32_bf16 v[56:59], v[120:123], v[132:135], v[56:59]
    v_mul_f32 v8, v4, v79
    v_mul_f32 v9, v5, v79
    ds_read_b128 v[208:211], v21 offset:10240
    ds_read_b128 v[212:215], v21 offset:11264
    v_mfma_f32_16x16x32_bf16 v[60:63], v[124:127], v[132:135], v[60:63]
    v_fma_f32 v2, -v6, v80, v2
    v_fma_f32 v3, -v7, v80, v3
    ds_read_b128 v[216:219], v21 offset:12288
    v_mfma_f32_16x16x32_bf16 v[64:67], v[128:131], v[132:135], v[64:67]
    v_fma_f32 v4, -v8, v80, v4
    v_fma_f32 v5, -v9, v80, v5
    ds_read_b128 v[220:223], v21 offset:13312
    ds_read_b128 v[224:227], v21 offset:14336
    v_mfma_f32_16x16x32_bf16 v[48:51], v[136:139], v[156:159], v[48:51]
    v_fma_f32 v6, v2, v79, v6
    v_fma_f32 v7, v3, v79, v7
    ds_read_b128 v[252:255], v20 offset:36864
    v_mfma_f32_16x16x32_bf16 v[52:55], v[140:143], v[156:159], v[52:55]
    v_fma_f32 v8, v4, v79, v8
    v_fma_f32 v9, v5, v79, v9
    ds_read_b128 v[232:235], v21 offset:15360
    ds_read_b128 v[236:239], v21 offset:16384
    v_mfma_f32_16x16x32_bf16 v[56:59], v[144:147], v[156:159], v[56:59]
    v_cvt_pk_bf16_f32 v2, v6, v7
    v_cvt_pk_bf16_f32 v3, v8, v9
    ds_read_b128 v[240:243], v21 offset:17408
    v_mfma_f32_16x16x32_bf16 v[60:63], v[148:151], v[156:159], v[60:63]
    v_lshlrev_b32 v6, 16, v2
    v_and_b32 v7, 0xffff0000, v2
    ds_read_b128 v[244:247], v21 offset:18432
    ds_read_b128 v[248:251], v21 offset:19456
    v_mfma_f32_16x16x32_bf16 v[64:67], v[152:155], v[156:159], v[64:67]
    v_lshlrev_b32 v8, 16, v3
    v_and_b32 v9, 0xffff0000, v3
    s_waitcnt lgkmcnt(12)
    v_mfma_f32_16x16x32_bf16 v[48:51], v[160:163], v[180:183], v[48:51]
    v_mfma_f32_16x16x32_bf16 v[52:55], v[164:167], v[180:183], v[52:55]
    s_barrier
    ds_read_b128 v[132:135], v20 offset:40960
    v_mfma_f32_16x16x32_bf16 v[56:59], v[168:171], v[180:183], v[56:59]
    v_lshlrev_b32 v12, 16, v82
    v_and_b32 v13, 0xffff0000, v82
    ds_read_b128 v[112:115], v21 offset:20480
    ds_read_b128 v[116:119], v21 offset:21504
    v_mfma_f32_16x16x32_bf16 v[60:63], v[172:175], v[180:183], v[60:63]
    v_lshlrev_b32 v14, 16, v83
    v_and_b32 v15, 0xffff0000, v83
    ds_read_b128 v[120:123], v21 offset:22528
    v_mfma_f32_16x16x32_bf16 v[64:67], v[176:179], v[180:183], v[64:67]
    v_mul_f32 v6, v6, v12
    v_mul_f32 v7, v7, v13
    ds_read_b128 v[124:127], v21 offset:23552
    ds_read_b128 v[128:131], v21 offset:24576
    v_mfma_f32_16x16x32_bf16 v[48:51], v[184:187], v[204:207], v[48:51]
    v_mul_f32 v8, v8, v14
    v_mul_f32 v9, v9, v15
    ds_read_b128 v[156:159], v20 offset:45056
    v_mfma_f32_16x16x32_bf16 v[52:55], v[188:191], v[204:207], v[52:55]
    v_cvt_pk_bf16_f32 v2, v6, v7
    v_cvt_pk_bf16_f32 v3, v8, v9
    ds_read_b128 v[136:139], v21 offset:25600
    ds_read_b128 v[140:143], v21 offset:26624
    v_mfma_f32_16x16x32_bf16 v[56:59], v[192:195], v[204:207], v[56:59]
    v_lshlrev_b32 v92, 16, v2
    v_and_b32 v93, 0xffff0000, v2
    ds_read_b128 v[144:147], v21 offset:27648
    v_mfma_f32_16x16x32_bf16 v[60:63], v[196:199], v[204:207], v[60:63]
    v_lshlrev_b32 v94, 16, v3
    v_and_b32 v95, 0xffff0000, v3
    ds_read_b128 v[148:151], v21 offset:28672
    ds_read_b128 v[152:155], v21 offset:29696
    v_mfma_f32_16x16x32_bf16 v[64:67], v[200:203], v[204:207], v[64:67]
    v_lshlrev_b32 v2, 16, v70
    v_and_b32 v3, 0xffff0000, v70
    s_waitcnt lgkmcnt(12)
    v_mfma_f32_16x16x32_bf16 v[48:51], v[208:211], v[228:231], v[48:51]
    v_mfma_f32_16x16x32_bf16 v[52:55], v[212:215], v[228:231], v[52:55]
    s_barrier
    ds_read_b128 v[180:183], v20 offset:49152
    v_mfma_f32_16x16x32_bf16 v[56:59], v[216:219], v[228:231], v[56:59]
    v_lshlrev_b32 v4, 16, v71
    v_and_b32 v5, 0xffff0000, v71
    ds_read_b128 v[160:163], v21 offset:30720
    ds_read_b128 v[164:167], v21 offset:31744
    v_mfma_f32_16x16x32_bf16 v[60:63], v[220:223], v[228:231], v[60:63]
    v_sub_f32 v2, v2, v78
    v_sub_f32 v3, v3, v78
    ds_read_b128 v[168:171], v21 offset:32768
    v_mfma_f32_16x16x32_bf16 v[64:67], v[224:227], v[228:231], v[64:67]
    v_sub_f32 v4, v4, v78
    v_sub_f32 v5, v5, v78
    ds_read_b128 v[172:175], v21 offset:33792
    ds_read_b128 v[176:179], v21 offset:34816
    v_mfma_f32_16x16x32_bf16 v[48:51], v[232:235], v[252:255], v[48:51]
    v_cvt_pk_bf16_f32 v6, v2, v3
    v_cvt_pk_bf16_f32 v7, v4, v5
    ds_read_b128 v[204:207], v20 offset:53248
    v_mfma_f32_16x16x32_bf16 v[52:55], v[236:239], v[252:255], v[52:55]
    v_lshlrev_b32 v2, 16, v6
    v_and_b32 v3, 0xffff0000, v6
    ds_read_b128 v[184:187], v21 offset:35840
    ds_read_b128 v[188:191], v21 offset:36864
    v_mfma_f32_16x16x32_bf16 v[56:59], v[240:243], v[252:255], v[56:59]
    v_lshlrev_b32 v4, 16, v7
    v_and_b32 v5, 0xffff0000, v7
    ds_read_b128 v[192:195], v21 offset:37888
    v_mfma_f32_16x16x32_bf16 v[60:63], v[244:247], v[252:255], v[60:63]
    v_mul_f32 v6, v2, v79
    v_mul_f32 v7, v3, v79
    ds_read_b128 v[196:199], v21 offset:38912
    ds_read_b128 v[200:203], v21 offset:39936
    v_mfma_f32_16x16x32_bf16 v[64:67], v[248:251], v[252:255], v[64:67]
    v_mul_f32 v8, v4, v79
    v_mul_f32 v9, v5, v79
    s_waitcnt lgkmcnt(12)
    v_mfma_f32_16x16x32_bf16 v[48:51], v[112:115], v[132:135], v[48:51]
    v_mfma_f32_16x16x32_bf16 v[52:55], v[116:119], v[132:135], v[52:55]
    s_barrier
    ds_read_b128 v[228:231], v20 offset:0
    v_mfma_f32_16x16x32_bf16 v[56:59], v[120:123], v[132:135], v[56:59]
    v_fma_f32 v2, -v6, v80, v2
    v_fma_f32 v3, -v7, v80, v3
    ds_read_b128 v[208:211], v19 offset:0
    ds_read_b128 v[212:215], v19 offset:1024
    v_mfma_f32_16x16x32_bf16 v[60:63], v[124:127], v[132:135], v[60:63]
    v_fma_f32 v4, -v8, v80, v4
    v_fma_f32 v5, -v9, v80, v5
    ds_read_b128 v[216:219], v19 offset:2048
    v_mfma_f32_16x16x32_bf16 v[64:67], v[128:131], v[132:135], v[64:67]
    v_fma_f32 v6, v2, v79, v6
    v_fma_f32 v7, v3, v79, v7
    ds_read_b128 v[220:223], v19 offset:3072
    ds_read_b128 v[224:227], v19 offset:4096
    v_mfma_f32_16x16x32_bf16 v[48:51], v[136:139], v[156:159], v[48:51]
    v_fma_f32 v8, v4, v79, v8
    v_fma_f32 v9, v5, v79, v9
    ds_read_b128 v[252:255], v20 offset:4096
    v_mfma_f32_16x16x32_bf16 v[52:55], v[140:143], v[156:159], v[52:55]
    v_cvt_pk_bf16_f32 v2, v6, v7
    v_cvt_pk_bf16_f32 v3, v8, v9
    ds_read_b128 v[232:235], v19 offset:5120
    ds_read_b128 v[236:239], v19 offset:6144
    v_mfma_f32_16x16x32_bf16 v[56:59], v[144:147], v[156:159], v[56:59]
    v_lshlrev_b32 v6, 16, v2
    v_and_b32 v7, 0xffff0000, v2
    ds_read_b128 v[240:243], v19 offset:7168
    v_mfma_f32_16x16x32_bf16 v[60:63], v[148:151], v[156:159], v[60:63]
    v_lshlrev_b32 v8, 16, v3
    v_and_b32 v9, 0xffff0000, v3
    ds_read_b128 v[244:247], v19 offset:8192
    ds_read_b128 v[248:251], v19 offset:9216
    v_mfma_f32_16x16x32_bf16 v[64:67], v[152:155], v[156:159], v[64:67]
    v_lshlrev_b32 v12, 16, v84
    v_and_b32 v13, 0xffff0000, v84
    s_waitcnt lgkmcnt(12)
    v_mfma_f32_16x16x32_bf16 v[48:51], v[160:163], v[180:183], v[48:51]
    v_mfma_f32_16x16x32_bf16 v[52:55], v[164:167], v[180:183], v[52:55]
    s_barrier
    ds_read_b128 v[132:135], v20 offset:8192
    v_mfma_f32_16x16x32_bf16 v[56:59], v[168:171], v[180:183], v[56:59]
    v_lshlrev_b32 v14, 16, v85
    v_and_b32 v15, 0xffff0000, v85
    ds_read_b128 v[112:115], v19 offset:10240
    ds_read_b128 v[116:119], v19 offset:11264
    v_mfma_f32_16x16x32_bf16 v[60:63], v[172:175], v[180:183], v[60:63]
    v_mul_f32 v6, v6, v12
    v_mul_f32 v7, v7, v13
    ds_read_b128 v[120:123], v19 offset:12288
    v_mfma_f32_16x16x32_bf16 v[64:67], v[176:179], v[180:183], v[64:67]
    v_mul_f32 v8, v8, v14
    v_mul_f32 v9, v9, v15
    ds_read_b128 v[124:127], v19 offset:13312
    ds_read_b128 v[128:131], v19 offset:14336
    v_mfma_f32_16x16x32_bf16 v[48:51], v[184:187], v[204:207], v[48:51]
    v_cvt_pk_bf16_f32 v2, v6, v7
    v_cvt_pk_bf16_f32 v3, v8, v9
    ds_read_b128 v[156:159], v20 offset:12288
    v_mfma_f32_16x16x32_bf16 v[52:55], v[188:191], v[204:207], v[52:55]
    v_lshlrev_b32 v96, 16, v2
    v_and_b32 v97, 0xffff0000, v2
    ds_read_b128 v[136:139], v19 offset:15360
    ds_read_b128 v[140:143], v19 offset:16384
    v_mfma_f32_16x16x32_bf16 v[56:59], v[192:195], v[204:207], v[56:59]
    v_lshlrev_b32 v98, 16, v3
    v_and_b32 v99, 0xffff0000, v3
    ds_read_b128 v[144:147], v19 offset:17408
    v_mfma_f32_16x16x32_bf16 v[60:63], v[196:199], v[204:207], v[60:63]
    v_lshlrev_b32 v2, 16, v72
    v_and_b32 v3, 0xffff0000, v72
    ds_read_b128 v[148:151], v19 offset:18432
    ds_read_b128 v[152:155], v19 offset:19456
    v_mfma_f32_16x16x32_bf16 v[64:67], v[200:203], v[204:207], v[64:67]
    v_lshlrev_b32 v4, 16, v73
    v_and_b32 v5, 0xffff0000, v73
    s_waitcnt lgkmcnt(12)
    v_mfma_f32_16x16x32_bf16 v[48:51], v[208:211], v[228:231], v[48:51]
    v_mfma_f32_16x16x32_bf16 v[52:55], v[212:215], v[228:231], v[52:55]
    s_barrier
    ds_read_b128 v[180:183], v20 offset:16384
    v_mfma_f32_16x16x32_bf16 v[56:59], v[216:219], v[228:231], v[56:59]
    v_sub_f32 v2, v2, v78
    v_sub_f32 v3, v3, v78
    ds_read_b128 v[160:163], v19 offset:20480
    ds_read_b128 v[164:167], v19 offset:21504
    v_mfma_f32_16x16x32_bf16 v[60:63], v[220:223], v[228:231], v[60:63]
    v_sub_f32 v4, v4, v78
    v_sub_f32 v5, v5, v78
    ds_read_b128 v[168:171], v19 offset:22528
    v_mfma_f32_16x16x32_bf16 v[64:67], v[224:227], v[228:231], v[64:67]
    v_cvt_pk_bf16_f32 v6, v2, v3
    v_cvt_pk_bf16_f32 v7, v4, v5
    ds_read_b128 v[172:175], v19 offset:23552
    ds_read_b128 v[176:179], v19 offset:24576
    v_mfma_f32_16x16x32_bf16 v[48:51], v[232:235], v[252:255], v[48:51]
    v_lshlrev_b32 v2, 16, v6
    v_and_b32 v3, 0xffff0000, v6
    ds_read_b128 v[204:207], v20 offset:20480
    v_mfma_f32_16x16x32_bf16 v[52:55], v[236:239], v[252:255], v[52:55]
    v_lshlrev_b32 v4, 16, v7
    v_and_b32 v5, 0xffff0000, v7
    ds_read_b128 v[184:187], v19 offset:25600
    ds_read_b128 v[188:191], v19 offset:26624
    v_mfma_f32_16x16x32_bf16 v[56:59], v[240:243], v[252:255], v[56:59]
    v_mul_f32 v6, v2, v79
    v_mul_f32 v7, v3, v79
    ds_read_b128 v[192:195], v19 offset:27648
    v_mfma_f32_16x16x32_bf16 v[60:63], v[244:247], v[252:255], v[60:63]
    v_mul_f32 v8, v4, v79
    v_mul_f32 v9, v5, v79
    ds_read_b128 v[196:199], v19 offset:28672
    ds_read_b128 v[200:203], v19 offset:29696
    v_mfma_f32_16x16x32_bf16 v[64:67], v[248:251], v[252:255], v[64:67]
    v_fma_f32 v2, -v6, v80, v2
    v_fma_f32 v3, -v7, v80, v3
    s_waitcnt lgkmcnt(12)
    v_mfma_f32_16x16x32_bf16 v[48:51], v[112:115], v[132:135], v[48:51]
    v_mfma_f32_16x16x32_bf16 v[52:55], v[116:119], v[132:135], v[52:55]
    s_barrier
    ds_read_b128 v[228:231], v20 offset:24576
    v_mfma_f32_16x16x32_bf16 v[56:59], v[120:123], v[132:135], v[56:59]
    v_fma_f32 v4, -v8, v80, v4
    v_fma_f32 v5, -v9, v80, v5
    ds_read_b128 v[208:211], v21 offset:0
    ds_read_b128 v[212:215], v21 offset:1024
    v_mfma_f32_16x16x32_bf16 v[60:63], v[124:127], v[132:135], v[60:63]
    v_fma_f32 v6, v2, v79, v6
    v_fma_f32 v7, v3, v79, v7
    ds_read_b128 v[216:219], v21 offset:2048
    v_mfma_f32_16x16x32_bf16 v[64:67], v[128:131], v[132:135], v[64:67]
    v_fma_f32 v8, v4, v79, v8
    v_fma_f32 v9, v5, v79, v9
    ds_read_b128 v[220:223], v21 offset:3072
    ds_read_b128 v[224:227], v21 offset:4096
    v_mfma_f32_16x16x32_bf16 v[48:51], v[136:139], v[156:159], v[48:51]
    v_cvt_pk_bf16_f32 v2, v6, v7
    v_cvt_pk_bf16_f32 v3, v8, v9
    ds_read_b128 v[252:255], v20 offset:28672
    v_mfma_f32_16x16x32_bf16 v[52:55], v[140:143], v[156:159], v[52:55]
    v_lshlrev_b32 v6, 16, v2
    v_and_b32 v7, 0xffff0000, v2
    ds_read_b128 v[232:235], v21 offset:5120
    ds_read_b128 v[236:239], v21 offset:6144
    v_mfma_f32_16x16x32_bf16 v[56:59], v[144:147], v[156:159], v[56:59]
    v_lshlrev_b32 v8, 16, v3
    v_and_b32 v9, 0xffff0000, v3
    ds_read_b128 v[240:243], v21 offset:7168
    v_mfma_f32_16x16x32_bf16 v[60:63], v[148:151], v[156:159], v[60:63]
    v_lshlrev_b32 v12, 16, v86
    v_and_b32 v13, 0xffff0000, v86
    ds_read_b128 v[244:247], v21 offset:8192
    ds_read_b128 v[248:251], v21 offset:9216
    v_mfma_f32_16x16x32_bf16 v[64:67], v[152:155], v[156:159], v[64:67]
    v_lshlrev_b32 v14, 16, v87
    v_and_b32 v15, 0xffff0000, v87
    s_waitcnt lgkmcnt(12)
    v_mfma_f32_16x16x32_bf16 v[48:51], v[160:163], v[180:183], v[48:51]
    v_mfma_f32_16x16x32_bf16 v[52:55], v[164:167], v[180:183], v[52:55]
    s_barrier
    ds_read_b128 v[132:135], v20 offset:32768
    v_mfma_f32_16x16x32_bf16 v[56:59], v[168:171], v[180:183], v[56:59]
    v_mul_f32 v6, v6, v12
    v_mul_f32 v7, v7, v13
    ds_read_b128 v[112:115], v21 offset:10240
    ds_read_b128 v[116:119], v21 offset:11264
    v_mfma_f32_16x16x32_bf16 v[60:63], v[172:175], v[180:183], v[60:63]
    v_mul_f32 v8, v8, v14
    v_mul_f32 v9, v9, v15
    ds_read_b128 v[120:123], v21 offset:12288
    v_mfma_f32_16x16x32_bf16 v[64:67], v[176:179], v[180:183], v[64:67]
    v_cvt_pk_bf16_f32 v2, v6, v7
    v_cvt_pk_bf16_f32 v3, v8, v9
    ds_read_b128 v[124:127], v21 offset:13312
    ds_read_b128 v[128:131], v21 offset:14336
    v_mfma_f32_16x16x32_bf16 v[48:51], v[184:187], v[204:207], v[48:51]
    v_lshlrev_b32 v100, 16, v2
    v_and_b32 v101, 0xffff0000, v2
    ds_read_b128 v[156:159], v20 offset:36864
    v_mfma_f32_16x16x32_bf16 v[52:55], v[188:191], v[204:207], v[52:55]
    v_lshlrev_b32 v102, 16, v3
    v_and_b32 v103, 0xffff0000, v3
    ds_read_b128 v[136:139], v21 offset:15360
    ds_read_b128 v[140:143], v21 offset:16384
    v_mfma_f32_16x16x32_bf16 v[56:59], v[192:195], v[204:207], v[56:59]
    v_lshlrev_b32 v2, 16, v74
    v_and_b32 v3, 0xffff0000, v74
    ds_read_b128 v[144:147], v21 offset:17408
    v_mfma_f32_16x16x32_bf16 v[60:63], v[196:199], v[204:207], v[60:63]
    v_lshlrev_b32 v4, 16, v75
    v_and_b32 v5, 0xffff0000, v75
    ds_read_b128 v[148:151], v21 offset:18432
    ds_read_b128 v[152:155], v21 offset:19456
    v_mfma_f32_16x16x32_bf16 v[64:67], v[200:203], v[204:207], v[64:67]
    v_sub_f32 v2, v2, v78
    v_sub_f32 v3, v3, v78
    s_waitcnt lgkmcnt(12)
    v_mfma_f32_16x16x32_bf16 v[48:51], v[208:211], v[228:231], v[48:51]
    v_mfma_f32_16x16x32_bf16 v[52:55], v[212:215], v[228:231], v[52:55]
    s_barrier
    ds_read_b128 v[180:183], v20 offset:40960
    v_mfma_f32_16x16x32_bf16 v[56:59], v[216:219], v[228:231], v[56:59]
    v_sub_f32 v4, v4, v78
    v_sub_f32 v5, v5, v78
    ds_read_b128 v[160:163], v21 offset:20480
    ds_read_b128 v[164:167], v21 offset:21504
    v_mfma_f32_16x16x32_bf16 v[60:63], v[220:223], v[228:231], v[60:63]
    v_cvt_pk_bf16_f32 v6, v2, v3
    v_cvt_pk_bf16_f32 v7, v4, v5
    ds_read_b128 v[168:171], v21 offset:22528
    v_mfma_f32_16x16x32_bf16 v[64:67], v[224:227], v[228:231], v[64:67]
    v_lshlrev_b32 v2, 16, v6
    v_and_b32 v3, 0xffff0000, v6
    ds_read_b128 v[172:175], v21 offset:23552
    ds_read_b128 v[176:179], v21 offset:24576
    v_mfma_f32_16x16x32_bf16 v[48:51], v[232:235], v[252:255], v[48:51]
    v_lshlrev_b32 v4, 16, v7
    v_and_b32 v5, 0xffff0000, v7
    ds_read_b128 v[204:207], v20 offset:45056
    v_mfma_f32_16x16x32_bf16 v[52:55], v[236:239], v[252:255], v[52:55]
    v_mul_f32 v6, v2, v79
    v_mul_f32 v7, v3, v79
    ds_read_b128 v[184:187], v21 offset:25600
    ds_read_b128 v[188:191], v21 offset:26624
    v_mfma_f32_16x16x32_bf16 v[56:59], v[240:243], v[252:255], v[56:59]
    v_mul_f32 v8, v4, v79
    v_mul_f32 v9, v5, v79
    ds_read_b128 v[192:195], v21 offset:27648
    v_mfma_f32_16x16x32_bf16 v[60:63], v[244:247], v[252:255], v[60:63]
    v_fma_f32 v2, -v6, v80, v2
    v_fma_f32 v3, -v7, v80, v3
    ds_read_b128 v[196:199], v21 offset:28672
    ds_read_b128 v[200:203], v21 offset:29696
    v_mfma_f32_16x16x32_bf16 v[64:67], v[248:251], v[252:255], v[64:67]
    v_fma_f32 v4, -v8, v80, v4
    v_fma_f32 v5, -v9, v80, v5
    s_waitcnt lgkmcnt(12)
    v_mfma_f32_16x16x32_bf16 v[48:51], v[112:115], v[132:135], v[48:51]
    v_mfma_f32_16x16x32_bf16 v[52:55], v[116:119], v[132:135], v[52:55]
    s_barrier
    ds_read_b128 v[228:231], v20 offset:49152
    v_mfma_f32_16x16x32_bf16 v[56:59], v[120:123], v[132:135], v[56:59]
    v_fma_f32 v6, v2, v79, v6
    v_fma_f32 v7, v3, v79, v7
    ds_read_b128 v[208:211], v21 offset:30720
    ds_read_b128 v[212:215], v21 offset:31744
    v_mfma_f32_16x16x32_bf16 v[60:63], v[124:127], v[132:135], v[60:63]
    v_fma_f32 v8, v4, v79, v8
    v_fma_f32 v9, v5, v79, v9
    ds_read_b128 v[216:219], v21 offset:32768
    v_mfma_f32_16x16x32_bf16 v[64:67], v[128:131], v[132:135], v[64:67]
    v_cvt_pk_bf16_f32 v2, v6, v7
    v_cvt_pk_bf16_f32 v3, v8, v9
    ds_read_b128 v[220:223], v21 offset:33792
    ds_read_b128 v[224:227], v21 offset:34816
    v_mfma_f32_16x16x32_bf16 v[48:51], v[136:139], v[156:159], v[48:51]
    v_lshlrev_b32 v6, 16, v2
    v_and_b32 v7, 0xffff0000, v2
    ds_read_b128 v[252:255], v20 offset:53248
    v_mfma_f32_16x16x32_bf16 v[52:55], v[140:143], v[156:159], v[52:55]
    v_lshlrev_b32 v8, 16, v3
    v_and_b32 v9, 0xffff0000, v3
    ds_read_b128 v[232:235], v21 offset:35840
    ds_read_b128 v[236:239], v21 offset:36864
    v_mfma_f32_16x16x32_bf16 v[56:59], v[144:147], v[156:159], v[56:59]
    v_lshlrev_b32 v12, 16, v88
    v_and_b32 v13, 0xffff0000, v88
    ds_read_b128 v[240:243], v21 offset:37888
    v_mfma_f32_16x16x32_bf16 v[60:63], v[148:151], v[156:159], v[60:63]
    v_lshlrev_b32 v14, 16, v89
    v_and_b32 v15, 0xffff0000, v89
    ds_read_b128 v[244:247], v21 offset:38912
    ds_read_b128 v[248:251], v21 offset:39936
    v_mfma_f32_16x16x32_bf16 v[64:67], v[152:155], v[156:159], v[64:67]
    v_mul_f32 v6, v6, v12
    v_mul_f32 v7, v7, v13
    s_waitcnt lgkmcnt(12)
    v_mfma_f32_16x16x32_bf16 v[48:51], v[160:163], v[180:183], v[48:51]
    v_mfma_f32_16x16x32_bf16 v[52:55], v[164:167], v[180:183], v[52:55]
    s_barrier
    ds_read_b128 v[132:135], v20 offset:0
    v_mfma_f32_16x16x32_bf16 v[56:59], v[168:171], v[180:183], v[56:59]
    v_mul_f32 v8, v8, v14
    v_mul_f32 v9, v9, v15
    ds_read_b128 v[112:115], v19 offset:0
    ds_read_b128 v[116:119], v19 offset:1024
    v_mfma_f32_16x16x32_bf16 v[60:63], v[172:175], v[180:183], v[60:63]
    v_cvt_pk_bf16_f32 v2, v6, v7
    v_cvt_pk_bf16_f32 v3, v8, v9
    ds_read_b128 v[120:123], v19 offset:2048
    v_mfma_f32_16x16x32_bf16 v[64:67], v[176:179], v[180:183], v[64:67]
    v_lshlrev_b32 v104, 16, v2
    v_and_b32 v105, 0xffff0000, v2
    ds_read_b128 v[124:127], v19 offset:3072
    ds_read_b128 v[128:131], v19 offset:4096
    v_mfma_f32_16x16x32_bf16 v[48:51], v[184:187], v[204:207], v[48:51]
    v_lshlrev_b32 v106, 16, v3
    v_and_b32 v107, 0xffff0000, v3
    ds_read_b128 v[156:159], v20 offset:4096
    v_mfma_f32_16x16x32_bf16 v[52:55], v[188:191], v[204:207], v[52:55]
    v_lshlrev_b32 v2, 16, v76
    v_and_b32 v3, 0xffff0000, v76
    ds_read_b128 v[136:139], v19 offset:5120
    ds_read_b128 v[140:143], v19 offset:6144
    v_mfma_f32_16x16x32_bf16 v[56:59], v[192:195], v[204:207], v[56:59]
    v_lshlrev_b32 v4, 16, v77
    v_and_b32 v5, 0xffff0000, v77
    ds_read_b128 v[144:147], v19 offset:7168
    v_mfma_f32_16x16x32_bf16 v[60:63], v[196:199], v[204:207], v[60:63]
    v_sub_f32 v2, v2, v78
    v_sub_f32 v3, v3, v78
    ds_read_b128 v[148:151], v19 offset:8192
    ds_read_b128 v[152:155], v19 offset:9216
    v_mfma_f32_16x16x32_bf16 v[64:67], v[200:203], v[204:207], v[64:67]
    v_sub_f32 v4, v4, v78
    v_sub_f32 v5, v5, v78
    s_waitcnt lgkmcnt(12)
    v_mfma_f32_16x16x32_bf16 v[48:51], v[208:211], v[228:231], v[48:51]
    v_mfma_f32_16x16x32_bf16 v[52:55], v[212:215], v[228:231], v[52:55]
    s_barrier
    ds_read_b128 v[180:183], v20 offset:8192
    v_mfma_f32_16x16x32_bf16 v[56:59], v[216:219], v[228:231], v[56:59]
    v_cvt_pk_bf16_f32 v6, v2, v3
    v_cvt_pk_bf16_f32 v7, v4, v5
    ds_read_b128 v[160:163], v19 offset:10240
    ds_read_b128 v[164:167], v19 offset:11264
    v_mfma_f32_16x16x32_bf16 v[60:63], v[220:223], v[228:231], v[60:63]
    v_lshlrev_b32 v2, 16, v6
    v_and_b32 v3, 0xffff0000, v6
    ds_read_b128 v[168:171], v19 offset:12288
    v_mfma_f32_16x16x32_bf16 v[64:67], v[224:227], v[228:231], v[64:67]
    v_lshlrev_b32 v4, 16, v7
    v_and_b32 v5, 0xffff0000, v7
    ds_read_b128 v[172:175], v19 offset:13312
    ds_read_b128 v[176:179], v19 offset:14336
    v_mfma_f32_16x16x32_bf16 v[48:51], v[232:235], v[252:255], v[48:51]
    v_mul_f32 v6, v2, v79
    v_mul_f32 v7, v3, v79
    ds_read_b128 v[204:207], v20 offset:12288
    v_mfma_f32_16x16x32_bf16 v[52:55], v[236:239], v[252:255], v[52:55]
    v_mul_f32 v8, v4, v79
    v_mul_f32 v9, v5, v79
    ds_read_b128 v[184:187], v19 offset:15360
    ds_read_b128 v[188:191], v19 offset:16384
    v_mfma_f32_16x16x32_bf16 v[56:59], v[240:243], v[252:255], v[56:59]
    v_fma_f32 v2, -v6, v80, v2
    v_fma_f32 v3, -v7, v80, v3
    ds_read_b128 v[192:195], v19 offset:17408
    v_mfma_f32_16x16x32_bf16 v[60:63], v[244:247], v[252:255], v[60:63]
    v_fma_f32 v4, -v8, v80, v4
    v_fma_f32 v5, -v9, v80, v5
    ds_read_b128 v[196:199], v19 offset:18432
    ds_read_b128 v[200:203], v19 offset:19456
    v_mfma_f32_16x16x32_bf16 v[64:67], v[248:251], v[252:255], v[64:67]
    v_fma_f32 v6, v2, v79, v6
    v_fma_f32 v7, v3, v79, v7
    s_waitcnt lgkmcnt(12)
    v_mfma_f32_16x16x32_bf16 v[48:51], v[112:115], v[132:135], v[48:51]
    v_mfma_f32_16x16x32_bf16 v[52:55], v[116:119], v[132:135], v[52:55]
    s_barrier
    ds_read_b128 v[228:231], v20 offset:16384
    v_mfma_f32_16x16x32_bf16 v[56:59], v[120:123], v[132:135], v[56:59]
    v_fma_f32 v8, v4, v79, v8
    v_fma_f32 v9, v5, v79, v9
    ds_read_b128 v[208:211], v19 offset:20480
    ds_read_b128 v[212:215], v19 offset:21504
    v_mfma_f32_16x16x32_bf16 v[60:63], v[124:127], v[132:135], v[60:63]
    v_cvt_pk_bf16_f32 v2, v6, v7
    v_cvt_pk_bf16_f32 v3, v8, v9
    ds_read_b128 v[216:219], v19 offset:22528
    v_mfma_f32_16x16x32_bf16 v[64:67], v[128:131], v[132:135], v[64:67]
    v_lshlrev_b32 v6, 16, v2
    v_and_b32 v7, 0xffff0000, v2
    ds_read_b128 v[220:223], v19 offset:23552
    ds_read_b128 v[224:227], v19 offset:24576
    v_mfma_f32_16x16x32_bf16 v[48:51], v[136:139], v[156:159], v[48:51]
    v_lshlrev_b32 v8, 16, v3
    v_and_b32 v9, 0xffff0000, v3
    ds_read_b128 v[252:255], v20 offset:20480
    v_mfma_f32_16x16x32_bf16 v[52:55], v[140:143], v[156:159], v[52:55]
    v_lshlrev_b32 v12, 16, v90
    v_and_b32 v13, 0xffff0000, v90
    ds_read_b128 v[232:235], v19 offset:25600
    ds_read_b128 v[236:239], v19 offset:26624
    v_mfma_f32_16x16x32_bf16 v[56:59], v[144:147], v[156:159], v[56:59]
    v_lshlrev_b32 v14, 16, v91
    v_and_b32 v15, 0xffff0000, v91
    ds_read_b128 v[240:243], v19 offset:27648
    v_mfma_f32_16x16x32_bf16 v[60:63], v[148:151], v[156:159], v[60:63]
    v_mul_f32 v6, v6, v12
    v_mul_f32 v7, v7, v13
    ds_read_b128 v[244:247], v19 offset:28672
    ds_read_b128 v[248:251], v19 offset:29696
    v_mfma_f32_16x16x32_bf16 v[64:67], v[152:155], v[156:159], v[64:67]
    v_mul_f32 v8, v8, v14
    v_mul_f32 v9, v9, v15
    s_waitcnt lgkmcnt(12)
    v_mfma_f32_16x16x32_bf16 v[48:51], v[160:163], v[180:183], v[48:51]
    v_mfma_f32_16x16x32_bf16 v[52:55], v[164:167], v[180:183], v[52:55]
    s_barrier
    ds_read_b128 v[132:135], v20 offset:24576
    v_mfma_f32_16x16x32_bf16 v[56:59], v[168:171], v[180:183], v[56:59]
    v_cvt_pk_bf16_f32 v2, v6, v7
    v_cvt_pk_bf16_f32 v3, v8, v9
    ds_read_b128 v[112:115], v21 offset:0
    ds_read_b128 v[116:119], v21 offset:1024
    v_mfma_f32_16x16x32_bf16 v[60:63], v[172:175], v[180:183], v[60:63]
    v_lshlrev_b32 v108, 16, v2
    v_and_b32 v109, 0xffff0000, v2
    ds_read_b128 v[120:123], v21 offset:2048
    v_mfma_f32_16x16x32_bf16 v[64:67], v[176:179], v[180:183], v[64:67]
    v_lshlrev_b32 v110, 16, v3
    v_and_b32 v111, 0xffff0000, v3
    ds_read_b128 v[124:127], v21 offset:3072
    ds_read_b128 v[128:131], v21 offset:4096
    v_mfma_f32_16x16x32_bf16 v[48:51], v[184:187], v[204:207], v[48:51]
    ds_read_b128 v[156:159], v20 offset:28672
    v_mfma_f32_16x16x32_bf16 v[52:55], v[188:191], v[204:207], v[52:55]
    ds_read_b128 v[136:139], v21 offset:5120
    ds_read_b128 v[140:143], v21 offset:6144
    v_mfma_f32_16x16x32_bf16 v[56:59], v[192:195], v[204:207], v[56:59]
    ds_read_b128 v[144:147], v21 offset:7168
    v_mfma_f32_16x16x32_bf16 v[60:63], v[196:199], v[204:207], v[60:63]
    ds_read_b128 v[148:151], v21 offset:8192
    ds_read_b128 v[152:155], v21 offset:9216
    v_mfma_f32_16x16x32_bf16 v[64:67], v[200:203], v[204:207], v[64:67]
    s_waitcnt lgkmcnt(12)
    v_mfma_f32_16x16x32_bf16 v[48:51], v[208:211], v[228:231], v[48:51]
    v_mfma_f32_16x16x32_bf16 v[52:55], v[212:215], v[228:231], v[52:55]
    s_barrier
    ds_read_b128 v[180:183], v20 offset:32768
    v_mfma_f32_16x16x32_bf16 v[56:59], v[216:219], v[228:231], v[56:59]
    ds_read_b128 v[160:163], v21 offset:10240
    ds_read_b128 v[164:167], v21 offset:11264
    v_mfma_f32_16x16x32_bf16 v[60:63], v[220:223], v[228:231], v[60:63]
    ds_read_b128 v[168:171], v21 offset:12288
    v_mfma_f32_16x16x32_bf16 v[64:67], v[224:227], v[228:231], v[64:67]
    ds_read_b128 v[172:175], v21 offset:13312
    ds_read_b128 v[176:179], v21 offset:14336
    v_mfma_f32_16x16x32_bf16 v[48:51], v[232:235], v[252:255], v[48:51]
    ds_read_b128 v[204:207], v20 offset:36864
    v_mfma_f32_16x16x32_bf16 v[52:55], v[236:239], v[252:255], v[52:55]
    ds_read_b128 v[184:187], v21 offset:15360
    ds_read_b128 v[188:191], v21 offset:16384
    v_mfma_f32_16x16x32_bf16 v[56:59], v[240:243], v[252:255], v[56:59]
    ds_read_b128 v[192:195], v21 offset:17408
    v_mfma_f32_16x16x32_bf16 v[60:63], v[244:247], v[252:255], v[60:63]
    ds_read_b128 v[196:199], v21 offset:18432
    ds_read_b128 v[200:203], v21 offset:19456
    v_mfma_f32_16x16x32_bf16 v[64:67], v[248:251], v[252:255], v[64:67]
    s_waitcnt lgkmcnt(12)
    v_mfma_f32_16x16x32_bf16 v[48:51], v[112:115], v[132:135], v[48:51]
    v_mfma_f32_16x16x32_bf16 v[52:55], v[116:119], v[132:135], v[52:55]
    s_barrier
    ds_read_b128 v[228:231], v20 offset:40960
    v_mfma_f32_16x16x32_bf16 v[56:59], v[120:123], v[132:135], v[56:59]
    ds_read_b128 v[208:211], v21 offset:20480
    ds_read_b128 v[212:215], v21 offset:21504
    v_mfma_f32_16x16x32_bf16 v[60:63], v[124:127], v[132:135], v[60:63]
    ds_read_b128 v[216:219], v21 offset:22528
    v_mfma_f32_16x16x32_bf16 v[64:67], v[128:131], v[132:135], v[64:67]
    ds_read_b128 v[220:223], v21 offset:23552
    ds_read_b128 v[224:227], v21 offset:24576
    v_mfma_f32_16x16x32_bf16 v[48:51], v[136:139], v[156:159], v[48:51]
    ds_read_b128 v[252:255], v20 offset:45056
    v_mfma_f32_16x16x32_bf16 v[52:55], v[140:143], v[156:159], v[52:55]
    ds_read_b128 v[232:235], v21 offset:25600
    ds_read_b128 v[236:239], v21 offset:26624
    v_mfma_f32_16x16x32_bf16 v[56:59], v[144:147], v[156:159], v[56:59]
    ds_read_b128 v[240:243], v21 offset:27648
    v_mfma_f32_16x16x32_bf16 v[60:63], v[148:151], v[156:159], v[60:63]
    ds_read_b128 v[244:247], v21 offset:28672
    ds_read_b128 v[248:251], v21 offset:29696
    v_mfma_f32_16x16x32_bf16 v[64:67], v[152:155], v[156:159], v[64:67]
    s_waitcnt lgkmcnt(12)
    v_mfma_f32_16x16x32_bf16 v[48:51], v[160:163], v[180:183], v[48:51]
    v_mfma_f32_16x16x32_bf16 v[52:55], v[164:167], v[180:183], v[52:55]
    s_barrier
    ds_read_b128 v[132:135], v20 offset:49152
    v_mfma_f32_16x16x32_bf16 v[56:59], v[168:171], v[180:183], v[56:59]
    ds_read_b128 v[112:115], v21 offset:30720
    ds_read_b128 v[116:119], v21 offset:31744
    v_mfma_f32_16x16x32_bf16 v[60:63], v[172:175], v[180:183], v[60:63]
    ds_read_b128 v[120:123], v21 offset:32768
    v_mfma_f32_16x16x32_bf16 v[64:67], v[176:179], v[180:183], v[64:67]
    ds_read_b128 v[124:127], v21 offset:33792
    ds_read_b128 v[128:131], v21 offset:34816
    v_mfma_f32_16x16x32_bf16 v[48:51], v[184:187], v[204:207], v[48:51]
    ds_read_b128 v[156:159], v20 offset:53248
    v_mfma_f32_16x16x32_bf16 v[52:55], v[188:191], v[204:207], v[52:55]
    ds_read_b128 v[136:139], v21 offset:35840
    ds_read_b128 v[140:143], v21 offset:36864
    v_mfma_f32_16x16x32_bf16 v[56:59], v[192:195], v[204:207], v[56:59]
    ds_read_b128 v[144:147], v21 offset:37888
    v_mfma_f32_16x16x32_bf16 v[60:63], v[196:199], v[204:207], v[60:63]
    ds_read_b128 v[148:151], v21 offset:38912
    ds_read_b128 v[152:155], v21 offset:39936
    v_mfma_f32_16x16x32_bf16 v[64:67], v[200:203], v[204:207], v[64:67]
    s_waitcnt lgkmcnt(12)
    v_mfma_f32_16x16x32_bf16 v[48:51], v[208:211], v[228:231], v[48:51]
    v_mfma_f32_16x16x32_bf16 v[52:55], v[212:215], v[228:231], v[52:55]
    s_barrier
    ds_read_b128 v[180:183], v20 offset:0
    v_mfma_f32_16x16x32_bf16 v[56:59], v[216:219], v[228:231], v[56:59]
    ds_read_b128 v[160:163], v19 offset:0
    ds_read_b128 v[164:167], v19 offset:1024
    v_mfma_f32_16x16x32_bf16 v[60:63], v[220:223], v[228:231], v[60:63]
    ds_read_b128 v[168:171], v19 offset:2048
    v_mfma_f32_16x16x32_bf16 v[64:67], v[224:227], v[228:231], v[64:67]
    ds_read_b128 v[172:175], v19 offset:3072
    ds_read_b128 v[176:179], v19 offset:4096
    v_mfma_f32_16x16x32_bf16 v[48:51], v[232:235], v[252:255], v[48:51]
    ds_read_b128 v[204:207], v20 offset:4096
    v_mfma_f32_16x16x32_bf16 v[52:55], v[236:239], v[252:255], v[52:55]
    ds_read_b128 v[184:187], v19 offset:5120
    ds_read_b128 v[188:191], v19 offset:6144
    v_mfma_f32_16x16x32_bf16 v[56:59], v[240:243], v[252:255], v[56:59]
    ds_read_b128 v[192:195], v19 offset:7168
    v_mfma_f32_16x16x32_bf16 v[60:63], v[244:247], v[252:255], v[60:63]
    ds_read_b128 v[196:199], v19 offset:8192
    ds_read_b128 v[200:203], v19 offset:9216
    v_mfma_f32_16x16x32_bf16 v[64:67], v[248:251], v[252:255], v[64:67]
    s_waitcnt lgkmcnt(12)
    v_mfma_f32_16x16x32_bf16 v[28:31], v[112:115], v[132:135], v[28:31]
    v_mfma_f32_16x16x32_bf16 v[32:35], v[116:119], v[132:135], v[32:35]
    s_barrier
    ds_read_b128 v[228:231], v20 offset:8192
    v_mfma_f32_16x16x32_bf16 v[36:39], v[120:123], v[132:135], v[36:39]
    ds_read_b128 v[208:211], v19 offset:10240
    ds_read_b128 v[212:215], v19 offset:11264
    v_mfma_f32_16x16x32_bf16 v[40:43], v[124:127], v[132:135], v[40:43]
    ds_read_b128 v[216:219], v19 offset:12288
    v_mfma_f32_16x16x32_bf16 v[44:47], v[128:131], v[132:135], v[44:47]
    ds_read_b128 v[220:223], v19 offset:13312
    ds_read_b128 v[224:227], v19 offset:14336
    v_mfma_f32_16x16x32_bf16 v[28:31], v[136:139], v[156:159], v[28:31]
    ds_read_b128 v[252:255], v20 offset:12288
    v_mfma_f32_16x16x32_bf16 v[32:35], v[140:143], v[156:159], v[32:35]
    ds_read_b128 v[232:235], v19 offset:15360
    ds_read_b128 v[236:239], v19 offset:16384
    v_mfma_f32_16x16x32_bf16 v[36:39], v[144:147], v[156:159], v[36:39]
    ds_read_b128 v[240:243], v19 offset:17408
    v_mfma_f32_16x16x32_bf16 v[40:43], v[148:151], v[156:159], v[40:43]
    ds_read_b128 v[244:247], v19 offset:18432
    ds_read_b128 v[248:251], v19 offset:19456
    v_mfma_f32_16x16x32_bf16 v[44:47], v[152:155], v[156:159], v[44:47]
    s_waitcnt lgkmcnt(12)
    v_mfma_f32_16x16x32_bf16 v[28:31], v[160:163], v[180:183], v[28:31]
    v_mfma_f32_16x16x32_bf16 v[32:35], v[164:167], v[180:183], v[32:35]
    s_barrier
    ds_read_b128 v[132:135], v20 offset:16384
    v_mfma_f32_16x16x32_bf16 v[36:39], v[168:171], v[180:183], v[36:39]
    ds_read_b128 v[112:115], v19 offset:20480
    ds_read_b128 v[116:119], v19 offset:21504
    v_mfma_f32_16x16x32_bf16 v[40:43], v[172:175], v[180:183], v[40:43]
    ds_read_b128 v[120:123], v19 offset:22528
    v_mfma_f32_16x16x32_bf16 v[44:47], v[176:179], v[180:183], v[44:47]
    ds_read_b128 v[124:127], v19 offset:23552
    ds_read_b128 v[128:131], v19 offset:24576
    v_mfma_f32_16x16x32_bf16 v[28:31], v[184:187], v[204:207], v[28:31]
    ds_read_b128 v[156:159], v20 offset:20480
    v_mfma_f32_16x16x32_bf16 v[32:35], v[188:191], v[204:207], v[32:35]
    ds_read_b128 v[136:139], v19 offset:25600
    ds_read_b128 v[140:143], v19 offset:26624
    v_mfma_f32_16x16x32_bf16 v[36:39], v[192:195], v[204:207], v[36:39]
    ds_read_b128 v[144:147], v19 offset:27648
    v_mfma_f32_16x16x32_bf16 v[40:43], v[196:199], v[204:207], v[40:43]
    ds_read_b128 v[148:151], v19 offset:28672
    ds_read_b128 v[152:155], v19 offset:29696
    v_mfma_f32_16x16x32_bf16 v[44:47], v[200:203], v[204:207], v[44:47]
    s_waitcnt lgkmcnt(12)
    v_mfma_f32_16x16x32_bf16 v[28:31], v[208:211], v[228:231], v[28:31]
    v_mfma_f32_16x16x32_bf16 v[32:35], v[212:215], v[228:231], v[32:35]
    s_barrier
    ds_read_b128 v[180:183], v20 offset:24576
    v_mfma_f32_16x16x32_bf16 v[36:39], v[216:219], v[228:231], v[36:39]
    v_cvt_pk_bf16_f32 v2, v48, v49
    v_cvt_pk_bf16_f32 v3, v50, v51
    ds_read_b128 v[160:163], v21 offset:0
    ds_read_b128 v[164:167], v21 offset:1024
    v_mfma_f32_16x16x32_bf16 v[40:43], v[220:223], v[228:231], v[40:43]
    v_lshlrev_b32 v48, 16, v2
    v_and_b32 v49, 0xffff0000, v2
    ds_read_b128 v[168:171], v21 offset:2048
    v_mfma_f32_16x16x32_bf16 v[44:47], v[224:227], v[228:231], v[44:47]
    v_lshlrev_b32 v50, 16, v3
    v_and_b32 v51, 0xffff0000, v3
    ds_read_b128 v[172:175], v21 offset:3072
    ds_read_b128 v[176:179], v21 offset:4096
    v_mfma_f32_16x16x32_bf16 v[28:31], v[232:235], v[252:255], v[28:31]
    v_mul_f32 v2, 0xbfb8aa3b, v48
    v_mul_f32 v3, 0xbfb8aa3b, v49
    ds_read_b128 v[204:207], v20 offset:28672
    v_mfma_f32_16x16x32_bf16 v[32:35], v[236:239], v[252:255], v[32:35]
    v_mul_f32 v4, 0xbfb8aa3b, v50
    v_mul_f32 v5, 0xbfb8aa3b, v51
    ds_read_b128 v[184:187], v21 offset:5120
    ds_read_b128 v[188:191], v21 offset:6144
    v_mfma_f32_16x16x32_bf16 v[36:39], v[240:243], v[252:255], v[36:39]
    v_exp_f32 v2, v2
    v_exp_f32 v3, v3
    ds_read_b128 v[192:195], v21 offset:7168
    v_mfma_f32_16x16x32_bf16 v[40:43], v[244:247], v[252:255], v[40:43]
    v_exp_f32 v4, v4
    v_exp_f32 v5, v5
    ds_read_b128 v[196:199], v21 offset:8192
    ds_read_b128 v[200:203], v21 offset:9216
    v_mfma_f32_16x16x32_bf16 v[44:47], v[248:251], v[252:255], v[44:47]
    v_add_f32 v2, 1.0, v2
    v_add_f32 v3, 1.0, v3
    s_waitcnt lgkmcnt(12)
    v_mfma_f32_16x16x32_bf16 v[28:31], v[112:115], v[132:135], v[28:31]
    v_mfma_f32_16x16x32_bf16 v[32:35], v[116:119], v[132:135], v[32:35]
    s_barrier
    ds_read_b128 v[228:231], v20 offset:32768
    v_mfma_f32_16x16x32_bf16 v[36:39], v[120:123], v[132:135], v[36:39]
    v_add_f32 v4, 1.0, v4
    v_add_f32 v5, 1.0, v5
    ds_read_b128 v[208:211], v21 offset:10240
    ds_read_b128 v[212:215], v21 offset:11264
    v_mfma_f32_16x16x32_bf16 v[40:43], v[124:127], v[132:135], v[40:43]
    v_rcp_f32 v2, v2
    v_rcp_f32 v3, v3
    ds_read_b128 v[216:219], v21 offset:12288
    v_mfma_f32_16x16x32_bf16 v[44:47], v[128:131], v[132:135], v[44:47]
    v_rcp_f32 v4, v4
    v_rcp_f32 v5, v5
    ds_read_b128 v[220:223], v21 offset:13312
    ds_read_b128 v[224:227], v21 offset:14336
    v_mfma_f32_16x16x32_bf16 v[28:31], v[136:139], v[156:159], v[28:31]
    v_mul_f32 v2, v2, v48
    v_mul_f32 v3, v3, v49
    ds_read_b128 v[252:255], v20 offset:36864
    v_mfma_f32_16x16x32_bf16 v[32:35], v[140:143], v[156:159], v[32:35]
    v_mul_f32 v4, v4, v50
    v_mul_f32 v5, v5, v51
    ds_read_b128 v[232:235], v21 offset:15360
    ds_read_b128 v[236:239], v21 offset:16384
    v_mfma_f32_16x16x32_bf16 v[36:39], v[144:147], v[156:159], v[36:39]
    v_cvt_pk_bf16_f32 v6, v2, v3
    v_cvt_pk_bf16_f32 v7, v4, v5
    ds_read_b128 v[240:243], v21 offset:17408
    v_mfma_f32_16x16x32_bf16 v[40:43], v[148:151], v[156:159], v[40:43]
    v_lshlrev_b32 v48, 16, v6
    v_and_b32 v49, 0xffff0000, v6
    ds_read_b128 v[244:247], v21 offset:18432
    ds_read_b128 v[248:251], v21 offset:19456
    v_mfma_f32_16x16x32_bf16 v[44:47], v[152:155], v[156:159], v[44:47]
    v_lshlrev_b32 v50, 16, v7
    v_and_b32 v51, 0xffff0000, v7
    s_waitcnt lgkmcnt(12)
    v_mfma_f32_16x16x32_bf16 v[28:31], v[160:163], v[180:183], v[28:31]
    v_mfma_f32_16x16x32_bf16 v[32:35], v[164:167], v[180:183], v[32:35]
    s_barrier
    ds_read_b128 v[132:135], v20 offset:40960
    v_mfma_f32_16x16x32_bf16 v[36:39], v[168:171], v[180:183], v[36:39]
    v_cvt_pk_bf16_f32 v2, v52, v53
    v_cvt_pk_bf16_f32 v3, v54, v55
    ds_read_b128 v[112:115], v21 offset:20480
    ds_read_b128 v[116:119], v21 offset:21504
    v_mfma_f32_16x16x32_bf16 v[40:43], v[172:175], v[180:183], v[40:43]
    v_lshlrev_b32 v52, 16, v2
    v_and_b32 v53, 0xffff0000, v2
    ds_read_b128 v[120:123], v21 offset:22528
    v_mfma_f32_16x16x32_bf16 v[44:47], v[176:179], v[180:183], v[44:47]
    v_lshlrev_b32 v54, 16, v3
    v_and_b32 v55, 0xffff0000, v3
    ds_read_b128 v[124:127], v21 offset:23552
    ds_read_b128 v[128:131], v21 offset:24576
    v_mfma_f32_16x16x32_bf16 v[28:31], v[184:187], v[204:207], v[28:31]
    v_mul_f32 v2, 0xbfb8aa3b, v52
    v_mul_f32 v3, 0xbfb8aa3b, v53
    ds_read_b128 v[156:159], v20 offset:45056
    v_mfma_f32_16x16x32_bf16 v[32:35], v[188:191], v[204:207], v[32:35]
    v_mul_f32 v4, 0xbfb8aa3b, v54
    v_mul_f32 v5, 0xbfb8aa3b, v55
    ds_read_b128 v[136:139], v21 offset:25600
    ds_read_b128 v[140:143], v21 offset:26624
    v_mfma_f32_16x16x32_bf16 v[36:39], v[192:195], v[204:207], v[36:39]
    v_exp_f32 v2, v2
    v_exp_f32 v3, v3
    ds_read_b128 v[144:147], v21 offset:27648
    v_mfma_f32_16x16x32_bf16 v[40:43], v[196:199], v[204:207], v[40:43]
    v_exp_f32 v4, v4
    v_exp_f32 v5, v5
    ds_read_b128 v[148:151], v21 offset:28672
    ds_read_b128 v[152:155], v21 offset:29696
    v_mfma_f32_16x16x32_bf16 v[44:47], v[200:203], v[204:207], v[44:47]
    v_add_f32 v2, 1.0, v2
    v_add_f32 v3, 1.0, v3
    s_waitcnt lgkmcnt(12)
    v_mfma_f32_16x16x32_bf16 v[28:31], v[208:211], v[228:231], v[28:31]
    v_mfma_f32_16x16x32_bf16 v[32:35], v[212:215], v[228:231], v[32:35]
    s_barrier
    ds_read_b128 v[180:183], v20 offset:49152
    v_mfma_f32_16x16x32_bf16 v[36:39], v[216:219], v[228:231], v[36:39]
    v_add_f32 v4, 1.0, v4
    v_add_f32 v5, 1.0, v5
    ds_read_b128 v[160:163], v21 offset:30720
    ds_read_b128 v[164:167], v21 offset:31744
    v_mfma_f32_16x16x32_bf16 v[40:43], v[220:223], v[228:231], v[40:43]
    v_rcp_f32 v2, v2
    v_rcp_f32 v3, v3
    ds_read_b128 v[168:171], v21 offset:32768
    v_mfma_f32_16x16x32_bf16 v[44:47], v[224:227], v[228:231], v[44:47]
    v_rcp_f32 v4, v4
    v_rcp_f32 v5, v5
    ds_read_b128 v[172:175], v21 offset:33792
    ds_read_b128 v[176:179], v21 offset:34816
    v_mfma_f32_16x16x32_bf16 v[28:31], v[232:235], v[252:255], v[28:31]
    v_mul_f32 v2, v2, v52
    v_mul_f32 v3, v3, v53
    ds_read_b128 v[204:207], v20 offset:53248
    v_mfma_f32_16x16x32_bf16 v[32:35], v[236:239], v[252:255], v[32:35]
    v_mul_f32 v4, v4, v54
    v_mul_f32 v5, v5, v55
    ds_read_b128 v[184:187], v21 offset:35840
    ds_read_b128 v[188:191], v21 offset:36864
    v_mfma_f32_16x16x32_bf16 v[36:39], v[240:243], v[252:255], v[36:39]
    v_cvt_pk_bf16_f32 v6, v2, v3
    v_cvt_pk_bf16_f32 v7, v4, v5
    ds_read_b128 v[192:195], v21 offset:37888
    v_mfma_f32_16x16x32_bf16 v[40:43], v[244:247], v[252:255], v[40:43]
    v_lshlrev_b32 v52, 16, v6
    v_and_b32 v53, 0xffff0000, v6
    ds_read_b128 v[196:199], v21 offset:38912
    ds_read_b128 v[200:203], v21 offset:39936
    v_mfma_f32_16x16x32_bf16 v[44:47], v[248:251], v[252:255], v[44:47]
    v_lshlrev_b32 v54, 16, v7
    v_and_b32 v55, 0xffff0000, v7
    s_waitcnt lgkmcnt(12)
    v_mfma_f32_16x16x32_bf16 v[28:31], v[112:115], v[132:135], v[28:31]
    v_mfma_f32_16x16x32_bf16 v[32:35], v[116:119], v[132:135], v[32:35]
    s_barrier
    ds_read_b128 v[228:231], v20 offset:0
    v_mfma_f32_16x16x32_bf16 v[36:39], v[120:123], v[132:135], v[36:39]
    v_cvt_pk_bf16_f32 v2, v56, v57
    v_cvt_pk_bf16_f32 v3, v58, v59
    ds_read_b128 v[208:211], v19 offset:0
    ds_read_b128 v[212:215], v19 offset:1024
    v_mfma_f32_16x16x32_bf16 v[40:43], v[124:127], v[132:135], v[40:43]
    v_lshlrev_b32 v56, 16, v2
    v_and_b32 v57, 0xffff0000, v2
    ds_read_b128 v[216:219], v19 offset:2048
    v_mfma_f32_16x16x32_bf16 v[44:47], v[128:131], v[132:135], v[44:47]
    v_lshlrev_b32 v58, 16, v3
    v_and_b32 v59, 0xffff0000, v3
    ds_read_b128 v[220:223], v19 offset:3072
    ds_read_b128 v[224:227], v19 offset:4096
    v_mfma_f32_16x16x32_bf16 v[28:31], v[136:139], v[156:159], v[28:31]
    v_mul_f32 v2, 0xbfb8aa3b, v56
    v_mul_f32 v3, 0xbfb8aa3b, v57
    ds_read_b128 v[252:255], v20 offset:4096
    v_mfma_f32_16x16x32_bf16 v[32:35], v[140:143], v[156:159], v[32:35]
    v_mul_f32 v4, 0xbfb8aa3b, v58
    v_mul_f32 v5, 0xbfb8aa3b, v59
    ds_read_b128 v[232:235], v19 offset:5120
    ds_read_b128 v[236:239], v19 offset:6144
    v_mfma_f32_16x16x32_bf16 v[36:39], v[144:147], v[156:159], v[36:39]
    v_exp_f32 v2, v2
    v_exp_f32 v3, v3
    ds_read_b128 v[240:243], v19 offset:7168
    v_mfma_f32_16x16x32_bf16 v[40:43], v[148:151], v[156:159], v[40:43]
    v_exp_f32 v4, v4
    v_exp_f32 v5, v5
    ds_read_b128 v[244:247], v19 offset:8192
    ds_read_b128 v[248:251], v19 offset:9216
    v_mfma_f32_16x16x32_bf16 v[44:47], v[152:155], v[156:159], v[44:47]
    v_add_f32 v2, 1.0, v2
    v_add_f32 v3, 1.0, v3
    s_waitcnt lgkmcnt(12)
    v_mfma_f32_16x16x32_bf16 v[28:31], v[160:163], v[180:183], v[28:31]
    v_mfma_f32_16x16x32_bf16 v[32:35], v[164:167], v[180:183], v[32:35]
    s_barrier
    ds_read_b128 v[132:135], v20 offset:8192
    v_mfma_f32_16x16x32_bf16 v[36:39], v[168:171], v[180:183], v[36:39]
    v_add_f32 v4, 1.0, v4
    v_add_f32 v5, 1.0, v5
    ds_read_b128 v[112:115], v19 offset:10240
    ds_read_b128 v[116:119], v19 offset:11264
    v_mfma_f32_16x16x32_bf16 v[40:43], v[172:175], v[180:183], v[40:43]
    v_rcp_f32 v2, v2
    v_rcp_f32 v3, v3
    ds_read_b128 v[120:123], v19 offset:12288
    v_mfma_f32_16x16x32_bf16 v[44:47], v[176:179], v[180:183], v[44:47]
    v_rcp_f32 v4, v4
    v_rcp_f32 v5, v5
    ds_read_b128 v[124:127], v19 offset:13312
    ds_read_b128 v[128:131], v19 offset:14336
    v_mfma_f32_16x16x32_bf16 v[28:31], v[184:187], v[204:207], v[28:31]
    v_mul_f32 v2, v2, v56
    v_mul_f32 v3, v3, v57
    ds_read_b128 v[156:159], v20 offset:12288
    v_mfma_f32_16x16x32_bf16 v[32:35], v[188:191], v[204:207], v[32:35]
    v_mul_f32 v4, v4, v58
    v_mul_f32 v5, v5, v59
    ds_read_b128 v[136:139], v19 offset:15360
    ds_read_b128 v[140:143], v19 offset:16384
    v_mfma_f32_16x16x32_bf16 v[36:39], v[192:195], v[204:207], v[36:39]
    v_cvt_pk_bf16_f32 v6, v2, v3
    v_cvt_pk_bf16_f32 v7, v4, v5
    ds_read_b128 v[144:147], v19 offset:17408
    v_mfma_f32_16x16x32_bf16 v[40:43], v[196:199], v[204:207], v[40:43]
    v_lshlrev_b32 v56, 16, v6
    v_and_b32 v57, 0xffff0000, v6
    ds_read_b128 v[148:151], v19 offset:18432
    ds_read_b128 v[152:155], v19 offset:19456
    v_mfma_f32_16x16x32_bf16 v[44:47], v[200:203], v[204:207], v[44:47]
    v_lshlrev_b32 v58, 16, v7
    v_and_b32 v59, 0xffff0000, v7
    s_waitcnt lgkmcnt(12)
    v_mfma_f32_16x16x32_bf16 v[28:31], v[208:211], v[228:231], v[28:31]
    v_mfma_f32_16x16x32_bf16 v[32:35], v[212:215], v[228:231], v[32:35]
    s_barrier
    ds_read_b128 v[180:183], v20 offset:16384
    v_mfma_f32_16x16x32_bf16 v[36:39], v[216:219], v[228:231], v[36:39]
    v_cvt_pk_bf16_f32 v2, v60, v61
    v_cvt_pk_bf16_f32 v3, v62, v63
    ds_read_b128 v[160:163], v19 offset:20480
    ds_read_b128 v[164:167], v19 offset:21504
    v_mfma_f32_16x16x32_bf16 v[40:43], v[220:223], v[228:231], v[40:43]
    v_lshlrev_b32 v60, 16, v2
    v_and_b32 v61, 0xffff0000, v2
    ds_read_b128 v[168:171], v19 offset:22528
    v_mfma_f32_16x16x32_bf16 v[44:47], v[224:227], v[228:231], v[44:47]
    v_lshlrev_b32 v62, 16, v3
    v_and_b32 v63, 0xffff0000, v3
    ds_read_b128 v[172:175], v19 offset:23552
    ds_read_b128 v[176:179], v19 offset:24576
    v_mfma_f32_16x16x32_bf16 v[28:31], v[232:235], v[252:255], v[28:31]
    v_mul_f32 v2, 0xbfb8aa3b, v60
    v_mul_f32 v3, 0xbfb8aa3b, v61
    ds_read_b128 v[204:207], v20 offset:20480
    v_mfma_f32_16x16x32_bf16 v[32:35], v[236:239], v[252:255], v[32:35]
    v_mul_f32 v4, 0xbfb8aa3b, v62
    v_mul_f32 v5, 0xbfb8aa3b, v63
    ds_read_b128 v[184:187], v19 offset:25600
    ds_read_b128 v[188:191], v19 offset:26624
    v_mfma_f32_16x16x32_bf16 v[36:39], v[240:243], v[252:255], v[36:39]
    v_exp_f32 v2, v2
    v_exp_f32 v3, v3
    ds_read_b128 v[192:195], v19 offset:27648
    v_mfma_f32_16x16x32_bf16 v[40:43], v[244:247], v[252:255], v[40:43]
    v_exp_f32 v4, v4
    v_exp_f32 v5, v5
    ds_read_b128 v[196:199], v19 offset:28672
    ds_read_b128 v[200:203], v19 offset:29696
    v_mfma_f32_16x16x32_bf16 v[44:47], v[248:251], v[252:255], v[44:47]
    v_add_f32 v2, 1.0, v2
    v_add_f32 v3, 1.0, v3
    s_waitcnt lgkmcnt(12)
    v_mfma_f32_16x16x32_bf16 v[28:31], v[112:115], v[132:135], v[28:31]
    v_mfma_f32_16x16x32_bf16 v[32:35], v[116:119], v[132:135], v[32:35]
    s_barrier
    ds_read_b128 v[228:231], v20 offset:24576
    v_mfma_f32_16x16x32_bf16 v[36:39], v[120:123], v[132:135], v[36:39]
    v_add_f32 v4, 1.0, v4
    v_add_f32 v5, 1.0, v5
    ds_read_b128 v[208:211], v21 offset:0
    ds_read_b128 v[212:215], v21 offset:1024
    v_mfma_f32_16x16x32_bf16 v[40:43], v[124:127], v[132:135], v[40:43]
    v_rcp_f32 v2, v2
    v_rcp_f32 v3, v3
    ds_read_b128 v[216:219], v21 offset:2048
    v_mfma_f32_16x16x32_bf16 v[44:47], v[128:131], v[132:135], v[44:47]
    v_rcp_f32 v4, v4
    v_rcp_f32 v5, v5
    ds_read_b128 v[220:223], v21 offset:3072
    ds_read_b128 v[224:227], v21 offset:4096
    v_mfma_f32_16x16x32_bf16 v[28:31], v[136:139], v[156:159], v[28:31]
    v_mul_f32 v2, v2, v60
    v_mul_f32 v3, v3, v61
    ds_read_b128 v[252:255], v20 offset:28672
    v_mfma_f32_16x16x32_bf16 v[32:35], v[140:143], v[156:159], v[32:35]
    v_mul_f32 v4, v4, v62
    v_mul_f32 v5, v5, v63
    ds_read_b128 v[232:235], v21 offset:5120
    ds_read_b128 v[236:239], v21 offset:6144
    v_mfma_f32_16x16x32_bf16 v[36:39], v[144:147], v[156:159], v[36:39]
    v_cvt_pk_bf16_f32 v6, v2, v3
    v_cvt_pk_bf16_f32 v7, v4, v5
    ds_read_b128 v[240:243], v21 offset:7168
    v_mfma_f32_16x16x32_bf16 v[40:43], v[148:151], v[156:159], v[40:43]
    v_lshlrev_b32 v60, 16, v6
    v_and_b32 v61, 0xffff0000, v6
    ds_read_b128 v[244:247], v21 offset:8192
    ds_read_b128 v[248:251], v21 offset:9216
    v_mfma_f32_16x16x32_bf16 v[44:47], v[152:155], v[156:159], v[44:47]
    v_lshlrev_b32 v62, 16, v7
    v_and_b32 v63, 0xffff0000, v7
    s_waitcnt lgkmcnt(12)
    v_mfma_f32_16x16x32_bf16 v[28:31], v[160:163], v[180:183], v[28:31]
    v_mfma_f32_16x16x32_bf16 v[32:35], v[164:167], v[180:183], v[32:35]
    s_barrier
    ds_read_b128 v[132:135], v20 offset:32768
    v_mfma_f32_16x16x32_bf16 v[36:39], v[168:171], v[180:183], v[36:39]
    v_cvt_pk_bf16_f32 v2, v64, v65
    v_cvt_pk_bf16_f32 v3, v66, v67
    ds_read_b128 v[112:115], v21 offset:10240
    ds_read_b128 v[116:119], v21 offset:11264
    v_mfma_f32_16x16x32_bf16 v[40:43], v[172:175], v[180:183], v[40:43]
    v_lshlrev_b32 v64, 16, v2
    v_and_b32 v65, 0xffff0000, v2
    ds_read_b128 v[120:123], v21 offset:12288
    v_mfma_f32_16x16x32_bf16 v[44:47], v[176:179], v[180:183], v[44:47]
    v_lshlrev_b32 v66, 16, v3
    v_and_b32 v67, 0xffff0000, v3
    ds_read_b128 v[124:127], v21 offset:13312
    ds_read_b128 v[128:131], v21 offset:14336
    v_mfma_f32_16x16x32_bf16 v[28:31], v[184:187], v[204:207], v[28:31]
    v_mul_f32 v2, 0xbfb8aa3b, v64
    v_mul_f32 v3, 0xbfb8aa3b, v65
    ds_read_b128 v[156:159], v20 offset:36864
    v_mfma_f32_16x16x32_bf16 v[32:35], v[188:191], v[204:207], v[32:35]
    v_mul_f32 v4, 0xbfb8aa3b, v66
    v_mul_f32 v5, 0xbfb8aa3b, v67
    ds_read_b128 v[136:139], v21 offset:15360
    ds_read_b128 v[140:143], v21 offset:16384
    v_mfma_f32_16x16x32_bf16 v[36:39], v[192:195], v[204:207], v[36:39]
    v_exp_f32 v2, v2
    v_exp_f32 v3, v3
    ds_read_b128 v[144:147], v21 offset:17408
    v_mfma_f32_16x16x32_bf16 v[40:43], v[196:199], v[204:207], v[40:43]
    v_exp_f32 v4, v4
    v_exp_f32 v5, v5
    ds_read_b128 v[148:151], v21 offset:18432
    ds_read_b128 v[152:155], v21 offset:19456
    v_mfma_f32_16x16x32_bf16 v[44:47], v[200:203], v[204:207], v[44:47]
    v_add_f32 v2, 1.0, v2
    v_add_f32 v3, 1.0, v3
    s_waitcnt lgkmcnt(12)
    v_mfma_f32_16x16x32_bf16 v[28:31], v[208:211], v[228:231], v[28:31]
    v_mfma_f32_16x16x32_bf16 v[32:35], v[212:215], v[228:231], v[32:35]
    s_barrier
    ds_read_b128 v[180:183], v20 offset:40960
    v_mfma_f32_16x16x32_bf16 v[36:39], v[216:219], v[228:231], v[36:39]
    v_add_f32 v4, 1.0, v4
    v_add_f32 v5, 1.0, v5
    ds_read_b128 v[160:163], v21 offset:20480
    ds_read_b128 v[164:167], v21 offset:21504
    v_mfma_f32_16x16x32_bf16 v[40:43], v[220:223], v[228:231], v[40:43]
    v_rcp_f32 v2, v2
    v_rcp_f32 v3, v3
    ds_read_b128 v[168:171], v21 offset:22528
    v_mfma_f32_16x16x32_bf16 v[44:47], v[224:227], v[228:231], v[44:47]
    v_rcp_f32 v4, v4
    v_rcp_f32 v5, v5
    ds_read_b128 v[172:175], v21 offset:23552
    ds_read_b128 v[176:179], v21 offset:24576
    v_mfma_f32_16x16x32_bf16 v[28:31], v[232:235], v[252:255], v[28:31]
    v_mul_f32 v2, v2, v64
    v_mul_f32 v3, v3, v65
    ds_read_b128 v[204:207], v20 offset:45056
    v_mfma_f32_16x16x32_bf16 v[32:35], v[236:239], v[252:255], v[32:35]
    v_mul_f32 v4, v4, v66
    v_mul_f32 v5, v5, v67
    ds_read_b128 v[184:187], v21 offset:25600
    ds_read_b128 v[188:191], v21 offset:26624
    v_mfma_f32_16x16x32_bf16 v[36:39], v[240:243], v[252:255], v[36:39]
    v_cvt_pk_bf16_f32 v6, v2, v3
    v_cvt_pk_bf16_f32 v7, v4, v5
    ds_read_b128 v[192:195], v21 offset:27648
    v_mfma_f32_16x16x32_bf16 v[40:43], v[244:247], v[252:255], v[40:43]
    v_lshlrev_b32 v64, 16, v6
    v_and_b32 v65, 0xffff0000, v6
    ds_read_b128 v[196:199], v21 offset:28672
    ds_read_b128 v[200:203], v21 offset:29696
    v_mfma_f32_16x16x32_bf16 v[44:47], v[248:251], v[252:255], v[44:47]
    v_lshlrev_b32 v66, 16, v7
    v_and_b32 v67, 0xffff0000, v7
    s_waitcnt lgkmcnt(12)
    v_mfma_f32_16x16x32_bf16 v[28:31], v[112:115], v[132:135], v[28:31]
    v_mfma_f32_16x16x32_bf16 v[32:35], v[116:119], v[132:135], v[32:35]
    s_barrier
    ds_read_b128 v[228:231], v20 offset:49152
    v_mfma_f32_16x16x32_bf16 v[36:39], v[120:123], v[132:135], v[36:39]
    ds_read_b128 v[208:211], v21 offset:30720
    ds_read_b128 v[212:215], v21 offset:31744
    v_mfma_f32_16x16x32_bf16 v[40:43], v[124:127], v[132:135], v[40:43]
    ds_read_b128 v[216:219], v21 offset:32768
    v_mfma_f32_16x16x32_bf16 v[44:47], v[128:131], v[132:135], v[44:47]
    ds_read_b128 v[220:223], v21 offset:33792
    ds_read_b128 v[224:227], v21 offset:34816
    v_mfma_f32_16x16x32_bf16 v[28:31], v[136:139], v[156:159], v[28:31]
    ds_read_b128 v[252:255], v20 offset:53248
    v_mfma_f32_16x16x32_bf16 v[32:35], v[140:143], v[156:159], v[32:35]
    ds_read_b128 v[232:235], v21 offset:35840
    ds_read_b128 v[236:239], v21 offset:36864
    v_mfma_f32_16x16x32_bf16 v[36:39], v[144:147], v[156:159], v[36:39]
    ds_read_b128 v[240:243], v21 offset:37888
    v_mfma_f32_16x16x32_bf16 v[40:43], v[148:151], v[156:159], v[40:43]
    ds_read_b128 v[244:247], v21 offset:38912
    ds_read_b128 v[248:251], v21 offset:39936
    v_mfma_f32_16x16x32_bf16 v[44:47], v[152:155], v[156:159], v[44:47]
    s_waitcnt lgkmcnt(12)
    v_mfma_f32_16x16x32_bf16 v[28:31], v[160:163], v[180:183], v[28:31]
    v_mfma_f32_16x16x32_bf16 v[32:35], v[164:167], v[180:183], v[32:35]
    s_barrier
    ds_read_b128 v[132:135], v20 offset:0
    v_mfma_f32_16x16x32_bf16 v[36:39], v[168:171], v[180:183], v[36:39]
    ds_read_b128 v[112:115], v19 offset:0
    ds_read_b128 v[116:119], v19 offset:1024
    v_mfma_f32_16x16x32_bf16 v[40:43], v[172:175], v[180:183], v[40:43]
    ds_read_b128 v[120:123], v19 offset:2048
    v_mfma_f32_16x16x32_bf16 v[44:47], v[176:179], v[180:183], v[44:47]
    ds_read_b128 v[124:127], v19 offset:3072
    ds_read_b128 v[128:131], v19 offset:4096
    v_mfma_f32_16x16x32_bf16 v[28:31], v[184:187], v[204:207], v[28:31]
    ds_read_b128 v[156:159], v20 offset:4096
    v_mfma_f32_16x16x32_bf16 v[32:35], v[188:191], v[204:207], v[32:35]
    ds_read_b128 v[136:139], v19 offset:5120
    ds_read_b128 v[140:143], v19 offset:6144
    v_mfma_f32_16x16x32_bf16 v[36:39], v[192:195], v[204:207], v[36:39]
    ds_read_b128 v[144:147], v19 offset:7168
    v_mfma_f32_16x16x32_bf16 v[40:43], v[196:199], v[204:207], v[40:43]
    ds_read_b128 v[148:151], v19 offset:8192
    ds_read_b128 v[152:155], v19 offset:9216
    v_mfma_f32_16x16x32_bf16 v[44:47], v[200:203], v[204:207], v[44:47]
    s_waitcnt lgkmcnt(12)
    v_mfma_f32_16x16x32_bf16 v[28:31], v[208:211], v[228:231], v[28:31]
    v_mfma_f32_16x16x32_bf16 v[32:35], v[212:215], v[228:231], v[32:35]
    s_barrier
    ds_read_b128 v[180:183], v20 offset:8192
    v_mfma_f32_16x16x32_bf16 v[36:39], v[216:219], v[228:231], v[36:39]
    ds_read_b128 v[160:163], v19 offset:10240
    ds_read_b128 v[164:167], v19 offset:11264
    v_mfma_f32_16x16x32_bf16 v[40:43], v[220:223], v[228:231], v[40:43]
    ds_read_b128 v[168:171], v19 offset:12288
    v_mfma_f32_16x16x32_bf16 v[44:47], v[224:227], v[228:231], v[44:47]
    ds_read_b128 v[172:175], v19 offset:13312
    ds_read_b128 v[176:179], v19 offset:14336
    v_mfma_f32_16x16x32_bf16 v[28:31], v[232:235], v[252:255], v[28:31]
    ds_read_b128 v[204:207], v20 offset:12288
    v_mfma_f32_16x16x32_bf16 v[32:35], v[236:239], v[252:255], v[32:35]
    ds_read_b128 v[184:187], v19 offset:15360
    ds_read_b128 v[188:191], v19 offset:16384
    v_mfma_f32_16x16x32_bf16 v[36:39], v[240:243], v[252:255], v[36:39]
    ds_read_b128 v[192:195], v19 offset:17408
    v_mfma_f32_16x16x32_bf16 v[40:43], v[244:247], v[252:255], v[40:43]
    ds_read_b128 v[196:199], v19 offset:18432
    ds_read_b128 v[200:203], v19 offset:19456
    v_mfma_f32_16x16x32_bf16 v[44:47], v[248:251], v[252:255], v[44:47]
    s_waitcnt lgkmcnt(12)
    v_mfma_f32_16x16x32_bf16 v[28:31], v[112:115], v[132:135], v[28:31]
    v_mfma_f32_16x16x32_bf16 v[32:35], v[116:119], v[132:135], v[32:35]
    s_barrier
    ds_read_b128 v[228:231], v20 offset:16384
    v_mfma_f32_16x16x32_bf16 v[36:39], v[120:123], v[132:135], v[36:39]
    ds_read_b128 v[208:211], v19 offset:20480
    ds_read_b128 v[212:215], v19 offset:21504
    v_mfma_f32_16x16x32_bf16 v[40:43], v[124:127], v[132:135], v[40:43]
    ds_read_b128 v[216:219], v19 offset:22528
    v_mfma_f32_16x16x32_bf16 v[44:47], v[128:131], v[132:135], v[44:47]
    ds_read_b128 v[220:223], v19 offset:23552
    ds_read_b128 v[224:227], v19 offset:24576
    v_mfma_f32_16x16x32_bf16 v[28:31], v[136:139], v[156:159], v[28:31]
    ds_read_b128 v[252:255], v20 offset:20480
    v_mfma_f32_16x16x32_bf16 v[32:35], v[140:143], v[156:159], v[32:35]
    ds_read_b128 v[232:235], v19 offset:25600
    ds_read_b128 v[236:239], v19 offset:26624
    v_mfma_f32_16x16x32_bf16 v[36:39], v[144:147], v[156:159], v[36:39]
    ds_read_b128 v[240:243], v19 offset:27648
    v_mfma_f32_16x16x32_bf16 v[40:43], v[148:151], v[156:159], v[40:43]
    ds_read_b128 v[244:247], v19 offset:28672
    ds_read_b128 v[248:251], v19 offset:29696
    v_mfma_f32_16x16x32_bf16 v[44:47], v[152:155], v[156:159], v[44:47]
    s_waitcnt lgkmcnt(12)
    v_mfma_f32_16x16x32_bf16 v[28:31], v[160:163], v[180:183], v[28:31]
    v_mfma_f32_16x16x32_bf16 v[32:35], v[164:167], v[180:183], v[32:35]
    s_barrier
    ds_read_b128 v[132:135], v20 offset:24576
    v_mfma_f32_16x16x32_bf16 v[36:39], v[168:171], v[180:183], v[36:39]
    ds_read_b128 v[112:115], v21 offset:0
    ds_read_b128 v[116:119], v21 offset:1024
    v_mfma_f32_16x16x32_bf16 v[40:43], v[172:175], v[180:183], v[40:43]
    ds_read_b128 v[120:123], v21 offset:2048
    v_mfma_f32_16x16x32_bf16 v[44:47], v[176:179], v[180:183], v[44:47]
    ds_read_b128 v[124:127], v21 offset:3072
    ds_read_b128 v[128:131], v21 offset:4096
    v_mfma_f32_16x16x32_bf16 v[28:31], v[184:187], v[204:207], v[28:31]
    ds_read_b128 v[156:159], v20 offset:28672
    v_mfma_f32_16x16x32_bf16 v[32:35], v[188:191], v[204:207], v[32:35]
    ds_read_b128 v[136:139], v21 offset:5120
    ds_read_b128 v[140:143], v21 offset:6144
    v_mfma_f32_16x16x32_bf16 v[36:39], v[192:195], v[204:207], v[36:39]
    ds_read_b128 v[144:147], v21 offset:7168
    v_mfma_f32_16x16x32_bf16 v[40:43], v[196:199], v[204:207], v[40:43]
    ds_read_b128 v[148:151], v21 offset:8192
    ds_read_b128 v[152:155], v21 offset:9216
    v_mfma_f32_16x16x32_bf16 v[44:47], v[200:203], v[204:207], v[44:47]
    s_waitcnt lgkmcnt(12)
    v_mfma_f32_16x16x32_bf16 v[28:31], v[208:211], v[228:231], v[28:31]
    v_mfma_f32_16x16x32_bf16 v[32:35], v[212:215], v[228:231], v[32:35]
    s_barrier
    ds_read_b128 v[180:183], v20 offset:32768
    v_mfma_f32_16x16x32_bf16 v[36:39], v[216:219], v[228:231], v[36:39]
    ds_read_b128 v[160:163], v21 offset:10240
    ds_read_b128 v[164:167], v21 offset:11264
    v_mfma_f32_16x16x32_bf16 v[40:43], v[220:223], v[228:231], v[40:43]
    ds_read_b128 v[168:171], v21 offset:12288
    v_mfma_f32_16x16x32_bf16 v[44:47], v[224:227], v[228:231], v[44:47]
    ds_read_b128 v[172:175], v21 offset:13312
    ds_read_b128 v[176:179], v21 offset:14336
    v_mfma_f32_16x16x32_bf16 v[28:31], v[232:235], v[252:255], v[28:31]
    ds_read_b128 v[204:207], v20 offset:36864
    v_mfma_f32_16x16x32_bf16 v[32:35], v[236:239], v[252:255], v[32:35]
    ds_read_b128 v[184:187], v21 offset:15360
    ds_read_b128 v[188:191], v21 offset:16384
    v_mfma_f32_16x16x32_bf16 v[36:39], v[240:243], v[252:255], v[36:39]
    ds_read_b128 v[192:195], v21 offset:17408
    v_mfma_f32_16x16x32_bf16 v[40:43], v[244:247], v[252:255], v[40:43]
    ds_read_b128 v[196:199], v21 offset:18432
    ds_read_b128 v[200:203], v21 offset:19456
    v_mfma_f32_16x16x32_bf16 v[44:47], v[248:251], v[252:255], v[44:47]
    s_waitcnt lgkmcnt(12)
    v_mfma_f32_16x16x32_bf16 v[28:31], v[112:115], v[132:135], v[28:31]
    v_mfma_f32_16x16x32_bf16 v[32:35], v[116:119], v[132:135], v[32:35]
    v_mfma_f32_16x16x32_bf16 v[36:39], v[120:123], v[132:135], v[36:39]
    v_mfma_f32_16x16x32_bf16 v[40:43], v[124:127], v[132:135], v[40:43]
    v_mfma_f32_16x16x32_bf16 v[44:47], v[128:131], v[132:135], v[44:47]
    v_mfma_f32_16x16x32_bf16 v[28:31], v[136:139], v[156:159], v[28:31]
    v_mfma_f32_16x16x32_bf16 v[32:35], v[140:143], v[156:159], v[32:35]
    v_mfma_f32_16x16x32_bf16 v[36:39], v[144:147], v[156:159], v[36:39]
    v_mfma_f32_16x16x32_bf16 v[40:43], v[148:151], v[156:159], v[40:43]
    v_mfma_f32_16x16x32_bf16 v[44:47], v[152:155], v[156:159], v[44:47]
    s_waitcnt lgkmcnt(0)
    v_mfma_f32_16x16x32_bf16 v[28:31], v[160:163], v[180:183], v[28:31]
    v_mfma_f32_16x16x32_bf16 v[32:35], v[164:167], v[180:183], v[32:35]
    v_mfma_f32_16x16x32_bf16 v[36:39], v[168:171], v[180:183], v[36:39]
    v_mfma_f32_16x16x32_bf16 v[40:43], v[172:175], v[180:183], v[40:43]
    v_mfma_f32_16x16x32_bf16 v[44:47], v[176:179], v[180:183], v[44:47]
    v_mfma_f32_16x16x32_bf16 v[28:31], v[184:187], v[204:207], v[28:31]
    v_mfma_f32_16x16x32_bf16 v[32:35], v[188:191], v[204:207], v[32:35]
    v_mfma_f32_16x16x32_bf16 v[36:39], v[192:195], v[204:207], v[36:39]
    v_mfma_f32_16x16x32_bf16 v[40:43], v[196:199], v[204:207], v[40:43]
    v_mfma_f32_16x16x32_bf16 v[44:47], v[200:203], v[204:207], v[44:47]
    v_lshlrev_b32 v18, 1, v18
    s_lshl_b32 s58, s58, 1
    s_nop 1
    v_pk_add_f32 v[92:93], v[28:29], v[92:93]
    v_pk_add_f32 v[94:95], v[30:31], v[94:95]
    v_lshlrev_b32 v112, 16, v68
    v_and_b32 v113, 0xffff0000, v68
    v_lshlrev_b32 v114, 16, v69
    v_and_b32 v115, 0xffff0000, v69
    v_pk_mul_f32 v[92:93], v[92:93], v[48:49]
    v_pk_mul_f32 v[94:95], v[94:95], v[50:51]
    v_pk_add_f32 v[112:113], v[112:113], v[92:93]
    v_pk_add_f32 v[114:115], v[114:115], v[94:95]
    buffer_store_dwordx4 v[112:115], v18, s[84:87], s58 offen offset:0
    v_pk_add_f32 v[96:97], v[32:33], v[96:97]
    v_pk_add_f32 v[98:99], v[34:35], v[98:99]
    v_lshlrev_b32 v116, 16, v70
    v_and_b32 v117, 0xffff0000, v70
    v_lshlrev_b32 v118, 16, v71
    v_and_b32 v119, 0xffff0000, v71
    v_pk_mul_f32 v[96:97], v[96:97], v[52:53]
    v_pk_mul_f32 v[98:99], v[98:99], v[54:55]
    v_pk_add_f32 v[116:117], v[116:117], v[96:97]
    v_pk_add_f32 v[118:119], v[118:119], v[98:99]
    buffer_store_dwordx4 v[116:119], v18, s[84:87], s58 offen offset:64
    v_pk_add_f32 v[100:101], v[36:37], v[100:101]
    v_pk_add_f32 v[102:103], v[38:39], v[102:103]
    v_lshlrev_b32 v120, 16, v72
    v_and_b32 v121, 0xffff0000, v72
    v_lshlrev_b32 v122, 16, v73
    v_and_b32 v123, 0xffff0000, v73
    v_pk_mul_f32 v[100:101], v[100:101], v[56:57]
    v_pk_mul_f32 v[102:103], v[102:103], v[58:59]
    v_pk_add_f32 v[120:121], v[120:121], v[100:101]
    v_pk_add_f32 v[122:123], v[122:123], v[102:103]
    buffer_store_dwordx4 v[120:123], v18, s[84:87], s58 offen offset:128
    v_pk_add_f32 v[104:105], v[40:41], v[104:105]
    v_pk_add_f32 v[106:107], v[42:43], v[106:107]
    v_lshlrev_b32 v124, 16, v74
    v_and_b32 v125, 0xffff0000, v74
    v_lshlrev_b32 v126, 16, v75
    v_and_b32 v127, 0xffff0000, v75
    v_pk_mul_f32 v[104:105], v[104:105], v[60:61]
    v_pk_mul_f32 v[106:107], v[106:107], v[62:63]
    v_pk_add_f32 v[124:125], v[124:125], v[104:105]
    v_pk_add_f32 v[126:127], v[126:127], v[106:107]
    buffer_store_dwordx4 v[124:127], v18, s[84:87], s58 offen offset:192
    v_pk_add_f32 v[108:109], v[44:45], v[108:109]
    v_pk_add_f32 v[110:111], v[46:47], v[110:111]
    v_lshlrev_b32 v128, 16, v76
    v_and_b32 v129, 0xffff0000, v76
    v_lshlrev_b32 v130, 16, v77
    v_and_b32 v131, 0xffff0000, v77
    v_pk_mul_f32 v[108:109], v[108:109], v[64:65]
    v_pk_mul_f32 v[110:111], v[110:111], v[66:67]
    v_pk_add_f32 v[128:129], v[128:129], v[108:109]
    v_pk_add_f32 v[130:131], v[130:131], v[110:111]
    buffer_store_dwordx4 v[128:131], v18, s[84:87], s58 offen offset:256
    s_branch k1_end
k1_ld:
    s_cmp_lg_u32 s49, 0
    s_cbranch_scc1 k1_lF
    s_or_b32 s57, s2, s48
    s_cmp_lg_u32 s57, 0
    s_cbranch_scc1 nononce_15
    s_memrealtime s[70:71]
    v_mov_b32 v18, 0
    s_waitcnt lgkmcnt(0)
    s_or_b32 s70, s70, 1
    v_mov_b32 v20, s70
    v_mov_b32 v21, s71
    s_mov_b64 exec, 1
    global_store_dwordx2 v18, v[20:21], s[30:31] sc1
    s_mov_b64 exec, -1
nononce_15:
    v_xor_b32 v17, v4, v3
    v_mul_u32_u24 v19, 5120, v3
    v_lshl_add_u32 v247, v17, 4, v19
    s_lshl_b32 s60, s50, 7
    s_lshl_b32 s59, s52, 6
    s_add_u32 s60, s60, s59
    s_lshl_b32 s59, s53, 1
    s_add_u32 s60, s60, s59
    s_mul_i32 s60, s60, 1280
    s_lshl_b32 s62, s48, 12
    s_add_u32 s62, s62, 46592
    s_add_u32 m0, s62, 0
    s_add_u32 s65, s60, 0
    buffer_load_dwordx4 v247, s[36:39], s65 offen lds
    s_add_u32 m0, s62, 1024
    s_add_u32 s65, s60, 40960
    buffer_load_dwordx4 v247, s[36:39], s65 offen lds
    s_add_u32 m0, s62, 2048
    s_add_u32 s65, s60, 1280
    buffer_load_dwordx4 v247, s[36:39], s65 offen lds
    s_add_u32 m0, s62, 3072
    s_add_u32 s65, s60, 42240
    buffer_load_dwordx4 v247, s[36:39], s65 offen lds
    s_cmp_lt_u32 s48, 2
    s_cselect_b32 s64, s10, s12
    s_cselect_b32 s65, s11, s13
    s_mov_b32 s40, s64
    s_and_b32 s41, s65, 0xffff
    s_mov_b32 s42, 819200
    s_mov_b32 s43, 0x20000
    v_xor_b32 v18, s52, v17
    v_mul_u32_u24 v19, 1280, v3
    v_lshl_add_u32 v240, v18, 4, v19
    s_mul_i32 s59, s51, 80
    s_mul_i32 s64, s53, 40
    s_add_u32 s59, s59, s64
    s_mul_i32 s59, s59, 1280
    s_mul_i32 s61, s53, 10240
    s_lshl_b32 s64, s52, 10
    s_add_u32 s61, s61, s64
    s_add_u32 s61, s61, 26112
    s_add_u32 m0, s61, 0
    s_add_u32 s65, s59, 0
    buffer_load_dwordx4 v240, s[40:43], s65 offen lds
    s_add_u32 m0, s61, 2048
    s_add_u32 s65, s59, 10240
    buffer_load_dwordx4 v240, s[40:43], s65 offen lds
    s_add_u32 m0, s61, 4096
    s_add_u32 s65, s59, 20480
    buffer_load_dwordx4 v240, s[40:43], s65 offen lds
    s_add_u32 m0, s61, 6144
    s_add_u32 s65, s59, 30720
    buffer_load_dwordx4 v240, s[40:43], s65 offen lds
    s_add_u32 m0, s61, 8192
    s_add_u32 s65, s59, 40960
    buffer_load_dwordx4 v240, s[40:43], s65 offen lds
    s_barrier
    s_add_u32 m0, s61, 36864
    s_add_u32 s65, s59, 128
    buffer_load_dwordx4 v240, s[40:43], s65 offen lds
    s_add_u32 m0, s61, 38912
    s_add_u32 s65, s59, 10368
    buffer_load_dwordx4 v240, s[40:43], s65 offen lds
    s_add_u32 m0, s61, 40960
    s_add_u32 s65, s59, 20608
    buffer_load_dwordx4 v240, s[40:43], s65 offen lds
    s_add_u32 m0, s61, 43008
    s_add_u32 s65, s59, 30848
    buffer_load_dwordx4 v240, s[40:43], s65 offen lds
    s_add_u32 m0, s61, 45056
    s_add_u32 s65, s59, 41088
    buffer_load_dwordx4 v240, s[40:43], s65 offen lds
    s_add_u32 m0, s62, 36864
    s_add_u32 s65, s60, 128
    buffer_load_dwordx4 v247, s[36:39], s65 offen lds
    s_add_u32 m0, s62, 37888
    s_add_u32 s65, s60, 41088
    buffer_load_dwordx4 v247, s[36:39], s65 offen lds
    s_add_u32 m0, s62, 38912
    s_add_u32 s65, s60, 1408
    buffer_load_dwordx4 v247, s[36:39], s65 offen lds
    s_add_u32 m0, s62, 39936
    s_add_u32 s65, s60, 42368
    buffer_load_dwordx4 v247, s[36:39], s65 offen lds
    v_mov_b32 v15, 2147483632
    v_mov_b32 v26, 0
    s_waitcnt vmcnt(9)
    s_barrier
    s_add_u32 m0, s61, 73728
    s_add_u32 s65, s59, 256
    buffer_load_dwordx4 v240, s[40:43], s65 offen lds
    s_add_u32 m0, s61, 75776
    s_add_u32 s65, s59, 10496
    buffer_load_dwordx4 v240, s[40:43], s65 offen lds
    s_add_u32 m0, s61, 77824
    s_add_u32 s65, s59, 20736
    buffer_load_dwordx4 v240, s[40:43], s65 offen lds
    s_add_u32 m0, s61, 79872
    s_add_u32 s65, s59, 30976
    buffer_load_dwordx4 v240, s[40:43], s65 offen lds
    s_add_u32 m0, s61, 81920
    s_add_u32 s65, s59, 41216
    buffer_load_dwordx4 v240, s[40:43], s65 offen lds
    s_add_u32 m0, s62, 73728
    s_add_u32 s65, s60, 256
    buffer_load_dwordx4 v247, s[36:39], s65 offen lds
    s_add_u32 m0, s62, 74752
    s_add_u32 s65, s60, 41216
    buffer_load_dwordx4 v247, s[36:39], s65 offen lds
    s_add_u32 m0, s62, 75776
    s_add_u32 s65, s60, 1536
    buffer_load_dwordx4 v247, s[36:39], s65 offen lds
    s_add_u32 m0, s62, 76800
    s_add_u32 s65, s60, 42496
    buffer_load_dwordx4 v247, s[36:39], s65 offen lds
    s_waitcnt vmcnt(9) lgkmcnt(0)
    s_barrier
    s_add_u32 m0, s61, 0
    s_add_u32 s65, s59, 384
    buffer_load_dwordx4 v240, s[40:43], s65 offen lds
    s_add_u32 m0, s61, 2048
    s_add_u32 s65, s59, 10624
    buffer_load_dwordx4 v240, s[40:43], s65 offen lds
    s_add_u32 m0, s61, 4096
    s_add_u32 s65, s59, 20864
    buffer_load_dwordx4 v240, s[40:43], s65 offen lds
    s_add_u32 m0, s61, 6144
    s_add_u32 s65, s59, 31104
    buffer_load_dwordx4 v240, s[40:43], s65 offen lds
    s_add_u32 m0, s61, 8192
    s_add_u32 s65, s59, 41344
    buffer_load_dwordx4 v240, s[40:43], s65 offen lds
    s_add_u32 m0, s62, 0
    s_add_u32 s65, s60, 384
    buffer_load_dwordx4 v247, s[36:39], s65 offen lds
    s_add_u32 m0, s62, 1024
    s_add_u32 s65, s60, 41344
    buffer_load_dwordx4 v247, s[36:39], s65 offen lds
    s_add_u32 m0, s62, 2048
    s_add_u32 s65, s60, 1664
    buffer_load_dwordx4 v247, s[36:39], s65 offen lds
    s_add_u32 m0, s62, 3072
    s_add_u32 s65, s60, 42624
    buffer_load_dwordx4 v247, s[36:39], s65 offen lds
    global_load_dwordx2 v[28:29], v26, s[30:31] sc1
    s_waitcnt vmcnt(10) lgkmcnt(0)
    s_barrier
    s_add_u32 m0, s61, 36864
    s_add_u32 s65, s59, 512
    buffer_load_dwordx4 v240, s[40:43], s65 offen lds
    s_add_u32 m0, s61, 38912
    s_add_u32 s65, s59, 10752
    buffer_load_dwordx4 v240, s[40:43], s65 offen lds
    s_add_u32 m0, s61, 40960
    s_add_u32 s65, s59, 20992
    buffer_load_dwordx4 v240, s[40:43], s65 offen lds
    s_add_u32 m0, s61, 43008
    s_add_u32 s65, s59, 31232
    buffer_load_dwordx4 v240, s[40:43], s65 offen lds
    s_add_u32 m0, s61, 45056
    s_add_u32 s65, s59, 41472
    buffer_load_dwordx4 v240, s[40:43], s65 offen lds
    s_add_u32 m0, s62, 36864
    s_add_u32 s65, s60, 512
    buffer_load_dwordx4 v247, s[36:39], s65 offen lds
    s_add_u32 m0, s62, 37888
    s_add_u32 s65, s60, 41472
    buffer_load_dwordx4 v247, s[36:39], s65 offen lds
    s_add_u32 m0, s62, 38912
    s_add_u32 s65, s60, 1792
    buffer_load_dwordx4 v247, s[36:39], s65 offen lds
    s_add_u32 m0, s62, 39936
    s_add_u32 s65, s60, 42752
    buffer_load_dwordx4 v247, s[36:39], s65 offen lds
    s_mov_b32 s58, 200000
    s_waitcnt vmcnt(9)
    s_branch npc_18
np_16:
    s_sleep 1
    global_load_dwordx2 v[28:29], v26, s[30:31] sc1
    s_waitcnt vmcnt(0)
npc_18:
    v_readfirstlane_b32 s57, v28
    s_nop 0
    s_cmp_lg_u32 s57, 0
    s_cbranch_scc1 npx_17
    s_sub_u32 s58, s58, 1
    s_cmp_lg_u32 s58, 0
    s_cbranch_scc1 np_16
npx_17:
    ds_write_b64 v26, v[28:29] offset:3008
    s_lshl_b32 s57, s49, 7
    s_lshl_b32 s58, s50, 3
    s_add_u32 s57, s57, s58
    s_add_u32 s57, s57, s51
    s_lshl_b32 s57, s57, 5
    s_lshl_b32 s58, s48, 3
    s_add_u32 s57, s57, s58
    s_add_u32 s79, s57, 589824
    v_cmp_eq_u32 vcc, 0, v0
    s_nop 1
    v_cndmask_b32 v27, v15, v26, vcc
    s_waitcnt lgkmcnt(0)
    s_barrier
    s_add_u32 m0, s61, 73728
    s_add_u32 s65, s59, 640
    buffer_load_dwordx4 v240, s[40:43], s65 offen lds
    s_add_u32 m0, s61, 75776
    s_add_u32 s65, s59, 10880
    buffer_load_dwordx4 v240, s[40:43], s65 offen lds
    s_add_u32 m0, s61, 77824
    s_add_u32 s65, s59, 21120
    buffer_load_dwordx4 v240, s[40:43], s65 offen lds
    s_add_u32 m0, s61, 79872
    s_add_u32 s65, s59, 31360
    buffer_load_dwordx4 v240, s[40:43], s65 offen lds
    s_add_u32 m0, s61, 81920
    s_add_u32 s65, s59, 41600
    buffer_load_dwordx4 v240, s[40:43], s65 offen lds
    s_add_u32 m0, s62, 73728
    s_add_u32 s65, s60, 640
    buffer_load_dwordx4 v247, s[36:39], s65 offen lds
    s_add_u32 m0, s62, 74752
    s_add_u32 s65, s60, 41600
    buffer_load_dwordx4 v247, s[36:39], s65 offen lds
    s_add_u32 m0, s62, 75776
    s_add_u32 s65, s60, 1920
    buffer_load_dwordx4 v247, s[36:39], s65 offen lds
    s_add_u32 m0, s62, 76800
    s_add_u32 s65, s60, 42880
    buffer_load_dwordx4 v247, s[36:39], s65 offen lds
    v_bfe_u32 v20, v0, 1, 4
    v_and_b32 v21, 7, v20
    s_lshl_b32 s57, s50, 3
    s_add_u32 s57, s57, 128
    v_add_u32 v21, s57, v21
    s_lshl_b32 s57, s49, 7
    s_add_u32 s57, s57, s51
    v_lshl_add_u32 v22, v20, 3, s57
    v_cmp_gt_u32 vcc, 32, v0
    s_nop 1
    v_cndmask_b32 v25, v22, v21, vcc
    v_lshlrev_b32 v25, 7, v25
    v_add_u32 v21, 32, v25
    v_cndmask_b32 v25, v25, v21, vcc
    v_and_b32 v20, 1, v0
    v_lshl_add_u32 v25, v20, 4, v25
    v_add_u32 v25, 950272, v25
    s_waitcnt vmcnt(9) lgkmcnt(0)
    s_barrier
    s_add_u32 m0, s61, 0
    s_add_u32 s65, s59, 768
    buffer_load_dwordx4 v240, s[40:43], s65 offen lds
    s_add_u32 m0, s61, 2048
    s_add_u32 s65, s59, 11008
    buffer_load_dwordx4 v240, s[40:43], s65 offen lds
    s_add_u32 m0, s61, 4096
    s_add_u32 s65, s59, 21248
    buffer_load_dwordx4 v240, s[40:43], s65 offen lds
    s_add_u32 m0, s61, 6144
    s_add_u32 s65, s59, 31488
    buffer_load_dwordx4 v240, s[40:43], s65 offen lds
    s_add_u32 m0, s61, 8192
    s_add_u32 s65, s59, 41728
    buffer_load_dwordx4 v240, s[40:43], s65 offen lds
    s_add_u32 m0, s62, 0
    s_add_u32 s65, s60, 768
    buffer_load_dwordx4 v247, s[36:39], s65 offen lds
    s_add_u32 m0, s62, 1024
    s_add_u32 s65, s60, 41728
    buffer_load_dwordx4 v247, s[36:39], s65 offen lds
    s_add_u32 m0, s62, 2048
    s_add_u32 s65, s60, 2048
    buffer_load_dwordx4 v247, s[36:39], s65 offen lds
    s_add_u32 m0, s62, 3072
    s_add_u32 s65, s60, 43008
    buffer_load_dwordx4 v247, s[36:39], s65 offen lds
    s_mov_b32 s68, s26
    s_and_b32 s69, s27, 0xffff
    s_mov_b32 s70, 2211840
    s_mov_b32 s71, 0x20000
    s_lshl_b32 s57, s50, 3
    s_add_u32 s57, s57, s51
    s_lshl_b32 s57, s57, 2
    s_add_u32 s57, s57, s48
    s_lshr_b32 s75, s57, 3
    s_and_b32 s76, s57, 7
    s_mul_i32 s58, s75, 40960
    s_mul_i32 s57, s76, 160
    s_add_u32 s58, s58, s57
    s_mul_i32 s77, s48, 5120
    s_add_u32 s77, s77, 136704
    v_add_u32 v17, 0, v0
    v_mul_u32_u24 v18, 6554, v17
    v_lshrrev_b32 v18, 16, v18
    v_mul_u32_u24 v19, 10, v18
    v_sub_u32 v19, v17, v19
    v_mul_u32_u24 v18, 1280, v18
    v_lshl_add_u32 v16, v19, 4, v18
    s_add_u32 m0, s77, 0
    s_nop 0
    buffer_load_dwordx4 v16, s[68:71], s58 offen lds
    v_add_u32 v17, 64, v0
    v_mul_u32_u24 v18, 6554, v17
    v_lshrrev_b32 v18, 16, v18
    v_mul_u32_u24 v19, 10, v18
    v_sub_u32 v19, v17, v19
    v_mul_u32_u24 v18, 1280, v18
    v_lshl_add_u32 v16, v19, 4, v18
    s_add_u32 m0, s77, 1024
    s_nop 0
    buffer_load_dwordx4 v16, s[68:71], s58 offen lds
    v_add_u32 v17, 128, v0
    v_mul_u32_u24 v18, 6554, v17
    v_lshrrev_b32 v18, 16, v18
    v_mul_u32_u24 v19, 10, v18
    v_sub_u32 v19, v17, v19
    v_mul_u32_u24 v18, 1280, v18
    v_lshl_add_u32 v16, v19, 4, v18
    s_add_u32 m0, s77, 2048
    s_nop 0
    buffer_load_dwordx4 v16, s[68:71], s58 offen lds
    v_add_u32 v17, 192, v0
    v_mul_u32_u24 v18, 6554, v17
    v_lshrrev_b32 v18, 16, v18
    v_mul_u32_u24 v19, 10, v18
    v_sub_u32 v19, v17, v19
    v_mul_u32_u24 v18, 1280, v18
    v_lshl_add_u32 v16, v19, 4, v18
    s_add_u32 m0, s77, 3072
    s_nop 0
    buffer_load_dwordx4 v16, s[68:71], s58 offen lds
    v_add_u32 v17, 256, v0
    v_mul_u32_u24 v18, 6554, v17
    v_lshrrev_b32 v18, 16, v18
    v_mul_u32_u24 v19, 10, v18
    v_sub_u32 v19, v17, v19
    v_mul_u32_u24 v18, 1280, v18
    v_lshl_add_u32 v16, v19, 4, v18
    s_add_u32 m0, s77, 4096
    s_nop 0
    buffer_load_dwordx4 v16, s[68:71], s58 offen lds
    s_waitcnt vmcnt(14) lgkmcnt(0)
    s_barrier
    s_add_u32 m0, s61, 36864
    s_add_u32 s65, s59, 896
    buffer_load_dwordx4 v240, s[40:43], s65 offen lds
    s_add_u32 m0, s61, 38912
    s_add_u32 s65, s59, 11136
    buffer_load_dwordx4 v240, s[40:43], s65 offen lds
    s_add_u32 m0, s61, 40960
    s_add_u32 s65, s59, 21376
    buffer_load_dwordx4 v240, s[40:43], s65 offen lds
    s_add_u32 m0, s61, 43008
    s_add_u32 s65, s59, 31616
    buffer_load_dwordx4 v240, s[40:43], s65 offen lds
    s_add_u32 m0, s61, 45056
    s_add_u32 s65, s59, 41856
    buffer_load_dwordx4 v240, s[40:43], s65 offen lds
    s_add_u32 m0, s62, 36864
    s_add_u32 s65, s60, 896
    buffer_load_dwordx4 v247, s[36:39], s65 offen lds
    s_add_u32 m0, s62, 37888
    s_add_u32 s65, s60, 41856
    buffer_load_dwordx4 v247, s[36:39], s65 offen lds
    s_add_u32 m0, s62, 38912
    s_add_u32 s65, s60, 2176
    buffer_load_dwordx4 v247, s[36:39], s65 offen lds
    s_add_u32 m0, s62, 39936
    s_add_u32 s65, s60, 43136
    buffer_load_dwordx4 v247, s[36:39], s65 offen lds
    s_waitcnt vmcnt(14) lgkmcnt(0)
    s_barrier
    s_add_u32 m0, s61, 73728
    s_add_u32 s65, s59, 1024
    buffer_load_dwordx4 v240, s[40:43], s65 offen lds
    s_add_u32 m0, s61, 75776
    s_add_u32 s65, s59, 11264
    buffer_load_dwordx4 v240, s[40:43], s65 offen lds
    s_add_u32 m0, s61, 77824
    s_add_u32 s65, s59, 21504
    buffer_load_dwordx4 v240, s[40:43], s65 offen lds
    s_add_u32 m0, s61, 79872
    s_add_u32 s65, s59, 31744
    buffer_load_dwordx4 v240, s[40:43], s65 offen lds
    s_add_u32 m0, s61, 81920
    s_add_u32 s65, s59, 41984
    buffer_load_dwordx4 v240, s[40:43], s65 offen lds
    s_add_u32 m0, s62, 73728
    s_add_u32 s65, s60, 1024
    buffer_load_dwordx4 v247, s[36:39], s65 offen lds
    s_add_u32 m0, s62, 74752
    s_add_u32 s65, s60, 41984
    buffer_load_dwordx4 v247, s[36:39], s65 offen lds
    s_add_u32 m0, s62, 75776
    s_add_u32 s65, s60, 2304
    buffer_load_dwordx4 v247, s[36:39], s65 offen lds
    s_add_u32 m0, s62, 76800
    s_add_u32 s65, s60, 43264
    buffer_load_dwordx4 v247, s[36:39], s65 offen lds
    s_waitcnt vmcnt(9) lgkmcnt(0)
    s_barrier
    s_add_u32 m0, s61, 0
    s_add_u32 s65, s59, 1152
    buffer_load_dwordx4 v240, s[40:43], s65 offen lds
    s_add_u32 m0, s61, 2048
    s_add_u32 s65, s59, 11392
    buffer_load_dwordx4 v240, s[40:43], s65 offen lds
    s_add_u32 m0, s61, 4096
    s_add_u32 s65, s59, 21632
    buffer_load_dwordx4 v240, s[40:43], s65 offen lds
    s_add_u32 m0, s61, 6144
    s_add_u32 s65, s59, 31872
    buffer_load_dwordx4 v240, s[40:43], s65 offen lds
    s_add_u32 m0, s61, 8192
    s_add_u32 s65, s59, 42112
    buffer_load_dwordx4 v240, s[40:43], s65 offen lds
    s_add_u32 m0, s62, 0
    s_add_u32 s65, s60, 1152
    buffer_load_dwordx4 v247, s[36:39], s65 offen lds
    s_add_u32 m0, s62, 1024
    s_add_u32 s65, s60, 42112
    buffer_load_dwordx4 v247, s[36:39], s65 offen lds
    s_add_u32 m0, s62, 2048
    s_add_u32 s65, s60, 2432
    buffer_load_dwordx4 v247, s[36:39], s65 offen lds
    s_add_u32 m0, s62, 3072
    s_add_u32 s65, s60, 43392
    buffer_load_dwordx4 v247, s[36:39], s65 offen lds
    buffer_load_dwordx4 v[32:35], v25, s[44:47], 0 offen sc1
    s_waitcnt vmcnt(10) lgkmcnt(0)
    s_barrier
    v_lshrrev_b32 v17, 2, v6
    v_lshl_add_u32 v17, v5, 2, v17
    v_mul_u32_u24 v17, 160, v17
    v_and_b32 v18, 3, v6
    v_lshl_add_u32 v17, v18, 3, v17
    v_add_u32 v17, s77, v17
    ds_read_b64_tr_b16 v[164:165], v17 offset:0
    ds_read_b64_tr_b16 v[166:167], v17 offset:2560
    ds_read_b64_tr_b16 v[168:169], v17 offset:32
    ds_read_b64_tr_b16 v[170:171], v17 offset:2592
    ds_read_b64_tr_b16 v[172:173], v17 offset:64
    ds_read_b64_tr_b16 v[174:175], v17 offset:2624
    ds_read_b64_tr_b16 v[176:177], v17 offset:96
    ds_read_b64_tr_b16 v[178:179], v17 offset:2656
    ds_read_b64_tr_b16 v[180:181], v17 offset:128
    ds_read_b64_tr_b16 v[182:183], v17 offset:2688
    s_mul_i32 s57, s76, 54
    s_add_u32 s57, s57, s75
    s_mul_i32 s57, s57, 5120
    s_add_u32 s57, s57, 3145728
    s_cmp_lt_u32 s75, 54
    s_cselect_b32 s57, s57, 2147483632
    v_lshlrev_b32 v18, 4, v0
    v_add_u32 v19, 4096, v18
    s_waitcnt lgkmcnt(0)
    buffer_store_dwordx4 v[164:167], v18, s[44:47], s57 offen offset:0 sc1
    buffer_store_dwordx4 v[168:171], v18, s[44:47], s57 offen offset:1024 sc1
    buffer_store_dwordx4 v[172:175], v18, s[44:47], s57 offen offset:2048 sc1
    buffer_store_dwordx4 v[176:179], v18, s[44:47], s57 offen offset:3072 sc1
    buffer_store_dwordx4 v[180:183], v19, s[44:47], s57 offen sc1
    s_mov_b32 s58, 200000
    s_waitcnt vmcnt(5)
    s_branch pollc_21
poll_19:
    s_sleep 1
    buffer_load_dwordx4 v[32:35], v25, s[44:47], 0 offen sc1
    s_waitcnt vmcnt(0)
pollc_21:
    v_cmp_ne_u64 vcc, v[32:33], v[28:29]
    v_cmp_ne_u64 s[66:67], v[34:35], v[28:29]
    s_nop 0
    s_or_b64 vcc, vcc, s[66:67]
    s_cmp_eq_u64 vcc, 0
    s_cbranch_scc1 pollx_20
    s_sub_u32 s58, s58, 1
    s_cmp_lg_u32 s58, 0
    s_cbranch_scc1 poll_19
pollx_20:
    v_lshlrev_b32 v34, 4, v1
    s_lshl_b32 s57, s50, 11
    s_add_u32 s57, s57, 0
    buffer_load_dwordx4 v[36:39], v34, s[44:47], s57 offen sc1
    v_lshlrev_b32 v35, 2, v1
    s_mul_i32 s57, s51, 640
    s_add_u32 s57, s57, 917504
    buffer_load_dword v40, v35, s[44:47], s57 offen sc1
    s_waitcnt lgkmcnt(0)
    s_barrier
    s_waitcnt vmcnt(0)
    v_cmp_gt_u32 vcc, 128, v1
    s_nop 0
    s_and_saveexec_b64 s[66:67], vcc
    ds_write_b128 v34, v[36:39] offset:0
    s_mov_b64 exec, s[66:67]
    v_cmp_gt_u32 vcc, 160, v1
    s_nop 0
    s_and_saveexec_b64 s[66:67], vcc
    ds_write_b32 v35, v40 offset:2048
    s_mov_b64 exec, s[66:67]
    s_waitcnt lgkmcnt(0)
    s_barrier
    buffer_store_dwordx2 v[28:29], v27, s[44:47], s79 offen sc1
    s_cmp_eq_u32 s52, 0
    s_cbranch_scc1 lq_22
    v_min_u32 v8, 39, v0
    s_mul_i32 s57, s53, 40
    v_add_u32 v8, s57, v8
    v_lshlrev_b32 v9, 3, v8
    v_add_u32 v9, 157184, v9
    v_mul_u32_u24 v10, 288, v8
    s_mul_i32 s57, s51, 1280
    v_lshlrev_b32 v11, 4, v8
    v_add_u32 v11, s57, v11
    s_mul_i32 s74, s50, 10240
    s_add_u32 s74, s74, 65536
    ds_read_b64 v[72:73], v10 offset:3208
    ds_read_b64 v[74:75], v10 offset:3216
    s_barrier
    ds_read_b64 v[64:65], v9
    ds_read_b64 v[66:67], v9 offset:640
    v_mov_b32 v82, v28
    v_mov_b32 v83, v29
    s_waitcnt lgkmcnt(0)
    v_pk_fma_f32 v[80:81], v[72:73], v[64:65], v[66:67] op_sel:[0,0,0] op_sel_hi:[0,1,1]
    v_pk_fma_f32 v[80:81], v[72:73], v[64:65], v[80:81] op_sel:[1,1,0] op_sel_hi:[1,0,1] neg_lo:[1,0,0]
    buffer_store_dwordx4 v[80:83], v11, s[44:47], s74 offen sc1
    s_mov_b32 s75, 100000
lb_23:
    s_sub_u32 s57, s50, 1
    s_mul_i32 s58, s57, 10240
    s_add_u32 s58, s58, 65536
    s_cmp_gt_u32 s50, 0
    s_cselect_b32 s58, s58, 2147483632
    buffer_load_dwordx4 v[96:99], v11, s[44:47], s58 offen sc1
    s_sub_u32 s57, s50, 2
    s_mul_i32 s58, s57, 10240
    s_add_u32 s58, s58, 65536
    s_cmp_gt_u32 s50, 1
    s_cselect_b32 s58, s58, 2147483632
    buffer_load_dwordx4 v[100:103], v11, s[44:47], s58 offen sc1
    s_sub_u32 s57, s50, 3
    s_mul_i32 s58, s57, 10240
    s_add_u32 s58, s58, 65536
    s_cmp_gt_u32 s50, 2
    s_cselect_b32 s58, s58, 2147483632
    buffer_load_dwordx4 v[104:107], v11, s[44:47], s58 offen sc1
    s_sub_u32 s57, s50, 4
    s_mul_i32 s58, s57, 10240
    s_add_u32 s58, s58, 65536
    s_cmp_gt_u32 s50, 3
    s_cselect_b32 s58, s58, 2147483632
    buffer_load_dwordx4 v[108:111], v11, s[44:47], s58 offen sc1
    s_sub_u32 s57, s50, 5
    s_mul_i32 s58, s57, 10240
    s_add_u32 s58, s58, 65536
    s_cmp_gt_u32 s50, 4
    s_cselect_b32 s58, s58, 2147483632
    buffer_load_dwordx4 v[112:115], v11, s[44:47], s58 offen sc1
    s_sub_u32 s57, s50, 6
    s_mul_i32 s58, s57, 10240
    s_add_u32 s58, s58, 65536
    s_cmp_gt_u32 s50, 5
    s_cselect_b32 s58, s58, 2147483632
    buffer_load_dwordx4 v[116:119], v11, s[44:47], s58 offen sc1
    s_sub_u32 s57, s50, 7
    s_mul_i32 s58, s57, 10240
    s_add_u32 s58, s58, 65536
    s_cmp_gt_u32 s50, 6
    s_cselect_b32 s58, s58, 2147483632
    buffer_load_dwordx4 v[120:123], v11, s[44:47], s58 offen sc1
    s_sub_u32 s57, s50, 8
    s_mul_i32 s58, s57, 10240
    s_add_u32 s58, s58, 65536
    s_cmp_gt_u32 s50, 7
    s_cselect_b32 s58, s58, 2147483632
    buffer_load_dwordx4 v[124:127], v11, s[44:47], s58 offen sc1
    s_sub_u32 s57, s50, 9
    s_mul_i32 s58, s57, 10240
    s_add_u32 s58, s58, 65536
    s_cmp_gt_u32 s50, 8
    s_cselect_b32 s58, s58, 2147483632
    buffer_load_dwordx4 v[128:131], v11, s[44:47], s58 offen sc1
    s_sub_u32 s57, s50, 10
    s_mul_i32 s58, s57, 10240
    s_add_u32 s58, s58, 65536
    s_cmp_gt_u32 s50, 9
    s_cselect_b32 s58, s58, 2147483632
    buffer_load_dwordx4 v[132:135], v11, s[44:47], s58 offen sc1
    s_sub_u32 s57, s50, 11
    s_mul_i32 s58, s57, 10240
    s_add_u32 s58, s58, 65536
    s_cmp_gt_u32 s50, 10
    s_cselect_b32 s58, s58, 2147483632
    buffer_load_dwordx4 v[136:139], v11, s[44:47], s58 offen sc1
    s_sub_u32 s57, s50, 12
    s_mul_i32 s58, s57, 10240
    s_add_u32 s58, s58, 65536
    s_cmp_gt_u32 s50, 11
    s_cselect_b32 s58, s58, 2147483632
    buffer_load_dwordx4 v[140:143], v11, s[44:47], s58 offen sc1
    s_sub_u32 s57, s50, 13
    s_mul_i32 s58, s57, 10240
    s_add_u32 s58, s58, 65536
    s_cmp_gt_u32 s50, 12
    s_cselect_b32 s58, s58, 2147483632
    buffer_load_dwordx4 v[144:147], v11, s[44:47], s58 offen sc1
    s_sub_u32 s57, s50, 14
    s_mul_i32 s58, s57, 10240
    s_add_u32 s58, s58, 65536
    s_cmp_gt_u32 s50, 13
    s_cselect_b32 s58, s58, 2147483632
    buffer_load_dwordx4 v[148:151], v11, s[44:47], s58 offen sc1
    s_sub_u32 s57, s50, 15
    s_mul_i32 s58, s57, 10240
    s_add_u32 s58, s58, 65536
    s_cmp_gt_u32 s50, 14
    s_cselect_b32 s58, s58, 2147483632
    buffer_load_dwordx4 v[152:155], v11, s[44:47], s58 offen sc1
    s_waitcnt vmcnt(0)
    s_mov_b64 vcc, 0
    v_cmp_ne_u64 s[70:71], v[98:99], v[28:29]
    s_cmp_gt_u32 s50, 0
    s_cselect_b64 s[70:71], s[70:71], 0
    s_or_b64 vcc, vcc, s[70:71]
    v_cmp_ne_u64 s[70:71], v[102:103], v[28:29]
    s_cmp_gt_u32 s50, 1
    s_cselect_b64 s[70:71], s[70:71], 0
    s_or_b64 vcc, vcc, s[70:71]
    v_cmp_ne_u64 s[70:71], v[106:107], v[28:29]
    s_cmp_gt_u32 s50, 2
    s_cselect_b64 s[70:71], s[70:71], 0
    s_or_b64 vcc, vcc, s[70:71]
    v_cmp_ne_u64 s[70:71], v[110:111], v[28:29]
    s_cmp_gt_u32 s50, 3
    s_cselect_b64 s[70:71], s[70:71], 0
    s_or_b64 vcc, vcc, s[70:71]
    v_cmp_ne_u64 s[70:71], v[114:115], v[28:29]
    s_cmp_gt_u32 s50, 4
    s_cselect_b64 s[70:71], s[70:71], 0
    s_or_b64 vcc, vcc, s[70:71]
    v_cmp_ne_u64 s[70:71], v[118:119], v[28:29]
    s_cmp_gt_u32 s50, 5
    s_cselect_b64 s[70:71], s[70:71], 0
    s_or_b64 vcc, vcc, s[70:71]
    v_cmp_ne_u64 s[70:71], v[122:123], v[28:29]
    s_cmp_gt_u32 s50, 6
    s_cselect_b64 s[70:71], s[70:71], 0
    s_or_b64 vcc, vcc, s[70:71]
    v_cmp_ne_u64 s[70:71], v[126:127], v[28:29]
    s_cmp_gt_u32 s50, 7
    s_cselect_b64 s[70:71], s[70:71], 0
    s_or_b64 vcc, vcc, s[70:71]
    v_cmp_ne_u64 s[70:71], v[130:131], v[28:29]
    s_cmp_gt_u32 s50, 8
    s_cselect_b64 s[70:71], s[70:71], 0
    s_or_b64 vcc, vcc, s[70:71]
    v_cmp_ne_u64 s[70:71], v[134:135], v[28:29]
    s_cmp_gt_u32 s50, 9
    s_cselect_b64 s[70:71], s[70:71], 0
    s_or_b64 vcc, vcc, s[70:71]
    v_cmp_ne_u64 s[70:71], v[138:139], v[28:29]
    s_cmp_gt_u32 s50, 10
    s_cselect_b64 s[70:71], s[70:71], 0
    s_or_b64 vcc, vcc, s[70:71]
    v_cmp_ne_u64 s[70:71], v[142:143], v[28:29]
    s_cmp_gt_u32 s50, 11
    s_cselect_b64 s[70:71], s[70:71], 0
    s_or_b64 vcc, vcc, s[70:71]
    v_cmp_ne_u64 s[70:71], v[146:147], v[28:29]
    s_cmp_gt_u32 s50, 12
    s_cselect_b64 s[70:71], s[70:71], 0
    s_or_b64 vcc, vcc, s[70:71]
    v_cmp_ne_u64 s[70:71], v[150:151], v[28:29]
    s_cmp_gt_u32 s50, 13
    s_cselect_b64 s[70:71], s[70:71], 0
    s_or_b64 vcc, vcc, s[70:71]
    v_cmp_ne_u64 s[70:71], v[154:155], v[28:29]
    s_cmp_gt_u32 s50, 14
    s_cselect_b64 s[70:71], s[70:71], 0
    s_or_b64 vcc, vcc, s[70:71]
    s_cmp_eq_u64 vcc, 0
    s_cbranch_scc1 lbx_24
    s_sleep 1
    s_sub_u32 s75, s75, 1
    s_cmp_lg_u32 s75, 0
    s_cbranch_scc1 lb_23
lbx_24:
    v_pk_fma_f32 v[148:149], v[74:75], v[152:153], v[148:149] op_sel:[0,0,0] op_sel_hi:[0,1,1]
    v_pk_fma_f32 v[148:149], v[74:75], v[152:153], v[148:149] op_sel:[1,1,0] op_sel_hi:[1,0,1] neg_lo:[1,0,0]
    v_pk_fma_f32 v[144:145], v[74:75], v[148:149], v[144:145] op_sel:[0,0,0] op_sel_hi:[0,1,1]
    v_pk_fma_f32 v[144:145], v[74:75], v[148:149], v[144:145] op_sel:[1,1,0] op_sel_hi:[1,0,1] neg_lo:[1,0,0]
    v_pk_fma_f32 v[140:141], v[74:75], v[144:145], v[140:141] op_sel:[0,0,0] op_sel_hi:[0,1,1]
    v_pk_fma_f32 v[140:141], v[74:75], v[144:145], v[140:141] op_sel:[1,1,0] op_sel_hi:[1,0,1] neg_lo:[1,0,0]
    v_pk_fma_f32 v[136:137], v[74:75], v[140:141], v[136:137] op_sel:[0,0,0] op_sel_hi:[0,1,1]
    v_pk_fma_f32 v[136:137], v[74:75], v[140:141], v[136:137] op_sel:[1,1,0] op_sel_hi:[1,0,1] neg_lo:[1,0,0]
    v_pk_fma_f32 v[132:133], v[74:75], v[136:137], v[132:133] op_sel:[0,0,0] op_sel_hi:[0,1,1]
    v_pk_fma_f32 v[132:133], v[74:75], v[136:137], v[132:133] op_sel:[1,1,0] op_sel_hi:[1,0,1] neg_lo:[1,0,0]
    v_pk_fma_f32 v[128:129], v[74:75], v[132:133], v[128:129] op_sel:[0,0,0] op_sel_hi:[0,1,1]
    v_pk_fma_f32 v[128:129], v[74:75], v[132:133], v[128:129] op_sel:[1,1,0] op_sel_hi:[1,0,1] neg_lo:[1,0,0]
    v_pk_fma_f32 v[124:125], v[74:75], v[128:129], v[124:125] op_sel:[0,0,0] op_sel_hi:[0,1,1]
    v_pk_fma_f32 v[124:125], v[74:75], v[128:129], v[124:125] op_sel:[1,1,0] op_sel_hi:[1,0,1] neg_lo:[1,0,0]
    v_pk_fma_f32 v[120:121], v[74:75], v[124:125], v[120:121] op_sel:[0,0,0] op_sel_hi:[0,1,1]
    v_pk_fma_f32 v[120:121], v[74:75], v[124:125], v[120:121] op_sel:[1,1,0] op_sel_hi:[1,0,1] neg_lo:[1,0,0]
    v_pk_fma_f32 v[116:117], v[74:75], v[120:121], v[116:117] op_sel:[0,0,0] op_sel_hi:[0,1,1]
    v_pk_fma_f32 v[116:117], v[74:75], v[120:121], v[116:117] op_sel:[1,1,0] op_sel_hi:[1,0,1] neg_lo:[1,0,0]
    v_pk_fma_f32 v[112:113], v[74:75], v[116:117], v[112:113] op_sel:[0,0,0] op_sel_hi:[0,1,1]
    v_pk_fma_f32 v[112:113], v[74:75], v[116:117], v[112:113] op_sel:[1,1,0] op_sel_hi:[1,0,1] neg_lo:[1,0,0]
    v_pk_fma_f32 v[108:109], v[74:75], v[112:113], v[108:109] op_sel:[0,0,0] op_sel_hi:[0,1,1]
    v_pk_fma_f32 v[108:109], v[74:75], v[112:113], v[108:109] op_sel:[1,1,0] op_sel_hi:[1,0,1] neg_lo:[1,0,0]
    v_pk_fma_f32 v[104:105], v[74:75], v[108:109], v[104:105] op_sel:[0,0,0] op_sel_hi:[0,1,1]
    v_pk_fma_f32 v[104:105], v[74:75], v[108:109], v[104:105] op_sel:[1,1,0] op_sel_hi:[1,0,1] neg_lo:[1,0,0]
    v_pk_fma_f32 v[100:101], v[74:75], v[104:105], v[100:101] op_sel:[0,0,0] op_sel_hi:[0,1,1]
    v_pk_fma_f32 v[100:101], v[74:75], v[104:105], v[100:101] op_sel:[1,1,0] op_sel_hi:[1,0,1] neg_lo:[1,0,0]
    v_pk_fma_f32 v[96:97], v[74:75], v[100:101], v[96:97] op_sel:[0,0,0] op_sel_hi:[0,1,1]
    v_pk_fma_f32 v[96:97], v[74:75], v[100:101], v[96:97] op_sel:[1,1,0] op_sel_hi:[1,0,1] neg_lo:[1,0,0]
    v_pk_fma_f32 v[84:85], v[72:73], v[96:97], v[64:65] op_sel:[0,0,0] op_sel_hi:[0,1,1]
    v_pk_fma_f32 v[84:85], v[72:73], v[96:97], v[84:85] op_sel:[1,1,0] op_sel_hi:[1,0,1] neg_lo:[1,0,0]
    ds_write_b64 v9, v[96:97] offset:1280
    ds_write_b64 v9, v[84:85] offset:1920
    s_waitcnt lgkmcnt(0)
    s_barrier
lq_22:
    s_branch p2_ld
k1_lF:
    v_xor_b32 v17, v4, v3
    v_mul_u32_u24 v19, 5120, v3
    v_lshl_add_u32 v247, v17, 4, v19
    s_lshl_b32 s60, s50, 7
    s_lshl_b32 s59, s52, 6
    s_add_u32 s60, s60, s59
    s_lshl_b32 s59, s53, 1
    s_add_u32 s60, s60, s59
    s_mul_i32 s60, s60, 1280
    s_lshl_b32 s62, s48, 12
    s_add_u32 s62, s62, 38912
    s_add_u32 m0, s62, 0
    s_add_u32 s65, s60, 0
    buffer_load_dwordx4 v247, s[36:39], s65 offen lds
    s_add_u32 m0, s62, 1024
    s_add_u32 s65, s60, 40960
    buffer_load_dwordx4 v247, s[36:39], s65 offen lds
    s_add_u32 m0, s62, 2048
    s_add_u32 s65, s60, 1280
    buffer_load_dwordx4 v247, s[36:39], s65 offen lds
    s_add_u32 m0, s62, 3072
    s_add_u32 s65, s60, 42240
    buffer_load_dwordx4 v247, s[36:39], s65 offen lds
    s_mov_b32 s40, s24
    s_and_b32 s41, s25, 0xffff
    s_mov_b32 s42, 2211840
    s_mov_b32 s43, 0x20000
    s_mul_i32 s59, s48, 55296
    s_lshl_b32 s64, s54, 5
    s_add_u32 s59, s59, s64
    s_mul_i32 s61, s48, 7168
    s_add_u32 s61, s61, 10240
    v_add_u32 v17, 0, v0
    v_mul_u32_u24 v18, 2341, v17
    v_lshrrev_b32 v18, 16, v18
    v_mul_u32_u24 v19, 28, v18
    v_sub_u32 v19, v17, v19
    v_lshrrev_b32 v17, 2, v18
    v_and_b32 v17, 2, v17
    v_xor_b32 v19, v19, v17
    v_mul_u32_u24 v18, 3456, v18
    v_lshl_add_u32 v240, v19, 4, v18
    s_add_u32 m0, s61, 0
    s_nop 0
    buffer_load_dwordx4 v240, s[40:43], s59 offen lds
    v_add_u32 v17, 64, v0
    v_mul_u32_u24 v18, 2341, v17
    v_lshrrev_b32 v18, 16, v18
    v_mul_u32_u24 v19, 28, v18
    v_sub_u32 v19, v17, v19
    v_lshrrev_b32 v17, 2, v18
    v_and_b32 v17, 2, v17
    v_xor_b32 v19, v19, v17
    v_mul_u32_u24 v18, 3456, v18
    v_lshl_add_u32 v241, v19, 4, v18
    s_add_u32 m0, s61, 1024
    s_nop 0
    buffer_load_dwordx4 v241, s[40:43], s59 offen lds
    v_add_u32 v17, 128, v0
    v_mul_u32_u24 v18, 2341, v17
    v_lshrrev_b32 v18, 16, v18
    v_mul_u32_u24 v19, 28, v18
    v_sub_u32 v19, v17, v19
    v_lshrrev_b32 v17, 2, v18
    v_and_b32 v17, 2, v17
    v_xor_b32 v19, v19, v17
    v_mul_u32_u24 v18, 3456, v18
    v_lshl_add_u32 v242, v19, 4, v18
    s_add_u32 m0, s61, 2048
    s_nop 0
    buffer_load_dwordx4 v242, s[40:43], s59 offen lds
    v_add_u32 v17, 192, v0
    v_mul_u32_u24 v18, 2341, v17
    v_lshrrev_b32 v18, 16, v18
    v_mul_u32_u24 v19, 28, v18
    v_sub_u32 v19, v17, v19
    v_lshrrev_b32 v17, 2, v18
    v_and_b32 v17, 2, v17
    v_xor_b32 v19, v19, v17
    v_mul_u32_u24 v18, 3456, v18
    v_lshl_add_u32 v243, v19, 4, v18
    s_add_u32 m0, s61, 3072
    s_nop 0
    buffer_load_dwordx4 v243, s[40:43], s59 offen lds
    v_add_u32 v17, 256, v0
    v_mul_u32_u24 v18, 2341, v17
    v_lshrrev_b32 v18, 16, v18
    v_mul_u32_u24 v19, 28, v18
    v_sub_u32 v19, v17, v19
    v_lshrrev_b32 v17, 2, v18
    v_and_b32 v17, 2, v17
    v_xor_b32 v19, v19, v17
    v_mul_u32_u24 v18, 3456, v18
    v_lshl_add_u32 v244, v19, 4, v18
    s_add_u32 m0, s61, 4096
    s_nop 0
    buffer_load_dwordx4 v244, s[40:43], s59 offen lds
    v_add_u32 v17, 320, v0
    v_mul_u32_u24 v18, 2341, v17
    v_lshrrev_b32 v18, 16, v18
    v_mul_u32_u24 v19, 28, v18
    v_sub_u32 v19, v17, v19
    v_lshrrev_b32 v17, 2, v18
    v_and_b32 v17, 2, v17
    v_xor_b32 v19, v19, v17
    v_mul_u32_u24 v18, 3456, v18
    v_lshl_add_u32 v245, v19, 4, v18
    s_add_u32 m0, s61, 5120
    s_nop 0
    buffer_load_dwordx4 v245, s[40:43], s59 offen lds
    v_add_u32 v17, 384, v0
    v_mul_u32_u24 v18, 2341, v17
    v_lshrrev_b32 v18, 16, v18
    v_mul_u32_u24 v19, 28, v18
    v_sub_u32 v19, v17, v19
    v_lshrrev_b32 v17, 2, v18
    v_and_b32 v17, 2, v17
    v_xor_b32 v19, v19, v17
    v_mul_u32_u24 v18, 3456, v18
    v_lshl_add_u32 v246, v19, 4, v18
    s_add_u32 m0, s61, 6144
    s_nop 0
    buffer_load_dwordx4 v246, s[40:43], s59 offen lds
    s_barrier
    s_add_u32 s65, s59, 221184
    s_add_u32 m0, s61, 45056
    s_nop 0
    buffer_load_dwordx4 v240, s[40:43], s65 offen lds
    s_add_u32 m0, s61, 46080
    s_nop 0
    buffer_load_dwordx4 v241, s[40:43], s65 offen lds
    s_add_u32 m0, s61, 47104
    s_nop 0
    buffer_load_dwordx4 v242, s[40:43], s65 offen lds
    s_add_u32 m0, s61, 48128
    s_nop 0
    buffer_load_dwordx4 v243, s[40:43], s65 offen lds
    s_add_u32 m0, s61, 49152
    s_nop 0
    buffer_load_dwordx4 v244, s[40:43], s65 offen lds
    s_add_u32 m0, s61, 50176
    s_nop 0
    buffer_load_dwordx4 v245, s[40:43], s65 offen lds
    s_add_u32 m0, s61, 51200
    s_nop 0
    buffer_load_dwordx4 v246, s[40:43], s65 offen lds
    s_add_u32 m0, s62, 45056
    s_add_u32 s65, s60, 128
    buffer_load_dwordx4 v247, s[36:39], s65 offen lds
    s_add_u32 m0, s62, 46080
    s_add_u32 s65, s60, 41088
    buffer_load_dwordx4 v247, s[36:39], s65 offen lds
    s_add_u32 m0, s62, 47104
    s_add_u32 s65, s60, 1408
    buffer_load_dwordx4 v247, s[36:39], s65 offen lds
    s_add_u32 m0, s62, 48128
    s_add_u32 s65, s60, 42368
    buffer_load_dwordx4 v247, s[36:39], s65 offen lds
    v_mov_b32 v15, 2147483632
    v_mov_b32 v26, 0
    s_mul_i32 s57, s50, 138240
    s_mul_i32 s58, s48, 34560
    s_add_u32 s57, s57, s58
    s_add_u32 s57, s57, s64
    s_mul_i32 s72, s48, 4480
    s_add_u32 s72, s72, 145408
    v_add_u32 v17, 0, v0
    v_mul_u32_u24 v18, 2341, v17
    v_lshrrev_b32 v18, 16, v18
    v_mul_u32_u24 v19, 28, v18
    v_sub_u32 v19, v17, v19
    v_mul_u32_u24 v18, 3456, v18
    v_lshl_add_u32 v16, v19, 4, v18
    s_add_u32 m0, s72, 0
    s_nop 0
    buffer_load_dwordx4 v16, s[40:43], s57 offen lds
    v_add_u32 v17, 64, v0
    v_mul_u32_u24 v18, 2341, v17
    v_lshrrev_b32 v18, 16, v18
    v_mul_u32_u24 v19, 28, v18
    v_sub_u32 v19, v17, v19
    v_mul_u32_u24 v18, 3456, v18
    v_lshl_add_u32 v16, v19, 4, v18
    s_add_u32 m0, s72, 1024
    s_nop 0
    buffer_load_dwordx4 v16, s[40:43], s57 offen lds
    v_add_u32 v17, 128, v0
    v_mul_u32_u24 v18, 2341, v17
    v_lshrrev_b32 v18, 16, v18
    v_mul_u32_u24 v19, 28, v18
    v_sub_u32 v19, v17, v19
    v_mul_u32_u24 v18, 3456, v18
    v_lshl_add_u32 v16, v19, 4, v18
    s_add_u32 m0, s72, 2048
    s_nop 0
    buffer_load_dwordx4 v16, s[40:43], s57 offen lds
    v_add_u32 v17, 192, v0
    v_mul_u32_u24 v18, 2341, v17
    v_lshrrev_b32 v18, 16, v18
    v_mul_u32_u24 v19, 28, v18
    v_sub_u32 v19, v17, v19
    v_mul_u32_u24 v18, 3456, v18
    v_lshl_add_u32 v16, v19, 4, v18
    s_add_u32 m0, s72, 3072
    s_nop 0
    buffer_load_dwordx4 v16, s[40:43], s57 offen lds
    v_add_u32 v17, 256, v0
    v_mul_u32_u24 v18, 2341, v17
    v_lshrrev_b32 v18, 16, v18
    v_mul_u32_u24 v19, 28, v18
    v_sub_u32 v19, v17, v19
    v_mul_u32_u24 v18, 3456, v18
    v_lshl_add_u32 v16, v19, 4, v18
    s_add_u32 m0, s72, 4096
    s_mov_b64 exec, 0xffffff
    buffer_load_dwordx4 v16, s[40:43], s57 offen lds
    s_mov_b64 exec, -1
    s_waitcnt vmcnt(16)
    s_barrier
    s_add_u32 s65, s59, 442368
    s_add_u32 m0, s61, 90112
    s_nop 0
    buffer_load_dwordx4 v240, s[40:43], s65 offen lds
    s_add_u32 m0, s61, 91136
    s_nop 0
    buffer_load_dwordx4 v241, s[40:43], s65 offen lds
    s_add_u32 m0, s61, 92160
    s_nop 0
    buffer_load_dwordx4 v242, s[40:43], s65 offen lds
    s_add_u32 m0, s61, 93184
    s_nop 0
    buffer_load_dwordx4 v243, s[40:43], s65 offen lds
    s_add_u32 m0, s61, 94208
    s_nop 0
    buffer_load_dwordx4 v244, s[40:43], s65 offen lds
    s_add_u32 m0, s61, 95232
    s_nop 0
    buffer_load_dwordx4 v245, s[40:43], s65 offen lds
    s_add_u32 m0, s61, 96256
    s_nop 0
    buffer_load_dwordx4 v246, s[40:43], s65 offen lds
    s_add_u32 m0, s62, 90112
    s_add_u32 s65, s60, 256
    buffer_load_dwordx4 v247, s[36:39], s65 offen lds
    s_add_u32 m0, s62, 91136
    s_add_u32 s65, s60, 41216
    buffer_load_dwordx4 v247, s[36:39], s65 offen lds
    s_add_u32 m0, s62, 92160
    s_add_u32 s65, s60, 1536
    buffer_load_dwordx4 v247, s[36:39], s65 offen lds
    s_add_u32 m0, s62, 93184
    s_add_u32 s65, s60, 42496
    buffer_load_dwordx4 v247, s[36:39], s65 offen lds
    v_mul_u32_u24 v7, 2341, v0
    v_lshrrev_b32 v7, 16, v7
    v_mul_u32_u24 v8, 28, v7
    v_sub_u32 v8, v0, v8
    v_min_u32 v7, 1, v7
    v_mul_u32_u24 v9, 2240, v7
    v_lshl_add_u32 v9, v8, 4, v9
    v_add_u32 v9, s72, v9
    s_waitcnt vmcnt(11)
    ds_read_b128 v[72:75], v9 offset:0
    ds_read_b128 v[76:79], v9 offset:448
    ds_read_b128 v[80:83], v9 offset:896
    ds_read_b128 v[84:87], v9 offset:1344
    ds_read_b128 v[88:91], v9 offset:1792
    s_waitcnt lgkmcnt(0)
    v_lshlrev_b32 v108, 16, v72
    v_and_b32 v109, 0xffff0000, v72
    v_lshlrev_b32 v110, 16, v73
    v_and_b32 v111, 0xffff0000, v73
    v_lshlrev_b32 v112, 16, v74
    v_and_b32 v113, 0xffff0000, v74
    v_lshlrev_b32 v114, 16, v75
    v_and_b32 v115, 0xffff0000, v75
    v_lshlrev_b32 v116, 16, v76
    v_and_b32 v117, 0xffff0000, v76
    v_add_f32 v108, v108, v116
    v_add_f32 v109, v109, v117
    v_lshlrev_b32 v116, 16, v77
    v_and_b32 v117, 0xffff0000, v77
    v_add_f32 v110, v110, v116
    v_add_f32 v111, v111, v117
    v_lshlrev_b32 v116, 16, v78
    v_and_b32 v117, 0xffff0000, v78
    v_add_f32 v112, v112, v116
    v_add_f32 v113, v113, v117
    v_lshlrev_b32 v116, 16, v79
    v_and_b32 v117, 0xffff0000, v79
    v_add_f32 v114, v114, v116
    v_add_f32 v115, v115, v117
    v_lshlrev_b32 v116, 16, v80
    v_and_b32 v117, 0xffff0000, v80
    v_add_f32 v108, v108, v116
    v_add_f32 v109, v109, v117
    v_lshlrev_b32 v116, 16, v81
    v_and_b32 v117, 0xffff0000, v81
    v_add_f32 v110, v110, v116
    v_add_f32 v111, v111, v117
    v_lshlrev_b32 v116, 16, v82
    v_and_b32 v117, 0xffff0000, v82
    v_add_f32 v112, v112, v116
    v_add_f32 v113, v113, v117
    v_lshlrev_b32 v116, 16, v83
    v_and_b32 v117, 0xffff0000, v83
    v_add_f32 v114, v114, v116
    v_add_f32 v115, v115, v117
    v_lshlrev_b32 v116, 16, v84
    v_and_b32 v117, 0xffff0000, v84
    v_add_f32 v108, v108, v116
    v_add_f32 v109, v109, v117
    v_lshlrev_b32 v116, 16, v85
    v_and_b32 v117, 0xffff0000, v85
    v_add_f32 v110, v110, v116
    v_add_f32 v111, v111, v117
    v_lshlrev_b32 v116, 16, v86
    v_and_b32 v117, 0xffff0000, v86
    v_add_f32 v112, v112, v116
    v_add_f32 v113, v113, v117
    v_lshlrev_b32 v116, 16, v87
    v_and_b32 v117, 0xffff0000, v87
    v_add_f32 v114, v114, v116
    v_add_f32 v115, v115, v117
    v_lshlrev_b32 v116, 16, v88
    v_and_b32 v117, 0xffff0000, v88
    v_add_f32 v108, v108, v116
    v_add_f32 v109, v109, v117
    v_lshlrev_b32 v116, 16, v89
    v_and_b32 v117, 0xffff0000, v89
    v_add_f32 v110, v110, v116
    v_add_f32 v111, v111, v117
    v_lshlrev_b32 v116, 16, v90
    v_and_b32 v117, 0xffff0000, v90
    v_add_f32 v112, v112, v116
    v_add_f32 v113, v113, v117
    v_lshlrev_b32 v116, 16, v91
    v_and_b32 v117, 0xffff0000, v91
    v_add_f32 v114, v114, v116
    v_add_f32 v115, v115, v117
    s_mul_i32 s57, s48, 1792
    v_lshlrev_b32 v9, 5, v0
    v_add_u32 v9, s57, v9
    v_cmp_gt_u32 vcc, 56, v0
    s_nop 0
    s_and_saveexec_b64 s[66:67], vcc
    ds_write_b128 v9, v[108:111] offset:3072
    ds_write_b128 v9, v[112:115] offset:3088
    s_mov_b64 exec, s[66:67]
    s_waitcnt lgkmcnt(0)
    s_barrier
    s_add_u32 s65, s59, 663552
    s_add_u32 m0, s61, 0
    s_nop 0
    buffer_load_dwordx4 v240, s[40:43], s65 offen lds
    s_add_u32 m0, s61, 1024
    s_nop 0
    buffer_load_dwordx4 v241, s[40:43], s65 offen lds
    s_add_u32 m0, s61, 2048
    s_nop 0
    buffer_load_dwordx4 v242, s[40:43], s65 offen lds
    s_add_u32 m0, s61, 3072
    s_nop 0
    buffer_load_dwordx4 v243, s[40:43], s65 offen lds
    s_add_u32 m0, s61, 4096
    s_nop 0
    buffer_load_dwordx4 v244, s[40:43], s65 offen lds
    s_add_u32 m0, s61, 5120
    s_nop 0
    buffer_load_dwordx4 v245, s[40:43], s65 offen lds
    s_add_u32 m0, s61, 6144
    s_nop 0
    buffer_load_dwordx4 v246, s[40:43], s65 offen lds
    s_add_u32 m0, s62, 0
    s_add_u32 s65, s60, 384
    buffer_load_dwordx4 v247, s[36:39], s65 offen lds
    s_add_u32 m0, s62, 1024
    s_add_u32 s65, s60, 41344
    buffer_load_dwordx4 v247, s[36:39], s65 offen lds
    s_add_u32 m0, s62, 2048
    s_add_u32 s65, s60, 1664
    buffer_load_dwordx4 v247, s[36:39], s65 offen lds
    s_add_u32 m0, s62, 3072
    s_add_u32 s65, s60, 42624
    buffer_load_dwordx4 v247, s[36:39], s65 offen lds
    v_lshlrev_b32 v9, 2, v1
    ds_read_b32 v108, v9 offset:3072
    ds_read_b32 v109, v9 offset:3968
    ds_read_b32 v110, v9 offset:4864
    ds_read_b32 v111, v9 offset:5760
    ds_read_b32 v112, v9 offset:6656
    ds_read_b32 v113, v9 offset:7552
    ds_read_b32 v114, v9 offset:8448
    ds_read_b32 v115, v9 offset:9344
    s_waitcnt lgkmcnt(0)
    v_add_f32 v108, v108, v109
    v_add_f32 v108, v108, v110
    v_add_f32 v108, v108, v111
    v_add_f32 v108, v108, v112
    v_add_f32 v108, v108, v113
    v_add_f32 v108, v108, v114
    v_add_f32 v108, v108, v115
    v_cmp_gt_u32 vcc, 224, v1
    s_nop 0
    s_and_saveexec_b64 s[66:67], vcc
    ds_write_b32 v9, v108 offset:2048
    s_mov_b64 exec, s[66:67]
    global_load_dwordx2 v[28:29], v26, s[30:31] sc1
    s_waitcnt vmcnt(12) lgkmcnt(0)
    s_barrier
    s_add_u32 s65, s59, 884736
    s_add_u32 m0, s61, 45056
    s_nop 0
    buffer_load_dwordx4 v240, s[40:43], s65 offen lds
    s_add_u32 m0, s61, 46080
    s_nop 0
    buffer_load_dwordx4 v241, s[40:43], s65 offen lds
    s_add_u32 m0, s61, 47104
    s_nop 0
    buffer_load_dwordx4 v242, s[40:43], s65 offen lds
    s_add_u32 m0, s61, 48128
    s_nop 0
    buffer_load_dwordx4 v243, s[40:43], s65 offen lds
    s_add_u32 m0, s61, 49152
    s_nop 0
    buffer_load_dwordx4 v244, s[40:43], s65 offen lds
    s_add_u32 m0, s61, 50176
    s_nop 0
    buffer_load_dwordx4 v245, s[40:43], s65 offen lds
    s_add_u32 m0, s61, 51200
    s_nop 0
    buffer_load_dwordx4 v246, s[40:43], s65 offen lds
    s_add_u32 m0, s62, 45056
    s_add_u32 s65, s60, 512
    buffer_load_dwordx4 v247, s[36:39], s65 offen lds
    s_add_u32 m0, s62, 46080
    s_add_u32 s65, s60, 41472
    buffer_load_dwordx4 v247, s[36:39], s65 offen lds
    s_add_u32 m0, s62, 47104
    s_add_u32 s65, s60, 1792
    buffer_load_dwordx4 v247, s[36:39], s65 offen lds
    s_add_u32 m0, s62, 48128
    s_add_u32 s65, s60, 42752
    buffer_load_dwordx4 v247, s[36:39], s65 offen lds
    s_mov_b32 s58, 200000
    s_waitcnt vmcnt(11)
    s_branch npc_27
np_25:
    s_sleep 1
    global_load_dwordx2 v[28:29], v26, s[30:31] sc1
    s_waitcnt vmcnt(0)
npc_27:
    v_readfirstlane_b32 s57, v28
    s_nop 0
    s_cmp_lg_u32 s57, 0
    s_cbranch_scc1 npx_26
    s_sub_u32 s58, s58, 1
    s_cmp_lg_u32 s58, 0
    s_cbranch_scc1 np_25
npx_26:
    ds_write_b64 v26, v[28:29] offset:3008
    s_lshl_b32 s57, s49, 7
    s_lshl_b32 s58, s50, 3
    s_add_u32 s57, s57, s58
    s_add_u32 s57, s57, s51
    s_lshl_b32 s57, s57, 5
    s_lshl_b32 s58, s48, 3
    s_add_u32 s57, s57, s58
    s_add_u32 s79, s57, 589824
    v_cmp_eq_u32 vcc, 0, v0
    s_nop 1
    v_cndmask_b32 v27, v15, v26, vcc
    s_waitcnt lgkmcnt(0)
    s_barrier
    s_add_u32 s65, s59, 1105920
    s_add_u32 m0, s61, 90112
    s_nop 0
    buffer_load_dwordx4 v240, s[40:43], s65 offen lds
    s_add_u32 m0, s61, 91136
    s_nop 0
    buffer_load_dwordx4 v241, s[40:43], s65 offen lds
    s_add_u32 m0, s61, 92160
    s_nop 0
    buffer_load_dwordx4 v242, s[40:43], s65 offen lds
    s_add_u32 m0, s61, 93184
    s_nop 0
    buffer_load_dwordx4 v243, s[40:43], s65 offen lds
    s_add_u32 m0, s61, 94208
    s_nop 0
    buffer_load_dwordx4 v244, s[40:43], s65 offen lds
    s_add_u32 m0, s61, 95232
    s_nop 0
    buffer_load_dwordx4 v245, s[40:43], s65 offen lds
    s_add_u32 m0, s61, 96256
    s_nop 0
    buffer_load_dwordx4 v246, s[40:43], s65 offen lds
    s_add_u32 m0, s62, 90112
    s_add_u32 s65, s60, 640
    buffer_load_dwordx4 v247, s[36:39], s65 offen lds
    s_add_u32 m0, s62, 91136
    s_add_u32 s65, s60, 41600
    buffer_load_dwordx4 v247, s[36:39], s65 offen lds
    s_add_u32 m0, s62, 92160
    s_add_u32 s65, s60, 1920
    buffer_load_dwordx4 v247, s[36:39], s65 offen lds
    s_add_u32 m0, s62, 93184
    s_add_u32 s65, s60, 42880
    buffer_load_dwordx4 v247, s[36:39], s65 offen lds
    v_bfe_u32 v20, v0, 1, 4
    v_and_b32 v21, 7, v20
    s_lshl_b32 s57, s50, 3
    s_add_u32 s57, s57, 128
    v_add_u32 v21, s57, v21
    s_lshl_b32 s57, s49, 7
    s_add_u32 s57, s57, s51
    v_lshl_add_u32 v22, v20, 3, s57
    v_cmp_gt_u32 vcc, 32, v0
    s_nop 1
    v_cndmask_b32 v25, v22, v21, vcc
    v_lshlrev_b32 v25, 7, v25
    v_add_u32 v21, 32, v25
    v_cndmask_b32 v25, v25, v21, vcc
    v_and_b32 v20, 1, v0
    v_lshl_add_u32 v25, v20, 4, v25
    v_add_u32 v25, 950272, v25
    s_waitcnt vmcnt(11) lgkmcnt(0)
    s_barrier
    s_add_u32 s65, s59, 1327104
    s_add_u32 m0, s61, 0
    s_nop 0
    buffer_load_dwordx4 v240, s[40:43], s65 offen lds
    s_add_u32 m0, s61, 1024
    s_nop 0
    buffer_load_dwordx4 v241, s[40:43], s65 offen lds
    s_add_u32 m0, s61, 2048
    s_nop 0
    buffer_load_dwordx4 v242, s[40:43], s65 offen lds
    s_add_u32 m0, s61, 3072
    s_nop 0
    buffer_load_dwordx4 v243, s[40:43], s65 offen lds
    s_add_u32 m0, s61, 4096
    s_nop 0
    buffer_load_dwordx4 v244, s[40:43], s65 offen lds
    s_add_u32 m0, s61, 5120
    s_nop 0
    buffer_load_dwordx4 v245, s[40:43], s65 offen lds
    s_add_u32 m0, s61, 6144
    s_nop 0
    buffer_load_dwordx4 v246, s[40:43], s65 offen lds
    s_add_u32 m0, s62, 0
    s_add_u32 s65, s60, 768
    buffer_load_dwordx4 v247, s[36:39], s65 offen lds
    s_add_u32 m0, s62, 1024
    s_add_u32 s65, s60, 41728
    buffer_load_dwordx4 v247, s[36:39], s65 offen lds
    s_add_u32 m0, s62, 2048
    s_add_u32 s65, s60, 2048
    buffer_load_dwordx4 v247, s[36:39], s65 offen lds
    s_add_u32 m0, s62, 3072
    s_add_u32 s65, s60, 43008
    buffer_load_dwordx4 v247, s[36:39], s65 offen lds
    s_waitcnt vmcnt(11) lgkmcnt(0)
    s_barrier
    s_add_u32 s65, s59, 1548288
    s_add_u32 m0, s61, 45056
    s_nop 0
    buffer_load_dwordx4 v240, s[40:43], s65 offen lds
    s_add_u32 m0, s61, 46080
    s_nop 0
    buffer_load_dwordx4 v241, s[40:43], s65 offen lds
    s_add_u32 m0, s61, 47104
    s_nop 0
    buffer_load_dwordx4 v242, s[40:43], s65 offen lds
    s_add_u32 m0, s61, 48128
    s_nop 0
    buffer_load_dwordx4 v243, s[40:43], s65 offen lds
    s_add_u32 m0, s61, 49152
    s_nop 0
    buffer_load_dwordx4 v244, s[40:43], s65 offen lds
    s_add_u32 m0, s61, 50176
    s_nop 0
    buffer_load_dwordx4 v245, s[40:43], s65 offen lds
    s_add_u32 m0, s61, 51200
    s_nop 0
    buffer_load_dwordx4 v246, s[40:43], s65 offen lds
    s_add_u32 m0, s62, 45056
    s_add_u32 s65, s60, 896
    buffer_load_dwordx4 v247, s[36:39], s65 offen lds
    s_add_u32 m0, s62, 46080
    s_add_u32 s65, s60, 41856
    buffer_load_dwordx4 v247, s[36:39], s65 offen lds
    s_add_u32 m0, s62, 47104
    s_add_u32 s65, s60, 2176
    buffer_load_dwordx4 v247, s[36:39], s65 offen lds
    s_add_u32 m0, s62, 48128
    s_add_u32 s65, s60, 43136
    buffer_load_dwordx4 v247, s[36:39], s65 offen lds
    s_waitcnt vmcnt(11) lgkmcnt(0)
    s_barrier
    s_add_u32 s65, s59, 1769472
    s_add_u32 m0, s61, 90112
    s_nop 0
    buffer_load_dwordx4 v240, s[40:43], s65 offen lds
    s_add_u32 m0, s61, 91136
    s_nop 0
    buffer_load_dwordx4 v241, s[40:43], s65 offen lds
    s_add_u32 m0, s61, 92160
    s_nop 0
    buffer_load_dwordx4 v242, s[40:43], s65 offen lds
    s_add_u32 m0, s61, 93184
    s_nop 0
    buffer_load_dwordx4 v243, s[40:43], s65 offen lds
    s_add_u32 m0, s61, 94208
    s_nop 0
    buffer_load_dwordx4 v244, s[40:43], s65 offen lds
    s_add_u32 m0, s61, 95232
    s_nop 0
    buffer_load_dwordx4 v245, s[40:43], s65 offen lds
    s_add_u32 m0, s61, 96256
    s_nop 0
    buffer_load_dwordx4 v246, s[40:43], s65 offen lds
    s_add_u32 m0, s62, 90112
    s_add_u32 s65, s60, 1024
    buffer_load_dwordx4 v247, s[36:39], s65 offen lds
    s_add_u32 m0, s62, 91136
    s_add_u32 s65, s60, 41984
    buffer_load_dwordx4 v247, s[36:39], s65 offen lds
    s_add_u32 m0, s62, 92160
    s_add_u32 s65, s60, 2304
    buffer_load_dwordx4 v247, s[36:39], s65 offen lds
    s_add_u32 m0, s62, 93184
    s_add_u32 s65, s60, 43264
    buffer_load_dwordx4 v247, s[36:39], s65 offen lds
    s_waitcnt vmcnt(11) lgkmcnt(0)
    s_barrier
    s_add_u32 s65, s59, 1990656
    s_add_u32 m0, s61, 0
    s_nop 0
    buffer_load_dwordx4 v240, s[40:43], s65 offen lds
    s_add_u32 m0, s61, 1024
    s_nop 0
    buffer_load_dwordx4 v241, s[40:43], s65 offen lds
    s_add_u32 m0, s61, 2048
    s_nop 0
    buffer_load_dwordx4 v242, s[40:43], s65 offen lds
    s_add_u32 m0, s61, 3072
    s_nop 0
    buffer_load_dwordx4 v243, s[40:43], s65 offen lds
    s_add_u32 m0, s61, 4096
    s_nop 0
    buffer_load_dwordx4 v244, s[40:43], s65 offen lds
    s_add_u32 m0, s61, 5120
    s_nop 0
    buffer_load_dwordx4 v245, s[40:43], s65 offen lds
    s_add_u32 m0, s61, 6144
    s_nop 0
    buffer_load_dwordx4 v246, s[40:43], s65 offen lds
    s_add_u32 m0, s62, 0
    s_add_u32 s65, s60, 1152
    buffer_load_dwordx4 v247, s[36:39], s65 offen lds
    s_add_u32 m0, s62, 1024
    s_add_u32 s65, s60, 42112
    buffer_load_dwordx4 v247, s[36:39], s65 offen lds
    s_add_u32 m0, s62, 2048
    s_add_u32 s65, s60, 2432
    buffer_load_dwordx4 v247, s[36:39], s65 offen lds
    s_add_u32 m0, s62, 3072
    s_add_u32 s65, s60, 43392
    buffer_load_dwordx4 v247, s[36:39], s65 offen lds
    buffer_load_dwordx4 v[32:35], v25, s[44:47], 0 offen sc1
    s_waitcnt vmcnt(12) lgkmcnt(0)
    s_barrier
    s_mov_b32 s58, 200000
    s_waitcnt vmcnt(0)
    s_branch pollc_30
poll_28:
    s_sleep 1
    buffer_load_dwordx4 v[32:35], v25, s[44:47], 0 offen sc1
    s_waitcnt vmcnt(0)
pollc_30:
    v_cmp_ne_u64 vcc, v[32:33], v[28:29]
    v_cmp_ne_u64 s[66:67], v[34:35], v[28:29]
    s_nop 0
    s_or_b64 vcc, vcc, s[66:67]
    s_cmp_eq_u64 vcc, 0
    s_cbranch_scc1 pollx_29
    s_sub_u32 s58, s58, 1
    s_cmp_lg_u32 s58, 0
    s_cbranch_scc1 poll_28
pollx_29:
    v_lshlrev_b32 v34, 4, v1
    s_lshl_b32 s57, s50, 11
    s_add_u32 s57, s57, 0
    buffer_load_dwordx4 v[36:39], v34, s[44:47], s57 offen sc1
    v_lshlrev_b32 v35, 2, v1
    s_mul_i32 s57, s51, 896
    s_add_u32 s57, s57, 655360
    buffer_load_dword v40, v35, s[44:47], s57 offen sc1
    s_add_u32 s57, s57, 7168
    buffer_load_dword v41, v35, s[44:47], s57 offen sc1
    s_add_u32 s57, s57, 7168
    buffer_load_dword v42, v35, s[44:47], s57 offen sc1
    s_add_u32 s57, s57, 7168
    buffer_load_dword v43, v35, s[44:47], s57 offen sc1
    s_add_u32 s57, s57, 7168
    buffer_load_dword v44, v35, s[44:47], s57 offen sc1
    s_add_u32 s57, s57, 7168
    buffer_load_dword v45, v35, s[44:47], s57 offen sc1
    s_add_u32 s57, s57, 7168
    buffer_load_dword v46, v35, s[44:47], s57 offen sc1
    s_add_u32 s57, s57, 7168
    buffer_load_dword v47, v35, s[44:47], s57 offen sc1
    s_add_u32 s57, s57, 7168
    buffer_load_dword v48, v35, s[44:47], s57 offen sc1
    s_add_u32 s57, s57, 7168
    buffer_load_dword v49, v35, s[44:47], s57 offen sc1
    s_add_u32 s57, s57, 7168
    buffer_load_dword v50, v35, s[44:47], s57 offen sc1
    s_add_u32 s57, s57, 7168
    buffer_load_dword v51, v35, s[44:47], s57 offen sc1
    s_add_u32 s57, s57, 7168
    buffer_load_dword v52, v35, s[44:47], s57 offen sc1
    s_add_u32 s57, s57, 7168
    buffer_load_dword v53, v35, s[44:47], s57 offen sc1
    s_add_u32 s57, s57, 7168
    buffer_load_dword v54, v35, s[44:47], s57 offen sc1
    s_add_u32 s57, s57, 7168
    buffer_load_dword v55, v35, s[44:47], s57 offen sc1
    s_add_u32 s57, s57, 7168
    s_waitcnt lgkmcnt(0)
    s_barrier
    s_waitcnt vmcnt(0)
    v_cmp_gt_u32 vcc, 128, v1
    s_nop 0
    s_and_saveexec_b64 s[66:67], vcc
    ds_write_b128 v34, v[36:39] offset:0
    s_mov_b64 exec, s[66:67]
    v_add_f32 v40, v40, v41
    v_add_f32 v40, v40, v42
    v_add_f32 v40, v40, v43
    v_add_f32 v40, v40, v44
    v_add_f32 v40, v40, v45
    v_add_f32 v40, v40, v46
    v_add_f32 v40, v40, v47
    v_add_f32 v40, v40, v48
    v_add_f32 v40, v40, v49
    v_add_f32 v40, v40, v50
    v_add_f32 v40, v40, v51
    v_add_f32 v40, v40, v52
    v_add_f32 v40, v40, v53
    v_add_f32 v40, v40, v54
    v_add_f32 v40, v40, v55
    v_cmp_gt_u32 vcc, 224, v1
    s_nop 0
    s_and_saveexec_b64 s[66:67], vcc
    ds_write_b32 v35, v40 offset:2048
    s_mov_b64 exec, s[66:67]
    s_waitcnt lgkmcnt(0)
    s_barrier
    s_barrier
    s_cmp_eq_u32 s52, 0
    s_cbranch_scc1 cq_31
    s_mov_b32 s68, s14
    s_and_b32 s69, s15, 0xffff
    s_mov_b32 s70, 819200
    s_mov_b32 s71, 0x20000
    s_mov_b32 s80, s16
    s_and_b32 s81, s17, 0xffff
    s_mov_b32 s82, 819200
    s_mov_b32 s83, 0x20000
    s_lshl_b32 s57, s50, 3
    s_add_u32 s57, s57, s51
    s_lshl_b32 s57, s57, 4
    s_lshl_b32 s58, s53, 2
    s_add_u32 s57, s57, s58
    s_add_u32 s57, s57, 0
    v_add_u32 v10, s57, v5
    v_mul_u32_u24 v11, 1639, v10
    v_lshrrev_b32 v11, 16, v11
    v_mul_u32_u24 v12, 40, v11
    v_sub_u32 v12, v10, v12
    v_lshl_add_u32 v13, v11, 4, v6
    v_mul_u32_u24 v13, 1280, v13
    v_lshl_add_u32 v13, v12, 5, v13
    buffer_load_dwordx4 v[92:95], v13, s[68:71], 0 offen
    buffer_load_dwordx4 v[96:99], v13, s[68:71], 0 offen offset:16
    buffer_load_dwordx4 v[100:103], v13, s[80:83], 0 offen
    buffer_load_dwordx4 v[104:107], v13, s[80:83], 0 offen offset:16
    v_mul_u32_u24 v14, 13108, v11
    v_lshrrev_b32 v14, 16, v14
    v_mul_u32_u24 v16, 5, v14
    v_sub_u32 v16, v11, v16
    v_mul_u32_u24 v14, 40, v14
    v_add_u32 v14, v14, v12
    v_mul_u32_u24 v14, 5120, v14
    v_lshl_add_u32 v14, v16, 10, v14
    v_lshl_add_u32 v14, v6, 4, v14
    v_cmp_gt_u32 vcc, 1600, v10
    s_nop 1
    v_cndmask_b32 v17, v15, v14, vcc
    s_lshl_b32 s57, s50, 3
    s_add_u32 s57, s57, s51
    s_lshl_b32 s57, s57, 4
    s_lshl_b32 s58, s53, 2
    s_add_u32 s57, s57, s58
    s_add_u32 s57, s57, 8
    v_add_u32 v10, s57, v5
    v_mul_u32_u24 v11, 1639, v10
    v_lshrrev_b32 v11, 16, v11
    v_mul_u32_u24 v12, 40, v11
    v_sub_u32 v12, v10, v12
    v_lshl_add_u32 v13, v11, 4, v6
    v_mul_u32_u24 v13, 1280, v13
    v_lshl_add_u32 v13, v12, 5, v13
    buffer_load_dwordx4 v[108:111], v13, s[68:71], 0 offen
    buffer_load_dwordx4 v[112:115], v13, s[68:71], 0 offen offset:16
    buffer_load_dwordx4 v[116:119], v13, s[80:83], 0 offen
    buffer_load_dwordx4 v[120:123], v13, s[80:83], 0 offen offset:16
    v_mul_u32_u24 v14, 13108, v11
    v_lshrrev_b32 v14, 16, v14
    v_mul_u32_u24 v16, 5, v14
    v_sub_u32 v16, v11, v16
    v_mul_u32_u24 v14, 40, v14
    v_add_u32 v14, v14, v12
    v_mul_u32_u24 v14, 5120, v14
    v_lshl_add_u32 v14, v16, 10, v14
    v_lshl_add_u32 v14, v6, 4, v14
    v_cmp_gt_u32 vcc, 1600, v10
    s_nop 1
    v_cndmask_b32 v18, v15, v14, vcc
    s_mov_b32 s57, 0x05040100
    s_mov_b32 s58, 0x07060302
    s_mov_b32 s65, 1048576
    s_waitcnt vmcnt(0)
    v_xor_b32 v100, 0x80008000, v100
    v_xor_b32 v101, 0x80008000, v101
    v_xor_b32 v102, 0x80008000, v102
    v_xor_b32 v103, 0x80008000, v103
    v_xor_b32 v104, 0x80008000, v104
    v_xor_b32 v105, 0x80008000, v105
    v_xor_b32 v106, 0x80008000, v106
    v_xor_b32 v107, 0x80008000, v107
    v_perm_b32 v40, v100, v92, s57
    v_perm_b32 v41, v100, v92, s58
    v_perm_b32 v42, v104, v96, s57
    v_perm_b32 v43, v104, v96, s58
    buffer_store_dwordx4 v[40:43], v17, s[44:47], s65 offen offset:0 sc1
    v_perm_b32 v44, v101, v93, s57
    v_perm_b32 v45, v101, v93, s58
    v_perm_b32 v46, v105, v97, s57
    v_perm_b32 v47, v105, v97, s58
    buffer_store_dwordx4 v[44:47], v17, s[44:47], s65 offen offset:256 sc1
    v_perm_b32 v48, v102, v94, s57
    v_perm_b32 v49, v102, v94, s58
    v_perm_b32 v50, v106, v98, s57
    v_perm_b32 v51, v106, v98, s58
    buffer_store_dwordx4 v[48:51], v17, s[44:47], s65 offen offset:512 sc1
    v_perm_b32 v52, v103, v95, s57
    v_perm_b32 v53, v103, v95, s58
    v_perm_b32 v54, v107, v99, s57
    v_perm_b32 v55, v107, v99, s58
    buffer_store_dwordx4 v[52:55], v17, s[44:47], s65 offen offset:768 sc1
    v_xor_b32 v116, 0x80008000, v116
    v_xor_b32 v117, 0x80008000, v117
    v_xor_b32 v118, 0x80008000, v118
    v_xor_b32 v119, 0x80008000, v119
    v_xor_b32 v120, 0x80008000, v120
    v_xor_b32 v121, 0x80008000, v121
    v_xor_b32 v122, 0x80008000, v122
    v_xor_b32 v123, 0x80008000, v123
    v_perm_b32 v56, v116, v108, s57
    v_perm_b32 v57, v116, v108, s58
    v_perm_b32 v58, v120, v112, s57
    v_perm_b32 v59, v120, v112, s58
    buffer_store_dwordx4 v[56:59], v18, s[44:47], s65 offen offset:0 sc1
    v_perm_b32 v60, v117, v109, s57
    v_perm_b32 v61, v117, v109, s58
    v_perm_b32 v62, v121, v113, s57
    v_perm_b32 v63, v121, v113, s58
    buffer_store_dwordx4 v[60:63], v18, s[44:47], s65 offen offset:256 sc1
    v_perm_b32 v64, v118, v110, s57
    v_perm_b32 v65, v118, v110, s58
    v_perm_b32 v66, v122, v114, s57
    v_perm_b32 v67, v122, v114, s58
    buffer_store_dwordx4 v[64:67], v18, s[44:47], s65 offen offset:512 sc1
    v_perm_b32 v68, v119, v111, s57
    v_perm_b32 v69, v119, v111, s58
    v_perm_b32 v70, v123, v115, s57
    v_perm_b32 v71, v123, v115, s58
    buffer_store_dwordx4 v[68:71], v18, s[44:47], s65 offen offset:768 sc1
    s_waitcnt vmcnt(0)
cq_31:
    buffer_store_dwordx2 v[28:29], v27, s[44:47], s79 offen sc1
p2_ld:
    s_lshl_b32 s57, s49, 7
    s_lshl_b32 s58, s50, 3
    s_add_u32 s57, s57, s58
    s_add_u32 s57, s57, s51
    s_lshl_b32 s57, s57, 7
    s_lshl_b32 s58, s48, 3
    s_add_u32 s57, s57, s58
    s_add_u32 s77, s57, 524288
    s_mov_b32 s78, s49
    s_and_b32 s57, s2, 3
    s_bfe_u32 s58, s2, 0x10002
    s_lshr_b32 s59, s35, 2
    s_lshl_b32 s50, s57, 2
    s_lshr_b32 s57, s59, 1
    s_add_u32 s50, s50, s57
    s_and_b32 s49, s59, 1
    s_lshl_b32 s51, s58, 2
    s_and_b32 s57, s35, 3
    s_add_u32 s51, s51, s57
    v_lshlrev_b32 v10, 4, v0
    s_mul_i32 s57, s53, 5120
    s_mul_i32 s62, s51, 204800
    s_add_u32 s62, s62, s57
    s_add_u32 s62, s62, 1048576
    s_mul_i32 s63, s51, 276480
    s_add_u32 s63, s63, s57
    s_add_u32 s63, s63, 3145728
    s_add_u32 s57, s57, 26112
    s_lshl_b32 s58, s53, 13
    s_lshl_b32 s59, s49, 12
    s_add_u32 s58, s58, s59
    s_mul_i32 s64, s50, 327680
    s_add_u32 s64, s64, s58
    s_add_u32 s64, s64, 6291456
    s_mul_i32 s66, s50, 442368
    s_add_u32 s66, s66, s58
    s_add_u32 s66, s66, 12582912
    s_lshl_b32 s59, s53, 12
    s_add_u32 s59, s59, 97792
    s_cmp_lg_u32 s52, 0
    s_cselect_b32 s62, s64, s62
    s_cselect_b32 s63, s66, s63
    s_cselect_b32 s58, s59, s57
    s_cbranch_scc0 p2_lA
    v_bfe_u32 v30, v0, 2, 3
    v_and_b32 v31, 3, v0
    v_lshlrev_b32 v30, 7, v30
    v_lshl_add_u32 v30, v31, 3, v30
    s_lshl_b32 s64, s50, 10
    s_add_u32 s64, s64, 524288
    s_add_u32 s66, s64, 16384
    s_mov_b32 s74, 0
    s_lshl_b32 s75, 5, s49
    s_mov_b32 s70, 400000
pp_32:
    s_and_b32 s71, s74, s75
    s_cmp_eq_u32 s71, s75
    s_cbranch_scc1 ppx_33
    buffer_load_dwordx2 v[34:35], v30, s[44:47], s66 offen sc1
    s_waitcnt vmcnt(0)
    v_cmp_eq_u64 vcc, v[34:35], v[28:29]
    s_nop 1
    s_mov_b32 s74, vcc_lo
    s_sub_u32 s70, s70, 1
    s_cmp_lg_u32 s70, 0
    s_cbranch_scc1 pp_32
ppx_33:
    s_add_u32 m0, s58, 0
    s_add_u32 s65, s63, 0
    buffer_load_dwordx4 v10, s[44:47], s65 offen sc1 lds
    s_add_u32 m0, s58, 1024
    s_add_u32 s65, s63, 1024
    buffer_load_dwordx4 v10, s[44:47], s65 offen sc1 lds
    s_add_u32 m0, s58, 2048
    s_add_u32 s65, s63, 2048
    buffer_load_dwordx4 v10, s[44:47], s65 offen sc1 lds
    s_add_u32 m0, s58, 3072
    s_add_u32 s65, s63, 3072
    buffer_load_dwordx4 v10, s[44:47], s65 offen sc1 lds
    s_add_u32 m0, s58, 8192
    s_add_u32 s65, s63, 16384
    buffer_load_dwordx4 v10, s[44:47], s65 offen sc1 lds
    s_add_u32 m0, s58, 9216
    s_add_u32 s65, s63, 17408
    buffer_load_dwordx4 v10, s[44:47], s65 offen sc1 lds
    s_add_u32 m0, s58, 10240
    s_add_u32 s65, s63, 18432
    buffer_load_dwordx4 v10, s[44:47], s65 offen sc1 lds
    s_add_u32 m0, s58, 11264
    s_add_u32 s65, s63, 19456
    buffer_load_dwordx4 v10, s[44:47], s65 offen sc1 lds
    s_add_u32 m0, s58, 16384
    s_add_u32 s65, s63, 32768
    buffer_load_dwordx4 v10, s[44:47], s65 offen sc1 lds
    s_add_u32 m0, s58, 17408
    s_add_u32 s65, s63, 33792
    buffer_load_dwordx4 v10, s[44:47], s65 offen sc1 lds
    s_add_u32 m0, s58, 18432
    s_add_u32 s65, s63, 34816
    buffer_load_dwordx4 v10, s[44:47], s65 offen sc1 lds
    s_add_u32 m0, s58, 19456
    s_add_u32 s65, s63, 35840
    buffer_load_dwordx4 v10, s[44:47], s65 offen sc1 lds
    s_waitcnt vmcnt(8)
    s_barrier
    s_waitcnt vmcnt(4)
    s_barrier
    s_lshl_b32 s75, 80, s49
    s_mov_b32 s70, 400000
pp_34:
    s_and_b32 s71, s74, s75
    s_cmp_eq_u32 s71, s75
    s_cbranch_scc1 ppx_35
    buffer_load_dwordx2 v[34:35], v30, s[44:47], s66 offen sc1
    s_waitcnt vmcnt(0)
    v_cmp_eq_u64 vcc, v[34:35], v[28:29]
    s_nop 1
    s_mov_b32 s74, vcc_lo
    s_sub_u32 s70, s70, 1
    s_cmp_lg_u32 s70, 0
    s_cbranch_scc1 pp_34
ppx_35:
    s_add_u32 m0, s58, 24576
    s_add_u32 s65, s63, 49152
    buffer_load_dwordx4 v10, s[44:47], s65 offen sc1 lds
    s_add_u32 m0, s58, 25600
    s_add_u32 s65, s63, 50176
    buffer_load_dwordx4 v10, s[44:47], s65 offen sc1 lds
    s_add_u32 m0, s58, 26624
    s_add_u32 s65, s63, 51200
    buffer_load_dwordx4 v10, s[44:47], s65 offen sc1 lds
    s_add_u32 m0, s58, 27648
    s_add_u32 s65, s63, 52224
    buffer_load_dwordx4 v10, s[44:47], s65 offen sc1 lds
    s_add_u32 m0, s58, 32768
    s_add_u32 s65, s63, 65536
    buffer_load_dwordx4 v10, s[44:47], s65 offen sc1 lds
    s_add_u32 m0, s58, 33792
    s_add_u32 s65, s63, 66560
    buffer_load_dwordx4 v10, s[44:47], s65 offen sc1 lds
    s_add_u32 m0, s58, 34816
    s_add_u32 s65, s63, 67584
    buffer_load_dwordx4 v10, s[44:47], s65 offen sc1 lds
    s_add_u32 m0, s58, 35840
    s_add_u32 s65, s63, 68608
    buffer_load_dwordx4 v10, s[44:47], s65 offen sc1 lds
    s_add_u32 m0, s58, 40960
    s_add_u32 s65, s63, 81920
    buffer_load_dwordx4 v10, s[44:47], s65 offen sc1 lds
    s_add_u32 m0, s58, 41984
    s_add_u32 s65, s63, 82944
    buffer_load_dwordx4 v10, s[44:47], s65 offen sc1 lds
    s_add_u32 m0, s58, 43008
    s_add_u32 s65, s63, 83968
    buffer_load_dwordx4 v10, s[44:47], s65 offen sc1 lds
    s_add_u32 m0, s58, 44032
    s_add_u32 s65, s63, 84992
    buffer_load_dwordx4 v10, s[44:47], s65 offen sc1 lds
    s_add_u32 m0, s58, 49152
    s_add_u32 s65, s63, 98304
    buffer_load_dwordx4 v10, s[44:47], s65 offen sc1 lds
    s_add_u32 m0, s58, 50176
    s_add_u32 s65, s63, 99328
    buffer_load_dwordx4 v10, s[44:47], s65 offen sc1 lds
    s_add_u32 m0, s58, 51200
    s_add_u32 s65, s63, 100352
    buffer_load_dwordx4 v10, s[44:47], s65 offen sc1 lds
    s_add_u32 m0, s58, 52224
    s_add_u32 s65, s63, 101376
    buffer_load_dwordx4 v10, s[44:47], s65 offen sc1 lds
    s_waitcnt vmcnt(16)
    s_barrier
    s_lshl_b32 s75, 1280, s49
    s_mov_b32 s70, 400000
pp_36:
    s_and_b32 s71, s74, s75
    s_cmp_eq_u32 s71, s75
    s_cbranch_scc1 ppx_37
    buffer_load_dwordx2 v[34:35], v30, s[44:47], s66 offen sc1
    s_waitcnt vmcnt(0)
    v_cmp_eq_u64 vcc, v[34:35], v[28:29]
    s_nop 1
    s_mov_b32 s74, vcc_lo
    s_sub_u32 s70, s70, 1
    s_cmp_lg_u32 s70, 0
    s_cbranch_scc1 pp_36
ppx_37:
    s_add_u32 m0, s58, 0
    s_add_u32 s65, s63, 114688
    buffer_load_dwordx4 v10, s[44:47], s65 offen sc1 lds
    s_add_u32 m0, s58, 1024
    s_add_u32 s65, s63, 115712
    buffer_load_dwordx4 v10, s[44:47], s65 offen sc1 lds
    s_add_u32 m0, s58, 2048
    s_add_u32 s65, s63, 116736
    buffer_load_dwordx4 v10, s[44:47], s65 offen sc1 lds
    s_add_u32 m0, s58, 3072
    s_add_u32 s65, s63, 117760
    buffer_load_dwordx4 v10, s[44:47], s65 offen sc1 lds
    s_waitcnt vmcnt(16)
    s_barrier
    s_add_u32 m0, s58, 8192
    s_add_u32 s65, s63, 131072
    buffer_load_dwordx4 v10, s[44:47], s65 offen sc1 lds
    s_add_u32 m0, s58, 9216
    s_add_u32 s65, s63, 132096
    buffer_load_dwordx4 v10, s[44:47], s65 offen sc1 lds
    s_add_u32 m0, s58, 10240
    s_add_u32 s65, s63, 133120
    buffer_load_dwordx4 v10, s[44:47], s65 offen sc1 lds
    s_add_u32 m0, s58, 11264
    s_add_u32 s65, s63, 134144
    buffer_load_dwordx4 v10, s[44:47], s65 offen sc1 lds
    s_waitcnt vmcnt(16)
    s_barrier
    s_add_u32 m0, s58, 16384
    s_add_u32 s65, s63, 147456
    buffer_load_dwordx4 v10, s[44:47], s65 offen sc1 lds
    s_add_u32 m0, s58, 17408
    s_add_u32 s65, s63, 148480
    buffer_load_dwordx4 v10, s[44:47], s65 offen sc1 lds
    s_add_u32 m0, s58, 18432
    s_add_u32 s65, s63, 149504
    buffer_load_dwordx4 v10, s[44:47], s65 offen sc1 lds
    s_add_u32 m0, s58, 19456
    s_add_u32 s65, s63, 150528
    buffer_load_dwordx4 v10, s[44:47], s65 offen sc1 lds
    s_waitcnt vmcnt(16)
    s_barrier
    s_lshl_b32 s75, 20480, s49
    s_mov_b32 s70, 400000
pp_38:
    s_and_b32 s71, s74, s75
    s_cmp_eq_u32 s71, s75
    s_cbranch_scc1 ppx_39
    buffer_load_dwordx2 v[34:35], v30, s[44:47], s66 offen sc1
    s_waitcnt vmcnt(0)
    v_cmp_eq_u64 vcc, v[34:35], v[28:29]
    s_nop 1
    s_mov_b32 s74, vcc_lo
    s_sub_u32 s70, s70, 1
    s_cmp_lg_u32 s70, 0
    s_cbranch_scc1 pp_38
ppx_39:
    s_add_u32 m0, s58, 24576
    s_add_u32 s65, s63, 163840
    buffer_load_dwordx4 v10, s[44:47], s65 offen sc1 lds
    s_add_u32 m0, s58, 25600
    s_add_u32 s65, s63, 164864
    buffer_load_dwordx4 v10, s[44:47], s65 offen sc1 lds
    s_add_u32 m0, s58, 26624
    s_add_u32 s65, s63, 165888
    buffer_load_dwordx4 v10, s[44:47], s65 offen sc1 lds
    s_add_u32 m0, s58, 27648
    s_add_u32 s65, s63, 166912
    buffer_load_dwordx4 v10, s[44:47], s65 offen sc1 lds
    s_waitcnt vmcnt(16)
    s_barrier
    s_add_u32 m0, s58, 32768
    s_add_u32 s65, s63, 180224
    buffer_load_dwordx4 v10, s[44:47], s65 offen sc1 lds
    s_add_u32 m0, s58, 33792
    s_add_u32 s65, s63, 181248
    buffer_load_dwordx4 v10, s[44:47], s65 offen sc1 lds
    s_add_u32 m0, s58, 34816
    s_add_u32 s65, s63, 182272
    buffer_load_dwordx4 v10, s[44:47], s65 offen sc1 lds
    s_add_u32 m0, s58, 35840
    s_add_u32 s65, s63, 183296
    buffer_load_dwordx4 v10, s[44:47], s65 offen sc1 lds
    s_waitcnt vmcnt(16)
    s_barrier
    s_add_u32 m0, s58, 40960
    s_add_u32 s65, s63, 196608
    buffer_load_dwordx4 v10, s[44:47], s65 offen sc1 lds
    s_add_u32 m0, s58, 41984
    s_add_u32 s65, s63, 197632
    buffer_load_dwordx4 v10, s[44:47], s65 offen sc1 lds
    s_add_u32 m0, s58, 43008
    s_add_u32 s65, s63, 198656
    buffer_load_dwordx4 v10, s[44:47], s65 offen sc1 lds
    s_add_u32 m0, s58, 44032
    s_add_u32 s65, s63, 199680
    buffer_load_dwordx4 v10, s[44:47], s65 offen sc1 lds
    s_waitcnt vmcnt(16)
    s_barrier
    s_add_u32 m0, s58, 49152
    s_add_u32 s65, s63, 212992
    buffer_load_dwordx4 v10, s[44:47], s65 offen sc1 lds
    s_add_u32 m0, s58, 50176
    s_add_u32 s65, s63, 214016
    buffer_load_dwordx4 v10, s[44:47], s65 offen sc1 lds
    s_add_u32 m0, s58, 51200
    s_add_u32 s65, s63, 215040
    buffer_load_dwordx4 v10, s[44:47], s65 offen sc1 lds
    s_add_u32 m0, s58, 52224
    s_add_u32 s65, s63, 216064
    buffer_load_dwordx4 v10, s[44:47], s65 offen sc1 lds
    s_waitcnt vmcnt(16)
    s_barrier
    s_lshl_b32 s75, 327680, s49
    s_mov_b32 s70, 400000
pp_40:
    s_and_b32 s71, s74, s75
    s_cmp_eq_u32 s71, s75
    s_cbranch_scc1 ppx_41
    buffer_load_dwordx2 v[34:35], v30, s[44:47], s66 offen sc1
    s_waitcnt vmcnt(0)
    v_cmp_eq_u64 vcc, v[34:35], v[28:29]
    s_nop 1
    s_mov_b32 s74, vcc_lo
    s_sub_u32 s70, s70, 1
    s_cmp_lg_u32 s70, 0
    s_cbranch_scc1 pp_40
ppx_41:
    s_add_u32 m0, s58, 0
    s_add_u32 s65, s63, 229376
    buffer_load_dwordx4 v10, s[44:47], s65 offen sc1 lds
    s_add_u32 m0, s58, 1024
    s_add_u32 s65, s63, 230400
    buffer_load_dwordx4 v10, s[44:47], s65 offen sc1 lds
    s_add_u32 m0, s58, 2048
    s_add_u32 s65, s63, 231424
    buffer_load_dwordx4 v10, s[44:47], s65 offen sc1 lds
    s_add_u32 m0, s58, 3072
    s_add_u32 s65, s63, 232448
    buffer_load_dwordx4 v10, s[44:47], s65 offen sc1 lds
    s_waitcnt vmcnt(16)
    s_barrier
    s_add_u32 m0, s58, 8192
    s_add_u32 s65, s63, 245760
    buffer_load_dwordx4 v10, s[44:47], s65 offen sc1 lds
    s_add_u32 m0, s58, 9216
    s_add_u32 s65, s63, 246784
    buffer_load_dwordx4 v10, s[44:47], s65 offen sc1 lds
    s_add_u32 m0, s58, 10240
    s_add_u32 s65, s63, 247808
    buffer_load_dwordx4 v10, s[44:47], s65 offen sc1 lds
    s_add_u32 m0, s58, 11264
    s_add_u32 s65, s63, 248832
    buffer_load_dwordx4 v10, s[44:47], s65 offen sc1 lds
    s_waitcnt vmcnt(16)
    s_barrier
    s_add_u32 m0, s58, 16384
    s_add_u32 s65, s63, 262144
    buffer_load_dwordx4 v10, s[44:47], s65 offen sc1 lds
    s_add_u32 m0, s58, 17408
    s_add_u32 s65, s63, 263168
    buffer_load_dwordx4 v10, s[44:47], s65 offen sc1 lds
    s_add_u32 m0, s58, 18432
    s_add_u32 s65, s63, 264192
    buffer_load_dwordx4 v10, s[44:47], s65 offen sc1 lds
    s_add_u32 m0, s58, 19456
    s_add_u32 s65, s63, 265216
    buffer_load_dwordx4 v10, s[44:47], s65 offen sc1 lds
    s_waitcnt vmcnt(16)
    s_barrier
    s_lshl_b32 s75, 5242880, s49
    s_mov_b32 s70, 400000
pp_42:
    s_and_b32 s71, s74, s75
    s_cmp_eq_u32 s71, s75
    s_cbranch_scc1 ppx_43
    buffer_load_dwordx2 v[34:35], v30, s[44:47], s66 offen sc1
    s_waitcnt vmcnt(0)
    v_cmp_eq_u64 vcc, v[34:35], v[28:29]
    s_nop 1
    s_mov_b32 s74, vcc_lo
    s_sub_u32 s70, s70, 1
    s_cmp_lg_u32 s70, 0
    s_cbranch_scc1 pp_42
ppx_43:
    s_add_u32 m0, s58, 24576
    s_add_u32 s65, s63, 278528
    buffer_load_dwordx4 v10, s[44:47], s65 offen sc1 lds
    s_add_u32 m0, s58, 25600
    s_add_u32 s65, s63, 279552
    buffer_load_dwordx4 v10, s[44:47], s65 offen sc1 lds
    s_add_u32 m0, s58, 26624
    s_add_u32 s65, s63, 280576
    buffer_load_dwordx4 v10, s[44:47], s65 offen sc1 lds
    s_add_u32 m0, s58, 27648
    s_add_u32 s65, s63, 281600
    buffer_load_dwordx4 v10, s[44:47], s65 offen sc1 lds
    s_waitcnt vmcnt(16)
    s_barrier
    s_add_u32 m0, s58, 32768
    s_add_u32 s65, s63, 294912
    buffer_load_dwordx4 v10, s[44:47], s65 offen sc1 lds
    s_add_u32 m0, s58, 33792
    s_add_u32 s65, s63, 295936
    buffer_load_dwordx4 v10, s[44:47], s65 offen sc1 lds
    s_add_u32 m0, s58, 34816
    s_add_u32 s65, s63, 296960
    buffer_load_dwordx4 v10, s[44:47], s65 offen sc1 lds
    s_add_u32 m0, s58, 35840
    s_add_u32 s65, s63, 297984
    buffer_load_dwordx4 v10, s[44:47], s65 offen sc1 lds
    s_waitcnt vmcnt(16)
    s_barrier
    s_add_u32 m0, s58, 40960
    s_add_u32 s65, s63, 311296
    buffer_load_dwordx4 v10, s[44:47], s65 offen sc1 lds
    s_add_u32 m0, s58, 41984
    s_add_u32 s65, s63, 312320
    buffer_load_dwordx4 v10, s[44:47], s65 offen sc1 lds
    s_add_u32 m0, s58, 43008
    s_add_u32 s65, s63, 313344
    buffer_load_dwordx4 v10, s[44:47], s65 offen sc1 lds
    s_add_u32 m0, s58, 44032
    s_add_u32 s65, s63, 314368
    buffer_load_dwordx4 v10, s[44:47], s65 offen sc1 lds
    s_waitcnt vmcnt(16)
    s_barrier
    s_add_u32 m0, s58, 49152
    s_add_u32 s65, s63, 327680
    buffer_load_dwordx4 v10, s[44:47], s65 offen sc1 lds
    s_add_u32 m0, s58, 50176
    s_add_u32 s65, s63, 328704
    buffer_load_dwordx4 v10, s[44:47], s65 offen sc1 lds
    s_add_u32 m0, s58, 51200
    s_add_u32 s65, s63, 329728
    buffer_load_dwordx4 v10, s[44:47], s65 offen sc1 lds
    s_add_u32 m0, s58, 52224
    s_add_u32 s65, s63, 330752
    buffer_load_dwordx4 v10, s[44:47], s65 offen sc1 lds
    s_waitcnt vmcnt(16)
    s_barrier
    s_lshl_b32 s75, 83886080, s49
    s_mov_b32 s70, 400000
pp_44:
    s_and_b32 s71, s74, s75
    s_cmp_eq_u32 s71, s75
    s_cbranch_scc1 ppx_45
    buffer_load_dwordx2 v[34:35], v30, s[44:47], s66 offen sc1
    s_waitcnt vmcnt(0)
    v_cmp_eq_u64 vcc, v[34:35], v[28:29]
    s_nop 1
    s_mov_b32 s74, vcc_lo
    s_sub_u32 s70, s70, 1
    s_cmp_lg_u32 s70, 0
    s_cbranch_scc1 pp_44
ppx_45:
    s_add_u32 m0, s58, 0
    s_add_u32 s65, s63, 344064
    buffer_load_dwordx4 v10, s[44:47], s65 offen sc1 lds
    s_add_u32 m0, s58, 1024
    s_add_u32 s65, s63, 345088
    buffer_load_dwordx4 v10, s[44:47], s65 offen sc1 lds
    s_add_u32 m0, s58, 2048
    s_add_u32 s65, s63, 346112
    buffer_load_dwordx4 v10, s[44:47], s65 offen sc1 lds
    s_add_u32 m0, s58, 3072
    s_add_u32 s65, s63, 347136
    buffer_load_dwordx4 v10, s[44:47], s65 offen sc1 lds
    s_waitcnt vmcnt(16)
    s_barrier
    s_add_u32 m0, s58, 8192
    s_add_u32 s65, s63, 360448
    buffer_load_dwordx4 v10, s[44:47], s65 offen sc1 lds
    s_add_u32 m0, s58, 9216
    s_add_u32 s65, s63, 361472
    buffer_load_dwordx4 v10, s[44:47], s65 offen sc1 lds
    s_add_u32 m0, s58, 10240
    s_add_u32 s65, s63, 362496
    buffer_load_dwordx4 v10, s[44:47], s65 offen sc1 lds
    s_add_u32 m0, s58, 11264
    s_add_u32 s65, s63, 363520
    buffer_load_dwordx4 v10, s[44:47], s65 offen sc1 lds
    s_waitcnt vmcnt(16)
    s_barrier
    s_add_u32 m0, s58, 16384
    s_add_u32 s65, s63, 376832
    buffer_load_dwordx4 v10, s[44:47], s65 offen sc1 lds
    s_add_u32 m0, s58, 17408
    s_add_u32 s65, s63, 377856
    buffer_load_dwordx4 v10, s[44:47], s65 offen sc1 lds
    s_add_u32 m0, s58, 18432
    s_add_u32 s65, s63, 378880
    buffer_load_dwordx4 v10, s[44:47], s65 offen sc1 lds
    s_add_u32 m0, s58, 19456
    s_add_u32 s65, s63, 379904
    buffer_load_dwordx4 v10, s[44:47], s65 offen sc1 lds
    s_waitcnt vmcnt(16)
    s_barrier
    s_lshl_b32 s75, 1342177280, s49
    s_mov_b32 s70, 400000
pp_46:
    s_and_b32 s71, s74, s75
    s_cmp_eq_u32 s71, s75
    s_cbranch_scc1 ppx_47
    buffer_load_dwordx2 v[34:35], v30, s[44:47], s66 offen sc1
    s_waitcnt vmcnt(0)
    v_cmp_eq_u64 vcc, v[34:35], v[28:29]
    s_nop 1
    s_mov_b32 s74, vcc_lo
    s_sub_u32 s70, s70, 1
    s_cmp_lg_u32 s70, 0
    s_cbranch_scc1 pp_46
ppx_47:
    buffer_load_dwordx2 v[32:33], v30, s[44:47], s64 offen sc1
    s_add_u32 m0, s58, 24576
    s_add_u32 s65, s63, 393216
    buffer_load_dwordx4 v10, s[44:47], s65 offen sc1 lds
    s_add_u32 m0, s58, 25600
    s_add_u32 s65, s63, 394240
    buffer_load_dwordx4 v10, s[44:47], s65 offen sc1 lds
    s_add_u32 m0, s58, 26624
    s_add_u32 s65, s63, 395264
    buffer_load_dwordx4 v10, s[44:47], s65 offen sc1 lds
    s_add_u32 m0, s58, 27648
    s_add_u32 s65, s63, 396288
    buffer_load_dwordx4 v10, s[44:47], s65 offen sc1 lds
    s_waitcnt vmcnt(17)
    s_barrier
    s_add_u32 m0, s58, 32768
    s_add_u32 s65, s63, 409600
    buffer_load_dwordx4 v10, s[44:47], s65 offen sc1 lds
    s_add_u32 m0, s58, 33792
    s_add_u32 s65, s63, 410624
    buffer_load_dwordx4 v10, s[44:47], s65 offen sc1 lds
    s_add_u32 m0, s58, 34816
    s_add_u32 s65, s63, 411648
    buffer_load_dwordx4 v10, s[44:47], s65 offen sc1 lds
    s_add_u32 m0, s58, 35840
    s_add_u32 s65, s63, 412672
    buffer_load_dwordx4 v10, s[44:47], s65 offen sc1 lds
    s_waitcnt vmcnt(17)
    s_barrier
    s_add_u32 m0, s58, 40960
    s_add_u32 s65, s63, 425984
    buffer_load_dwordx4 v10, s[44:47], s65 offen sc1 lds
    s_add_u32 m0, s58, 41984
    s_add_u32 s65, s63, 427008
    buffer_load_dwordx4 v10, s[44:47], s65 offen sc1 lds
    s_add_u32 m0, s58, 43008
    s_add_u32 s65, s63, 428032
    buffer_load_dwordx4 v10, s[44:47], s65 offen sc1 lds
    s_add_u32 m0, s58, 44032
    s_add_u32 s65, s63, 429056
    buffer_load_dwordx4 v10, s[44:47], s65 offen sc1 lds
    s_waitcnt vmcnt(17)
    s_barrier
    s_mov_b32 s70, 400000
    s_waitcnt vmcnt(12)
    s_branch spc_50
sp_48:
    buffer_load_dwordx2 v[32:33], v30, s[44:47], s64 offen sc1
    s_waitcnt vmcnt(0)
spc_50:
    v_cmp_ne_u64 vcc, v[32:33], v[28:29]
    s_nop 0
    s_cmp_eq_u64 vcc, 0
    s_cbranch_scc1 spx_49
    s_sleep 1
    s_sub_u32 s70, s70, 1
    s_cmp_lg_u32 s70, 0
    s_cbranch_scc1 sp_48
spx_49:
    s_add_u32 m0, s58, 49152
    s_add_u32 s65, s62, 0
    buffer_load_dwordx4 v10, s[44:47], s65 offen sc1 lds
    s_add_u32 m0, s58, 50176
    s_add_u32 s65, s62, 1024
    buffer_load_dwordx4 v10, s[44:47], s65 offen sc1 lds
    s_add_u32 m0, s58, 51200
    s_add_u32 s65, s62, 2048
    buffer_load_dwordx4 v10, s[44:47], s65 offen sc1 lds
    s_add_u32 m0, s58, 52224
    s_add_u32 s65, s62, 3072
    buffer_load_dwordx4 v10, s[44:47], s65 offen sc1 lds
    s_barrier
    s_add_u32 m0, s58, 0
    s_add_u32 s65, s62, 16384
    buffer_load_dwordx4 v10, s[44:47], s65 offen sc1 lds
    s_add_u32 m0, s58, 1024
    s_add_u32 s65, s62, 17408
    buffer_load_dwordx4 v10, s[44:47], s65 offen sc1 lds
    s_add_u32 m0, s58, 2048
    s_add_u32 s65, s62, 18432
    buffer_load_dwordx4 v10, s[44:47], s65 offen sc1 lds
    s_add_u32 m0, s58, 3072
    s_add_u32 s65, s62, 19456
    buffer_load_dwordx4 v10, s[44:47], s65 offen sc1 lds
    s_waitcnt vmcnt(16)
    s_barrier
    s_add_u32 m0, s58, 8192
    s_add_u32 s65, s62, 32768
    buffer_load_dwordx4 v10, s[44:47], s65 offen sc1 lds
    s_add_u32 m0, s58, 9216
    s_add_u32 s65, s62, 33792
    buffer_load_dwordx4 v10, s[44:47], s65 offen sc1 lds
    s_add_u32 m0, s58, 10240
    s_add_u32 s65, s62, 34816
    buffer_load_dwordx4 v10, s[44:47], s65 offen sc1 lds
    s_add_u32 m0, s58, 11264
    s_add_u32 s65, s62, 35840
    buffer_load_dwordx4 v10, s[44:47], s65 offen sc1 lds
    s_waitcnt vmcnt(16)
    s_barrier
    s_add_u32 m0, s58, 16384
    s_add_u32 s65, s62, 49152
    buffer_load_dwordx4 v10, s[44:47], s65 offen sc1 lds
    s_add_u32 m0, s58, 17408
    s_add_u32 s65, s62, 50176
    buffer_load_dwordx4 v10, s[44:47], s65 offen sc1 lds
    s_add_u32 m0, s58, 18432
    s_add_u32 s65, s62, 51200
    buffer_load_dwordx4 v10, s[44:47], s65 offen sc1 lds
    s_add_u32 m0, s58, 19456
    s_add_u32 s65, s62, 52224
    buffer_load_dwordx4 v10, s[44:47], s65 offen sc1 lds
    s_waitcnt vmcnt(16)
    s_barrier
    s_add_u32 m0, s58, 24576
    s_add_u32 s65, s62, 65536
    buffer_load_dwordx4 v10, s[44:47], s65 offen sc1 lds
    s_add_u32 m0, s58, 25600
    s_add_u32 s65, s62, 66560
    buffer_load_dwordx4 v10, s[44:47], s65 offen sc1 lds
    s_add_u32 m0, s58, 26624
    s_add_u32 s65, s62, 67584
    buffer_load_dwordx4 v10, s[44:47], s65 offen sc1 lds
    s_add_u32 m0, s58, 27648
    s_add_u32 s65, s62, 68608
    buffer_load_dwordx4 v10, s[44:47], s65 offen sc1 lds
    s_waitcnt vmcnt(16)
    s_barrier
    s_add_u32 m0, s58, 32768
    s_add_u32 s65, s62, 81920
    buffer_load_dwordx4 v10, s[44:47], s65 offen sc1 lds
    s_add_u32 m0, s58, 33792
    s_add_u32 s65, s62, 82944
    buffer_load_dwordx4 v10, s[44:47], s65 offen sc1 lds
    s_add_u32 m0, s58, 34816
    s_add_u32 s65, s62, 83968
    buffer_load_dwordx4 v10, s[44:47], s65 offen sc1 lds
    s_add_u32 m0, s58, 35840
    s_add_u32 s65, s62, 84992
    buffer_load_dwordx4 v10, s[44:47], s65 offen sc1 lds
    s_waitcnt vmcnt(16)
    s_barrier
    s_add_u32 m0, s58, 40960
    s_add_u32 s65, s62, 98304
    buffer_load_dwordx4 v10, s[44:47], s65 offen sc1 lds
    s_add_u32 m0, s58, 41984
    s_add_u32 s65, s62, 99328
    buffer_load_dwordx4 v10, s[44:47], s65 offen sc1 lds
    s_add_u32 m0, s58, 43008
    s_add_u32 s65, s62, 100352
    buffer_load_dwordx4 v10, s[44:47], s65 offen sc1 lds
    s_add_u32 m0, s58, 44032
    s_add_u32 s65, s62, 101376
    buffer_load_dwordx4 v10, s[44:47], s65 offen sc1 lds
    s_waitcnt vmcnt(16)
    s_barrier
    s_add_u32 m0, s58, 49152
    s_add_u32 s65, s62, 114688
    buffer_load_dwordx4 v10, s[44:47], s65 offen sc1 lds
    s_add_u32 m0, s58, 50176
    s_add_u32 s65, s62, 115712
    buffer_load_dwordx4 v10, s[44:47], s65 offen sc1 lds
    s_add_u32 m0, s58, 51200
    s_add_u32 s65, s62, 116736
    buffer_load_dwordx4 v10, s[44:47], s65 offen sc1 lds
    s_add_u32 m0, s58, 52224
    s_add_u32 s65, s62, 117760
    buffer_load_dwordx4 v10, s[44:47], s65 offen sc1 lds
    s_waitcnt vmcnt(16)
    s_barrier
    s_add_u32 m0, s58, 0
    s_add_u32 s65, s62, 131072
    buffer_load_dwordx4 v10, s[44:47], s65 offen sc1 lds
    s_add_u32 m0, s58, 1024
    s_add_u32 s65, s62, 132096
    buffer_load_dwordx4 v10, s[44:47], s65 offen sc1 lds
    s_add_u32 m0, s58, 2048
    s_add_u32 s65, s62, 133120
    buffer_load_dwordx4 v10, s[44:47], s65 offen sc1 lds
    s_add_u32 m0, s58, 3072
    s_add_u32 s65, s62, 134144
    buffer_load_dwordx4 v10, s[44:47], s65 offen sc1 lds
    s_waitcnt vmcnt(16)
    s_barrier
    s_add_u32 m0, s58, 8192
    s_add_u32 s65, s62, 147456
    buffer_load_dwordx4 v10, s[44:47], s65 offen sc1 lds
    s_add_u32 m0, s58, 9216
    s_add_u32 s65, s62, 148480
    buffer_load_dwordx4 v10, s[44:47], s65 offen sc1 lds
    s_add_u32 m0, s58, 10240
    s_add_u32 s65, s62, 149504
    buffer_load_dwordx4 v10, s[44:47], s65 offen sc1 lds
    s_add_u32 m0, s58, 11264
    s_add_u32 s65, s62, 150528
    buffer_load_dwordx4 v10, s[44:47], s65 offen sc1 lds
    s_waitcnt vmcnt(16)
    s_barrier
    s_add_u32 m0, s58, 16384
    s_add_u32 s65, s62, 163840
    buffer_load_dwordx4 v10, s[44:47], s65 offen sc1 lds
    s_add_u32 m0, s58, 17408
    s_add_u32 s65, s62, 164864
    buffer_load_dwordx4 v10, s[44:47], s65 offen sc1 lds
    s_add_u32 m0, s58, 18432
    s_add_u32 s65, s62, 165888
    buffer_load_dwordx4 v10, s[44:47], s65 offen sc1 lds
    s_add_u32 m0, s58, 19456
    s_add_u32 s65, s62, 166912
    buffer_load_dwordx4 v10, s[44:47], s65 offen sc1 lds
    s_waitcnt vmcnt(16)
    s_barrier
    s_add_u32 m0, s58, 24576
    s_add_u32 s65, s62, 180224
    buffer_load_dwordx4 v10, s[44:47], s65 offen sc1 lds
    s_add_u32 m0, s58, 25600
    s_add_u32 s65, s62, 181248
    buffer_load_dwordx4 v10, s[44:47], s65 offen sc1 lds
    s_add_u32 m0, s58, 26624
    s_add_u32 s65, s62, 182272
    buffer_load_dwordx4 v10, s[44:47], s65 offen sc1 lds
    s_add_u32 m0, s58, 27648
    s_add_u32 s65, s62, 183296
    buffer_load_dwordx4 v10, s[44:47], s65 offen sc1 lds
    s_waitcnt vmcnt(16)
    s_barrier
    s_add_u32 m0, s58, 32768
    s_add_u32 s65, s62, 196608
    buffer_load_dwordx4 v10, s[44:47], s65 offen sc1 lds
    s_add_u32 m0, s58, 33792
    s_add_u32 s65, s62, 197632
    buffer_load_dwordx4 v10, s[44:47], s65 offen sc1 lds
    s_add_u32 m0, s58, 34816
    s_add_u32 s65, s62, 198656
    buffer_load_dwordx4 v10, s[44:47], s65 offen sc1 lds
    s_add_u32 m0, s58, 35840
    s_add_u32 s65, s62, 199680
    buffer_load_dwordx4 v10, s[44:47], s65 offen sc1 lds
    s_waitcnt vmcnt(16)
    s_barrier
    s_add_u32 m0, s58, 40960
    s_add_u32 s65, s62, 212992
    buffer_load_dwordx4 v10, s[44:47], s65 offen sc1 lds
    s_add_u32 m0, s58, 41984
    s_add_u32 s65, s62, 214016
    buffer_load_dwordx4 v10, s[44:47], s65 offen sc1 lds
    s_add_u32 m0, s58, 43008
    s_add_u32 s65, s62, 215040
    buffer_load_dwordx4 v10, s[44:47], s65 offen sc1 lds
    s_add_u32 m0, s58, 44032
    s_add_u32 s65, s62, 216064
    buffer_load_dwordx4 v10, s[44:47], s65 offen sc1 lds
    s_waitcnt vmcnt(16)
    s_barrier
    s_add_u32 m0, s58, 49152
    s_add_u32 s65, s62, 229376
    buffer_load_dwordx4 v10, s[44:47], s65 offen sc1 lds
    s_add_u32 m0, s58, 50176
    s_add_u32 s65, s62, 230400
    buffer_load_dwordx4 v10, s[44:47], s65 offen sc1 lds
    s_add_u32 m0, s58, 51200
    s_add_u32 s65, s62, 231424
    buffer_load_dwordx4 v10, s[44:47], s65 offen sc1 lds
    s_add_u32 m0, s58, 52224
    s_add_u32 s65, s62, 232448
    buffer_load_dwordx4 v10, s[44:47], s65 offen sc1 lds
    s_waitcnt vmcnt(16)
    s_barrier
    s_add_u32 m0, s58, 0
    s_add_u32 s65, s62, 245760
    buffer_load_dwordx4 v10, s[44:47], s65 offen sc1 lds
    s_add_u32 m0, s58, 1024
    s_add_u32 s65, s62, 246784
    buffer_load_dwordx4 v10, s[44:47], s65 offen sc1 lds
    s_add_u32 m0, s58, 2048
    s_add_u32 s65, s62, 247808
    buffer_load_dwordx4 v10, s[44:47], s65 offen sc1 lds
    s_add_u32 m0, s58, 3072
    s_add_u32 s65, s62, 248832
    buffer_load_dwordx4 v10, s[44:47], s65 offen sc1 lds
    s_waitcnt vmcnt(16)
    s_barrier
    s_add_u32 m0, s58, 8192
    s_add_u32 s65, s62, 262144
    buffer_load_dwordx4 v10, s[44:47], s65 offen sc1 lds
    s_add_u32 m0, s58, 9216
    s_add_u32 s65, s62, 263168
    buffer_load_dwordx4 v10, s[44:47], s65 offen sc1 lds
    s_add_u32 m0, s58, 10240
    s_add_u32 s65, s62, 264192
    buffer_load_dwordx4 v10, s[44:47], s65 offen sc1 lds
    s_add_u32 m0, s58, 11264
    s_add_u32 s65, s62, 265216
    buffer_load_dwordx4 v10, s[44:47], s65 offen sc1 lds
    s_waitcnt vmcnt(16)
    s_barrier
    s_add_u32 m0, s58, 16384
    s_add_u32 s65, s62, 278528
    buffer_load_dwordx4 v10, s[44:47], s65 offen sc1 lds
    s_add_u32 m0, s58, 17408
    s_add_u32 s65, s62, 279552
    buffer_load_dwordx4 v10, s[44:47], s65 offen sc1 lds
    s_add_u32 m0, s58, 18432
    s_add_u32 s65, s62, 280576
    buffer_load_dwordx4 v10, s[44:47], s65 offen sc1 lds
    s_add_u32 m0, s58, 19456
    s_add_u32 s65, s62, 281600
    buffer_load_dwordx4 v10, s[44:47], s65 offen sc1 lds
    s_waitcnt vmcnt(16)
    s_barrier
    s_add_u32 m0, s58, 24576
    s_add_u32 s65, s62, 294912
    buffer_load_dwordx4 v10, s[44:47], s65 offen sc1 lds
    s_add_u32 m0, s58, 25600
    s_add_u32 s65, s62, 295936
    buffer_load_dwordx4 v10, s[44:47], s65 offen sc1 lds
    s_add_u32 m0, s58, 26624
    s_add_u32 s65, s62, 296960
    buffer_load_dwordx4 v10, s[44:47], s65 offen sc1 lds
    s_add_u32 m0, s58, 27648
    s_add_u32 s65, s62, 297984
    buffer_load_dwordx4 v10, s[44:47], s65 offen sc1 lds
    s_waitcnt vmcnt(16)
    s_barrier
    s_add_u32 m0, s58, 32768
    s_add_u32 s65, s62, 311296
    buffer_load_dwordx4 v10, s[44:47], s65 offen sc1 lds
    s_add_u32 m0, s58, 33792
    s_add_u32 s65, s62, 312320
    buffer_load_dwordx4 v10, s[44:47], s65 offen sc1 lds
    s_add_u32 m0, s58, 34816
    s_add_u32 s65, s62, 313344
    buffer_load_dwordx4 v10, s[44:47], s65 offen sc1 lds
    s_add_u32 m0, s58, 35840
    s_add_u32 s65, s62, 314368
    buffer_load_dwordx4 v10, s[44:47], s65 offen sc1 lds
    s_waitcnt vmcnt(16)
    s_barrier
    s_waitcnt vmcnt(12)
    s_barrier
    s_waitcnt vmcnt(8)
    s_barrier
    s_waitcnt vmcnt(4)
    s_barrier
    s_waitcnt vmcnt(0)
    s_barrier
    s_branch k1_end
p2_lA:
    v_lshlrev_b32 v30, 4, v0
    v_add_u32 v30, 589824, v30
    v_add_u32 v31, 4096, v30
    s_cmp_lg_u32 s78, 0
    s_cbranch_scc1 nox_51
    s_barrier
    s_mov_b32 s70, 2
sp_54:
    buffer_load_dwordx4 v[32:35], v30, s[44:47], 0 offen offset:0 sc1
    buffer_load_dwordx4 v[36:39], v30, s[44:47], 0 offen offset:1024 sc1
    buffer_load_dwordx4 v[40:43], v30, s[44:47], 0 offen offset:2048 sc1
    buffer_load_dwordx4 v[44:47], v30, s[44:47], 0 offen offset:3072 sc1
    s_waitcnt vmcnt(0)
spc_56:
    v_cmp_ne_u64 vcc, v[32:33], v[28:29]
    v_cmp_ne_u64 s[72:73], v[34:35], v[28:29]
    s_nop 0
    s_or_b64 vcc, vcc, s[72:73]
    v_cmp_ne_u64 s[72:73], v[36:37], v[28:29]
    s_nop 0
    s_or_b64 vcc, vcc, s[72:73]
    v_cmp_ne_u64 s[72:73], v[38:39], v[28:29]
    s_nop 0
    s_or_b64 vcc, vcc, s[72:73]
    v_cmp_ne_u64 s[72:73], v[40:41], v[28:29]
    s_nop 0
    s_or_b64 vcc, vcc, s[72:73]
    v_cmp_ne_u64 s[72:73], v[42:43], v[28:29]
    s_nop 0
    s_or_b64 vcc, vcc, s[72:73]
    v_cmp_ne_u64 s[72:73], v[44:45], v[28:29]
    s_nop 0
    s_or_b64 vcc, vcc, s[72:73]
    v_cmp_ne_u64 s[72:73], v[46:47], v[28:29]
    s_nop 0
    s_or_b64 vcc, vcc, s[72:73]
    s_cmp_eq_u64 vcc, 0
    s_cbranch_scc1 spx_55
    s_sleep 1
    s_sub_u32 s70, s70, 1
    s_cmp_lg_u32 s70, 0
    s_cbranch_scc1 sp_54
spx_55:
    s_cmp_eq_u32 s70, 0
    s_cbranch_scc1 late_52
    s_add_u32 m0, s58, 0
    s_add_u32 s65, s63, 0
    buffer_load_dwordx4 v10, s[44:47], s65 offen sc1 lds
    s_add_u32 m0, s58, 1024
    s_add_u32 s65, s63, 1024
    buffer_load_dwordx4 v10, s[44:47], s65 offen sc1 lds
    s_add_u32 m0, s58, 2048
    s_add_u32 s65, s63, 2048
    buffer_load_dwordx4 v10, s[44:47], s65 offen sc1 lds
    s_add_u32 m0, s58, 3072
    s_add_u32 s65, s63, 3072
    buffer_load_dwordx4 v10, s[44:47], s65 offen sc1 lds
    s_add_u32 m0, s58, 4096
    s_add_u32 s65, s63, 4096
    buffer_load_dwordx4 v10, s[44:47], s65 offen sc1 lds
    s_add_u32 m0, s58, 10240
    s_add_u32 s65, s63, 10240
    buffer_load_dwordx4 v10, s[44:47], s65 offen sc1 lds
    s_add_u32 m0, s58, 11264
    s_add_u32 s65, s63, 11264
    buffer_load_dwordx4 v10, s[44:47], s65 offen sc1 lds
    s_add_u32 m0, s58, 12288
    s_add_u32 s65, s63, 12288
    buffer_load_dwordx4 v10, s[44:47], s65 offen sc1 lds
    s_add_u32 m0, s58, 13312
    s_add_u32 s65, s63, 13312
    buffer_load_dwordx4 v10, s[44:47], s65 offen sc1 lds
    s_add_u32 m0, s58, 14336
    s_add_u32 s65, s63, 14336
    buffer_load_dwordx4 v10, s[44:47], s65 offen sc1 lds
    s_add_u32 m0, s58, 20480
    s_add_u32 s65, s63, 20480
    buffer_load_dwordx4 v10, s[44:47], s65 offen sc1 lds
    s_add_u32 m0, s58, 21504
    s_add_u32 s65, s63, 21504
    buffer_load_dwordx4 v10, s[44:47], s65 offen sc1 lds
    s_add_u32 m0, s58, 22528
    s_add_u32 s65, s63, 22528
    buffer_load_dwordx4 v10, s[44:47], s65 offen sc1 lds
    s_add_u32 m0, s58, 23552
    s_add_u32 s65, s63, 23552
    buffer_load_dwordx4 v10, s[44:47], s65 offen sc1 lds
    s_add_u32 m0, s58, 24576
    s_add_u32 s65, s63, 24576
    buffer_load_dwordx4 v10, s[44:47], s65 offen sc1 lds
    s_add_u32 m0, s58, 30720
    s_add_u32 s65, s63, 30720
    buffer_load_dwordx4 v10, s[44:47], s65 offen sc1 lds
    s_add_u32 m0, s58, 31744
    s_add_u32 s65, s63, 31744
    buffer_load_dwordx4 v10, s[44:47], s65 offen sc1 lds
    s_add_u32 m0, s58, 32768
    s_add_u32 s65, s63, 32768
    buffer_load_dwordx4 v10, s[44:47], s65 offen sc1 lds
    s_add_u32 m0, s58, 33792
    s_add_u32 s65, s63, 33792
    buffer_load_dwordx4 v10, s[44:47], s65 offen sc1 lds
    s_add_u32 m0, s58, 34816
    s_add_u32 s65, s63, 34816
    buffer_load_dwordx4 v10, s[44:47], s65 offen sc1 lds
    s_add_u32 m0, s58, 40960
    s_add_u32 s65, s63, 40960
    buffer_load_dwordx4 v10, s[44:47], s65 offen sc1 lds
    s_add_u32 m0, s58, 41984
    s_add_u32 s65, s63, 41984
    buffer_load_dwordx4 v10, s[44:47], s65 offen sc1 lds
    s_add_u32 m0, s58, 43008
    s_add_u32 s65, s63, 43008
    buffer_load_dwordx4 v10, s[44:47], s65 offen sc1 lds
    s_add_u32 m0, s58, 44032
    s_add_u32 s65, s63, 44032
    buffer_load_dwordx4 v10, s[44:47], s65 offen sc1 lds
    s_add_u32 m0, s58, 45056
    s_add_u32 s65, s63, 45056
    buffer_load_dwordx4 v10, s[44:47], s65 offen sc1 lds
    s_add_u32 m0, s58, 51200
    s_add_u32 s65, s63, 51200
    buffer_load_dwordx4 v10, s[44:47], s65 offen sc1 lds
    s_add_u32 m0, s58, 52224
    s_add_u32 s65, s63, 52224
    buffer_load_dwordx4 v10, s[44:47], s65 offen sc1 lds
    s_add_u32 m0, s58, 53248
    s_add_u32 s65, s63, 53248
    buffer_load_dwordx4 v10, s[44:47], s65 offen sc1 lds
    s_add_u32 m0, s58, 54272
    s_add_u32 s65, s63, 54272
    buffer_load_dwordx4 v10, s[44:47], s65 offen sc1 lds
    s_add_u32 m0, s58, 55296
    s_add_u32 s65, s63, 55296
    buffer_load_dwordx4 v10, s[44:47], s65 offen sc1 lds
    s_add_u32 m0, s58, 61440
    s_add_u32 s65, s63, 61440
    buffer_load_dwordx4 v10, s[44:47], s65 offen sc1 lds
    s_add_u32 m0, s58, 62464
    s_add_u32 s65, s63, 62464
    buffer_load_dwordx4 v10, s[44:47], s65 offen sc1 lds
    s_add_u32 m0, s58, 63488
    s_add_u32 s65, s63, 63488
    buffer_load_dwordx4 v10, s[44:47], s65 offen sc1 lds
    s_add_u32 m0, s58, 64512
    s_add_u32 s65, s63, 64512
    buffer_load_dwordx4 v10, s[44:47], s65 offen sc1 lds
    s_add_u32 m0, s58, 65536
    s_add_u32 s65, s63, 65536
    buffer_load_dwordx4 v10, s[44:47], s65 offen sc1 lds
    s_barrier
    s_branch done_53
late_52:
    s_barrier
nox_51:
    s_mov_b32 s70, 400000
sp_57:
    buffer_load_dwordx4 v[32:35], v30, s[44:47], 0 offen offset:0 sc1
    buffer_load_dwordx4 v[36:39], v30, s[44:47], 0 offen offset:1024 sc1
    buffer_load_dwordx4 v[40:43], v30, s[44:47], 0 offen offset:2048 sc1
    buffer_load_dwordx4 v[44:47], v30, s[44:47], 0 offen offset:3072 sc1
    s_waitcnt vmcnt(0)
spc_59:
    v_cmp_ne_u64 vcc, v[32:33], v[28:29]
    v_cmp_ne_u64 s[72:73], v[34:35], v[28:29]
    s_nop 0
    s_or_b64 vcc, vcc, s[72:73]
    v_cmp_ne_u64 s[72:73], v[36:37], v[28:29]
    s_nop 0
    s_or_b64 vcc, vcc, s[72:73]
    v_cmp_ne_u64 s[72:73], v[38:39], v[28:29]
    s_nop 0
    s_or_b64 vcc, vcc, s[72:73]
    v_cmp_ne_u64 s[72:73], v[40:41], v[28:29]
    s_nop 0
    s_or_b64 vcc, vcc, s[72:73]
    v_cmp_ne_u64 s[72:73], v[42:43], v[28:29]
    s_nop 0
    s_or_b64 vcc, vcc, s[72:73]
    v_cmp_ne_u64 s[72:73], v[44:45], v[28:29]
    s_nop 0
    s_or_b64 vcc, vcc, s[72:73]
    v_cmp_ne_u64 s[72:73], v[46:47], v[28:29]
    s_nop 0
    s_or_b64 vcc, vcc, s[72:73]
    s_cmp_eq_u64 vcc, 0
    s_cbranch_scc1 spx_58
    s_sleep 1
    s_sub_u32 s70, s70, 1
    s_cmp_lg_u32 s70, 0
    s_cbranch_scc1 sp_57
spx_58:
    s_add_u32 m0, s58, 0
    s_add_u32 s65, s63, 0
    buffer_load_dwordx4 v10, s[44:47], s65 offen sc1 lds
    s_add_u32 m0, s58, 1024
    s_add_u32 s65, s63, 1024
    buffer_load_dwordx4 v10, s[44:47], s65 offen sc1 lds
    s_add_u32 m0, s58, 2048
    s_add_u32 s65, s63, 2048
    buffer_load_dwordx4 v10, s[44:47], s65 offen sc1 lds
    s_add_u32 m0, s58, 3072
    s_add_u32 s65, s63, 3072
    buffer_load_dwordx4 v10, s[44:47], s65 offen sc1 lds
    s_add_u32 m0, s58, 4096
    s_add_u32 s65, s63, 4096
    buffer_load_dwordx4 v10, s[44:47], s65 offen sc1 lds
    s_add_u32 m0, s58, 10240
    s_add_u32 s65, s63, 10240
    buffer_load_dwordx4 v10, s[44:47], s65 offen sc1 lds
    s_add_u32 m0, s58, 11264
    s_add_u32 s65, s63, 11264
    buffer_load_dwordx4 v10, s[44:47], s65 offen sc1 lds
    s_add_u32 m0, s58, 12288
    s_add_u32 s65, s63, 12288
    buffer_load_dwordx4 v10, s[44:47], s65 offen sc1 lds
    s_add_u32 m0, s58, 13312
    s_add_u32 s65, s63, 13312
    buffer_load_dwordx4 v10, s[44:47], s65 offen sc1 lds
    s_add_u32 m0, s58, 14336
    s_add_u32 s65, s63, 14336
    buffer_load_dwordx4 v10, s[44:47], s65 offen sc1 lds
    s_add_u32 m0, s58, 20480
    s_add_u32 s65, s63, 20480
    buffer_load_dwordx4 v10, s[44:47], s65 offen sc1 lds
    s_add_u32 m0, s58, 21504
    s_add_u32 s65, s63, 21504
    buffer_load_dwordx4 v10, s[44:47], s65 offen sc1 lds
    s_add_u32 m0, s58, 22528
    s_add_u32 s65, s63, 22528
    buffer_load_dwordx4 v10, s[44:47], s65 offen sc1 lds
    s_add_u32 m0, s58, 23552
    s_add_u32 s65, s63, 23552
    buffer_load_dwordx4 v10, s[44:47], s65 offen sc1 lds
    s_add_u32 m0, s58, 24576
    s_add_u32 s65, s63, 24576
    buffer_load_dwordx4 v10, s[44:47], s65 offen sc1 lds
    s_add_u32 m0, s58, 30720
    s_add_u32 s65, s63, 30720
    buffer_load_dwordx4 v10, s[44:47], s65 offen sc1 lds
    s_add_u32 m0, s58, 31744
    s_add_u32 s65, s63, 31744
    buffer_load_dwordx4 v10, s[44:47], s65 offen sc1 lds
    s_add_u32 m0, s58, 32768
    s_add_u32 s65, s63, 32768
    buffer_load_dwordx4 v10, s[44:47], s65 offen sc1 lds
    s_add_u32 m0, s58, 33792
    s_add_u32 s65, s63, 33792
    buffer_load_dwordx4 v10, s[44:47], s65 offen sc1 lds
    s_add_u32 m0, s58, 34816
    s_add_u32 s65, s63, 34816
    buffer_load_dwordx4 v10, s[44:47], s65 offen sc1 lds
    s_add_u32 m0, s58, 40960
    s_add_u32 s65, s63, 40960
    buffer_load_dwordx4 v10, s[44:47], s65 offen sc1 lds
    s_add_u32 m0, s58, 41984
    s_add_u32 s65, s63, 41984
    buffer_load_dwordx4 v10, s[44:47], s65 offen sc1 lds
    s_add_u32 m0, s58, 43008
    s_add_u32 s65, s63, 43008
    buffer_load_dwordx4 v10, s[44:47], s65 offen sc1 lds
    s_add_u32 m0, s58, 44032
    s_add_u32 s65, s63, 44032
    buffer_load_dwordx4 v10, s[44:47], s65 offen sc1 lds
    s_add_u32 m0, s58, 45056
    s_add_u32 s65, s63, 45056
    buffer_load_dwordx4 v10, s[44:47], s65 offen sc1 lds
    s_add_u32 m0, s58, 51200
    s_add_u32 s65, s63, 51200
    buffer_load_dwordx4 v10, s[44:47], s65 offen sc1 lds
    s_add_u32 m0, s58, 52224
    s_add_u32 s65, s63, 52224
    buffer_load_dwordx4 v10, s[44:47], s65 offen sc1 lds
    s_add_u32 m0, s58, 53248
    s_add_u32 s65, s63, 53248
    buffer_load_dwordx4 v10, s[44:47], s65 offen sc1 lds
    s_add_u32 m0, s58, 54272
    s_add_u32 s65, s63, 54272
    buffer_load_dwordx4 v10, s[44:47], s65 offen sc1 lds
    s_add_u32 m0, s58, 55296
    s_add_u32 s65, s63, 55296
    buffer_load_dwordx4 v10, s[44:47], s65 offen sc1 lds
    s_add_u32 m0, s58, 61440
    s_add_u32 s65, s63, 61440
    buffer_load_dwordx4 v10, s[44:47], s65 offen sc1 lds
    s_add_u32 m0, s58, 62464
    s_add_u32 s65, s63, 62464
    buffer_load_dwordx4 v10, s[44:47], s65 offen sc1 lds
    s_add_u32 m0, s58, 63488
    s_add_u32 s65, s63, 63488
    buffer_load_dwordx4 v10, s[44:47], s65 offen sc1 lds
    s_add_u32 m0, s58, 64512
    s_add_u32 s65, s63, 64512
    buffer_load_dwordx4 v10, s[44:47], s65 offen sc1 lds
    s_add_u32 m0, s58, 65536
    s_add_u32 s65, s63, 65536
    buffer_load_dwordx4 v10, s[44:47], s65 offen sc1 lds
done_53:
    s_waitcnt vmcnt(30)
    s_barrier
    s_waitcnt vmcnt(25)
    s_barrier
    s_waitcnt vmcnt(20)
    s_barrier
    s_add_u32 m0, s58, 0
    s_add_u32 s65, s63, 71680
    buffer_load_dwordx4 v10, s[44:47], s65 offen sc1 lds
    s_add_u32 m0, s58, 1024
    s_add_u32 s65, s63, 72704
    buffer_load_dwordx4 v10, s[44:47], s65 offen sc1 lds
    s_add_u32 m0, s58, 2048
    s_add_u32 s65, s63, 73728
    buffer_load_dwordx4 v10, s[44:47], s65 offen sc1 lds
    s_add_u32 m0, s58, 3072
    s_add_u32 s65, s63, 74752
    buffer_load_dwordx4 v10, s[44:47], s65 offen sc1 lds
    s_add_u32 m0, s58, 4096
    s_add_u32 s65, s63, 75776
    buffer_load_dwordx4 v10, s[44:47], s65 offen sc1 lds
    s_waitcnt vmcnt(20)
    s_barrier
    s_add_u32 m0, s58, 10240
    s_add_u32 s65, s63, 81920
    buffer_load_dwordx4 v10, s[44:47], s65 offen sc1 lds
    s_add_u32 m0, s58, 11264
    s_add_u32 s65, s63, 82944
    buffer_load_dwordx4 v10, s[44:47], s65 offen sc1 lds
    s_add_u32 m0, s58, 12288
    s_add_u32 s65, s63, 83968
    buffer_load_dwordx4 v10, s[44:47], s65 offen sc1 lds
    s_add_u32 m0, s58, 13312
    s_add_u32 s65, s63, 84992
    buffer_load_dwordx4 v10, s[44:47], s65 offen sc1 lds
    s_add_u32 m0, s58, 14336
    s_add_u32 s65, s63, 86016
    buffer_load_dwordx4 v10, s[44:47], s65 offen sc1 lds
    s_waitcnt vmcnt(20)
    s_barrier
    s_add_u32 m0, s58, 20480
    s_add_u32 s65, s63, 92160
    buffer_load_dwordx4 v10, s[44:47], s65 offen sc1 lds
    s_add_u32 m0, s58, 21504
    s_add_u32 s65, s63, 93184
    buffer_load_dwordx4 v10, s[44:47], s65 offen sc1 lds
    s_add_u32 m0, s58, 22528
    s_add_u32 s65, s63, 94208
    buffer_load_dwordx4 v10, s[44:47], s65 offen sc1 lds
    s_add_u32 m0, s58, 23552
    s_add_u32 s65, s63, 95232
    buffer_load_dwordx4 v10, s[44:47], s65 offen sc1 lds
    s_add_u32 m0, s58, 24576
    s_add_u32 s65, s63, 96256
    buffer_load_dwordx4 v10, s[44:47], s65 offen sc1 lds
    s_waitcnt vmcnt(20)
    s_barrier
    s_add_u32 m0, s58, 30720
    s_add_u32 s65, s63, 102400
    buffer_load_dwordx4 v10, s[44:47], s65 offen sc1 lds
    s_add_u32 m0, s58, 31744
    s_add_u32 s65, s63, 103424
    buffer_load_dwordx4 v10, s[44:47], s65 offen sc1 lds
    s_add_u32 m0, s58, 32768
    s_add_u32 s65, s63, 104448
    buffer_load_dwordx4 v10, s[44:47], s65 offen sc1 lds
    s_add_u32 m0, s58, 33792
    s_add_u32 s65, s63, 105472
    buffer_load_dwordx4 v10, s[44:47], s65 offen sc1 lds
    s_add_u32 m0, s58, 34816
    s_add_u32 s65, s63, 106496
    buffer_load_dwordx4 v10, s[44:47], s65 offen sc1 lds
    s_waitcnt vmcnt(20)
    s_barrier
    s_add_u32 m0, s58, 40960
    s_add_u32 s65, s63, 112640
    buffer_load_dwordx4 v10, s[44:47], s65 offen sc1 lds
    s_add_u32 m0, s58, 41984
    s_add_u32 s65, s63, 113664
    buffer_load_dwordx4 v10, s[44:47], s65 offen sc1 lds
    s_add_u32 m0, s58, 43008
    s_add_u32 s65, s63, 114688
    buffer_load_dwordx4 v10, s[44:47], s65 offen sc1 lds
    s_add_u32 m0, s58, 44032
    s_add_u32 s65, s63, 115712
    buffer_load_dwordx4 v10, s[44:47], s65 offen sc1 lds
    s_add_u32 m0, s58, 45056
    s_add_u32 s65, s63, 116736
    buffer_load_dwordx4 v10, s[44:47], s65 offen sc1 lds
    s_waitcnt vmcnt(20)
    s_barrier
    s_add_u32 m0, s58, 51200
    s_add_u32 s65, s63, 122880
    buffer_load_dwordx4 v10, s[44:47], s65 offen sc1 lds
    s_add_u32 m0, s58, 52224
    s_add_u32 s65, s63, 123904
    buffer_load_dwordx4 v10, s[44:47], s65 offen sc1 lds
    s_add_u32 m0, s58, 53248
    s_add_u32 s65, s63, 124928
    buffer_load_dwordx4 v10, s[44:47], s65 offen sc1 lds
    s_add_u32 m0, s58, 54272
    s_add_u32 s65, s63, 125952
    buffer_load_dwordx4 v10, s[44:47], s65 offen sc1 lds
    s_add_u32 m0, s58, 55296
    s_add_u32 s65, s63, 126976
    buffer_load_dwordx4 v10, s[44:47], s65 offen sc1 lds
    s_waitcnt vmcnt(20)
    s_barrier
    s_add_u32 m0, s58, 61440
    s_add_u32 s65, s63, 133120
    buffer_load_dwordx4 v10, s[44:47], s65 offen sc1 lds
    s_add_u32 m0, s58, 62464
    s_add_u32 s65, s63, 134144
    buffer_load_dwordx4 v10, s[44:47], s65 offen sc1 lds
    s_add_u32 m0, s58, 63488
    s_add_u32 s65, s63, 135168
    buffer_load_dwordx4 v10, s[44:47], s65 offen sc1 lds
    s_add_u32 m0, s58, 64512
    s_add_u32 s65, s63, 136192
    buffer_load_dwordx4 v10, s[44:47], s65 offen sc1 lds
    s_add_u32 m0, s58, 65536
    s_add_u32 s65, s63, 137216
    buffer_load_dwordx4 v10, s[44:47], s65 offen sc1 lds
    s_waitcnt vmcnt(20)
    s_barrier
    s_add_u32 m0, s58, 0
    s_add_u32 s65, s63, 143360
    buffer_load_dwordx4 v10, s[44:47], s65 offen sc1 lds
    s_add_u32 m0, s58, 1024
    s_add_u32 s65, s63, 144384
    buffer_load_dwordx4 v10, s[44:47], s65 offen sc1 lds
    s_add_u32 m0, s58, 2048
    s_add_u32 s65, s63, 145408
    buffer_load_dwordx4 v10, s[44:47], s65 offen sc1 lds
    s_add_u32 m0, s58, 3072
    s_add_u32 s65, s63, 146432
    buffer_load_dwordx4 v10, s[44:47], s65 offen sc1 lds
    s_add_u32 m0, s58, 4096
    s_add_u32 s65, s63, 147456
    buffer_load_dwordx4 v10, s[44:47], s65 offen sc1 lds
    s_waitcnt vmcnt(20)
    s_barrier
    s_add_u32 m0, s58, 10240
    s_add_u32 s65, s63, 153600
    buffer_load_dwordx4 v10, s[44:47], s65 offen sc1 lds
    s_add_u32 m0, s58, 11264
    s_add_u32 s65, s63, 154624
    buffer_load_dwordx4 v10, s[44:47], s65 offen sc1 lds
    s_add_u32 m0, s58, 12288
    s_add_u32 s65, s63, 155648
    buffer_load_dwordx4 v10, s[44:47], s65 offen sc1 lds
    s_add_u32 m0, s58, 13312
    s_add_u32 s65, s63, 156672
    buffer_load_dwordx4 v10, s[44:47], s65 offen sc1 lds
    s_add_u32 m0, s58, 14336
    s_add_u32 s65, s63, 157696
    buffer_load_dwordx4 v10, s[44:47], s65 offen sc1 lds
    s_waitcnt vmcnt(20)
    s_barrier
    s_add_u32 m0, s58, 20480
    s_add_u32 s65, s63, 163840
    buffer_load_dwordx4 v10, s[44:47], s65 offen sc1 lds
    s_add_u32 m0, s58, 21504
    s_add_u32 s65, s63, 164864
    buffer_load_dwordx4 v10, s[44:47], s65 offen sc1 lds
    s_add_u32 m0, s58, 22528
    s_add_u32 s65, s63, 165888
    buffer_load_dwordx4 v10, s[44:47], s65 offen sc1 lds
    s_add_u32 m0, s58, 23552
    s_add_u32 s65, s63, 166912
    buffer_load_dwordx4 v10, s[44:47], s65 offen sc1 lds
    s_add_u32 m0, s58, 24576
    s_add_u32 s65, s63, 167936
    buffer_load_dwordx4 v10, s[44:47], s65 offen sc1 lds
    s_waitcnt vmcnt(20)
    s_barrier
    s_add_u32 m0, s58, 30720
    s_add_u32 s65, s63, 174080
    buffer_load_dwordx4 v10, s[44:47], s65 offen sc1 lds
    s_add_u32 m0, s58, 31744
    s_add_u32 s65, s63, 175104
    buffer_load_dwordx4 v10, s[44:47], s65 offen sc1 lds
    s_add_u32 m0, s58, 32768
    s_add_u32 s65, s63, 176128
    buffer_load_dwordx4 v10, s[44:47], s65 offen sc1 lds
    s_add_u32 m0, s58, 33792
    s_add_u32 s65, s63, 177152
    buffer_load_dwordx4 v10, s[44:47], s65 offen sc1 lds
    s_add_u32 m0, s58, 34816
    s_add_u32 s65, s63, 178176
    buffer_load_dwordx4 v10, s[44:47], s65 offen sc1 lds
    s_waitcnt vmcnt(20)
    s_barrier
    s_add_u32 m0, s58, 40960
    s_add_u32 s65, s63, 184320
    buffer_load_dwordx4 v10, s[44:47], s65 offen sc1 lds
    s_add_u32 m0, s58, 41984
    s_add_u32 s65, s63, 185344
    buffer_load_dwordx4 v10, s[44:47], s65 offen sc1 lds
    s_add_u32 m0, s58, 43008
    s_add_u32 s65, s63, 186368
    buffer_load_dwordx4 v10, s[44:47], s65 offen sc1 lds
    s_add_u32 m0, s58, 44032
    s_add_u32 s65, s63, 187392
    buffer_load_dwordx4 v10, s[44:47], s65 offen sc1 lds
    s_add_u32 m0, s58, 45056
    s_add_u32 s65, s63, 188416
    buffer_load_dwordx4 v10, s[44:47], s65 offen sc1 lds
    s_waitcnt vmcnt(20)
    s_barrier
    s_add_u32 m0, s58, 51200
    s_add_u32 s65, s63, 194560
    buffer_load_dwordx4 v10, s[44:47], s65 offen sc1 lds
    s_add_u32 m0, s58, 52224
    s_add_u32 s65, s63, 195584
    buffer_load_dwordx4 v10, s[44:47], s65 offen sc1 lds
    s_add_u32 m0, s58, 53248
    s_add_u32 s65, s63, 196608
    buffer_load_dwordx4 v10, s[44:47], s65 offen sc1 lds
    s_add_u32 m0, s58, 54272
    s_add_u32 s65, s63, 197632
    buffer_load_dwordx4 v10, s[44:47], s65 offen sc1 lds
    s_add_u32 m0, s58, 55296
    s_add_u32 s65, s63, 198656
    buffer_load_dwordx4 v10, s[44:47], s65 offen sc1 lds
    s_waitcnt vmcnt(20)
    s_barrier
    s_add_u32 m0, s58, 61440
    s_add_u32 s65, s63, 204800
    buffer_load_dwordx4 v10, s[44:47], s65 offen sc1 lds
    s_add_u32 m0, s58, 62464
    s_add_u32 s65, s63, 205824
    buffer_load_dwordx4 v10, s[44:47], s65 offen sc1 lds
    s_add_u32 m0, s58, 63488
    s_add_u32 s65, s63, 206848
    buffer_load_dwordx4 v10, s[44:47], s65 offen sc1 lds
    s_add_u32 m0, s58, 64512
    s_add_u32 s65, s63, 207872
    buffer_load_dwordx4 v10, s[44:47], s65 offen sc1 lds
    s_add_u32 m0, s58, 65536
    s_add_u32 s65, s63, 208896
    buffer_load_dwordx4 v10, s[44:47], s65 offen sc1 lds
    s_waitcnt vmcnt(20)
    s_barrier
    s_add_u32 m0, s58, 0
    s_add_u32 s65, s63, 215040
    buffer_load_dwordx4 v10, s[44:47], s65 offen sc1 lds
    s_add_u32 m0, s58, 1024
    s_add_u32 s65, s63, 216064
    buffer_load_dwordx4 v10, s[44:47], s65 offen sc1 lds
    s_add_u32 m0, s58, 2048
    s_add_u32 s65, s63, 217088
    buffer_load_dwordx4 v10, s[44:47], s65 offen sc1 lds
    s_add_u32 m0, s58, 3072
    s_add_u32 s65, s63, 218112
    buffer_load_dwordx4 v10, s[44:47], s65 offen sc1 lds
    s_add_u32 m0, s58, 4096
    s_add_u32 s65, s63, 219136
    buffer_load_dwordx4 v10, s[44:47], s65 offen sc1 lds
    s_waitcnt vmcnt(20)
    s_barrier
    s_add_u32 m0, s58, 10240
    s_add_u32 s65, s63, 225280
    buffer_load_dwordx4 v10, s[44:47], s65 offen sc1 lds
    s_add_u32 m0, s58, 11264
    s_add_u32 s65, s63, 226304
    buffer_load_dwordx4 v10, s[44:47], s65 offen sc1 lds
    s_add_u32 m0, s58, 12288
    s_add_u32 s65, s63, 227328
    buffer_load_dwordx4 v10, s[44:47], s65 offen sc1 lds
    s_add_u32 m0, s58, 13312
    s_add_u32 s65, s63, 228352
    buffer_load_dwordx4 v10, s[44:47], s65 offen sc1 lds
    s_add_u32 m0, s58, 14336
    s_add_u32 s65, s63, 229376
    buffer_load_dwordx4 v10, s[44:47], s65 offen sc1 lds
    s_waitcnt vmcnt(20)
    s_barrier
    s_add_u32 m0, s58, 20480
    s_add_u32 s65, s63, 235520
    buffer_load_dwordx4 v10, s[44:47], s65 offen sc1 lds
    s_add_u32 m0, s58, 21504
    s_add_u32 s65, s63, 236544
    buffer_load_dwordx4 v10, s[44:47], s65 offen sc1 lds
    s_add_u32 m0, s58, 22528
    s_add_u32 s65, s63, 237568
    buffer_load_dwordx4 v10, s[44:47], s65 offen sc1 lds
    s_add_u32 m0, s58, 23552
    s_add_u32 s65, s63, 238592
    buffer_load_dwordx4 v10, s[44:47], s65 offen sc1 lds
    s_add_u32 m0, s58, 24576
    s_add_u32 s65, s63, 239616
    buffer_load_dwordx4 v10, s[44:47], s65 offen sc1 lds
    s_waitcnt vmcnt(20)
    s_barrier
    buffer_load_dwordx4 v[32:35], v31, s[44:47], 0 offen offset:0 sc1
    buffer_load_dwordx4 v[36:39], v31, s[44:47], 0 offen offset:1024 sc1
    buffer_load_dwordx4 v[40:43], v31, s[44:47], 0 offen offset:2048 sc1
    buffer_load_dwordx4 v[44:47], v31, s[44:47], 0 offen offset:3072 sc1
    s_add_u32 m0, s58, 30720
    s_add_u32 s65, s63, 245760
    buffer_load_dwordx4 v10, s[44:47], s65 offen sc1 lds
    s_add_u32 m0, s58, 31744
    s_add_u32 s65, s63, 246784
    buffer_load_dwordx4 v10, s[44:47], s65 offen sc1 lds
    s_add_u32 m0, s58, 32768
    s_add_u32 s65, s63, 247808
    buffer_load_dwordx4 v10, s[44:47], s65 offen sc1 lds
    s_add_u32 m0, s58, 33792
    s_add_u32 s65, s63, 248832
    buffer_load_dwordx4 v10, s[44:47], s65 offen sc1 lds
    s_add_u32 m0, s58, 34816
    s_add_u32 s65, s63, 249856
    buffer_load_dwordx4 v10, s[44:47], s65 offen sc1 lds
    s_waitcnt vmcnt(24)
    s_barrier
    s_add_u32 m0, s58, 40960
    s_add_u32 s65, s63, 256000
    buffer_load_dwordx4 v10, s[44:47], s65 offen sc1 lds
    s_add_u32 m0, s58, 41984
    s_add_u32 s65, s63, 257024
    buffer_load_dwordx4 v10, s[44:47], s65 offen sc1 lds
    s_add_u32 m0, s58, 43008
    s_add_u32 s65, s63, 258048
    buffer_load_dwordx4 v10, s[44:47], s65 offen sc1 lds
    s_add_u32 m0, s58, 44032
    s_add_u32 s65, s63, 259072
    buffer_load_dwordx4 v10, s[44:47], s65 offen sc1 lds
    s_add_u32 m0, s58, 45056
    s_add_u32 s65, s63, 260096
    buffer_load_dwordx4 v10, s[44:47], s65 offen sc1 lds
    s_waitcnt vmcnt(24)
    s_barrier
    s_add_u32 m0, s58, 51200
    s_add_u32 s65, s63, 266240
    buffer_load_dwordx4 v10, s[44:47], s65 offen sc1 lds
    s_add_u32 m0, s58, 52224
    s_add_u32 s65, s63, 267264
    buffer_load_dwordx4 v10, s[44:47], s65 offen sc1 lds
    s_add_u32 m0, s58, 53248
    s_add_u32 s65, s63, 268288
    buffer_load_dwordx4 v10, s[44:47], s65 offen sc1 lds
    s_add_u32 m0, s58, 54272
    s_add_u32 s65, s63, 269312
    buffer_load_dwordx4 v10, s[44:47], s65 offen sc1 lds
    s_add_u32 m0, s58, 55296
    s_add_u32 s65, s63, 270336
    buffer_load_dwordx4 v10, s[44:47], s65 offen sc1 lds
    s_waitcnt vmcnt(24)
    s_barrier
    s_mov_b32 s70, 400000
    s_waitcnt vmcnt(15)
    s_branch spc_62
sp_60:
    buffer_load_dwordx4 v[32:35], v31, s[44:47], 0 offen offset:0 sc1
    buffer_load_dwordx4 v[36:39], v31, s[44:47], 0 offen offset:1024 sc1
    buffer_load_dwordx4 v[40:43], v31, s[44:47], 0 offen offset:2048 sc1
    buffer_load_dwordx4 v[44:47], v31, s[44:47], 0 offen offset:3072 sc1
    s_waitcnt vmcnt(0)
spc_62:
    v_cmp_ne_u64 vcc, v[32:33], v[28:29]
    v_cmp_ne_u64 s[72:73], v[34:35], v[28:29]
    s_nop 0
    s_or_b64 vcc, vcc, s[72:73]
    v_cmp_ne_u64 s[72:73], v[36:37], v[28:29]
    s_nop 0
    s_or_b64 vcc, vcc, s[72:73]
    v_cmp_ne_u64 s[72:73], v[38:39], v[28:29]
    s_nop 0
    s_or_b64 vcc, vcc, s[72:73]
    v_cmp_ne_u64 s[72:73], v[40:41], v[28:29]
    s_nop 0
    s_or_b64 vcc, vcc, s[72:73]
    v_cmp_ne_u64 s[72:73], v[42:43], v[28:29]
    s_nop 0
    s_or_b64 vcc, vcc, s[72:73]
    v_cmp_ne_u64 s[72:73], v[44:45], v[28:29]
    s_nop 0
    s_or_b64 vcc, vcc, s[72:73]
    v_cmp_ne_u64 s[72:73], v[46:47], v[28:29]
    s_nop 0
    s_or_b64 vcc, vcc, s[72:73]
    s_cmp_eq_u64 vcc, 0
    s_cbranch_scc1 spx_61
    s_sleep 1
    s_sub_u32 s70, s70, 1
    s_cmp_lg_u32 s70, 0
    s_cbranch_scc1 sp_60
spx_61:
    s_add_u32 m0, s58, 61440
    s_add_u32 s65, s62, 0
    buffer_load_dwordx4 v10, s[44:47], s65 offen sc1 lds
    s_add_u32 m0, s58, 62464
    s_add_u32 s65, s62, 1024
    buffer_load_dwordx4 v10, s[44:47], s65 offen sc1 lds
    s_add_u32 m0, s58, 63488
    s_add_u32 s65, s62, 2048
    buffer_load_dwordx4 v10, s[44:47], s65 offen sc1 lds
    s_add_u32 m0, s58, 64512
    s_add_u32 s65, s62, 3072
    buffer_load_dwordx4 v10, s[44:47], s65 offen sc1 lds
    s_add_u32 m0, s58, 65536
    s_add_u32 s65, s62, 4096
    buffer_load_dwordx4 v10, s[44:47], s65 offen sc1 lds
    s_barrier
    s_add_u32 m0, s58, 0
    s_add_u32 s65, s62, 10240
    buffer_load_dwordx4 v10, s[44:47], s65 offen sc1 lds
    s_add_u32 m0, s58, 1024
    s_add_u32 s65, s62, 11264
    buffer_load_dwordx4 v10, s[44:47], s65 offen sc1 lds
    s_add_u32 m0, s58, 2048
    s_add_u32 s65, s62, 12288
    buffer_load_dwordx4 v10, s[44:47], s65 offen sc1 lds
    s_add_u32 m0, s58, 3072
    s_add_u32 s65, s62, 13312
    buffer_load_dwordx4 v10, s[44:47], s65 offen sc1 lds
    s_add_u32 m0, s58, 4096
    s_add_u32 s65, s62, 14336
    buffer_load_dwordx4 v10, s[44:47], s65 offen sc1 lds
    s_waitcnt vmcnt(20)
    s_barrier
    s_add_u32 m0, s58, 10240
    s_add_u32 s65, s62, 20480
    buffer_load_dwordx4 v10, s[44:47], s65 offen sc1 lds
    s_add_u32 m0, s58, 11264
    s_add_u32 s65, s62, 21504
    buffer_load_dwordx4 v10, s[44:47], s65 offen sc1 lds
    s_add_u32 m0, s58, 12288
    s_add_u32 s65, s62, 22528
    buffer_load_dwordx4 v10, s[44:47], s65 offen sc1 lds
    s_add_u32 m0, s58, 13312
    s_add_u32 s65, s62, 23552
    buffer_load_dwordx4 v10, s[44:47], s65 offen sc1 lds
    s_add_u32 m0, s58, 14336
    s_add_u32 s65, s62, 24576
    buffer_load_dwordx4 v10, s[44:47], s65 offen sc1 lds
    s_waitcnt vmcnt(20)
    s_barrier
    s_add_u32 m0, s58, 20480
    s_add_u32 s65, s62, 30720
    buffer_load_dwordx4 v10, s[44:47], s65 offen sc1 lds
    s_add_u32 m0, s58, 21504
    s_add_u32 s65, s62, 31744
    buffer_load_dwordx4 v10, s[44:47], s65 offen sc1 lds
    s_add_u32 m0, s58, 22528
    s_add_u32 s65, s62, 32768
    buffer_load_dwordx4 v10, s[44:47], s65 offen sc1 lds
    s_add_u32 m0, s58, 23552
    s_add_u32 s65, s62, 33792
    buffer_load_dwordx4 v10, s[44:47], s65 offen sc1 lds
    s_add_u32 m0, s58, 24576
    s_add_u32 s65, s62, 34816
    buffer_load_dwordx4 v10, s[44:47], s65 offen sc1 lds
    s_waitcnt vmcnt(20)
    s_barrier
    s_add_u32 m0, s58, 30720
    s_add_u32 s65, s62, 40960
    buffer_load_dwordx4 v10, s[44:47], s65 offen sc1 lds
    s_add_u32 m0, s58, 31744
    s_add_u32 s65, s62, 41984
    buffer_load_dwordx4 v10, s[44:47], s65 offen sc1 lds
    s_add_u32 m0, s58, 32768
    s_add_u32 s65, s62, 43008
    buffer_load_dwordx4 v10, s[44:47], s65 offen sc1 lds
    s_add_u32 m0, s58, 33792
    s_add_u32 s65, s62, 44032
    buffer_load_dwordx4 v10, s[44:47], s65 offen sc1 lds
    s_add_u32 m0, s58, 34816
    s_add_u32 s65, s62, 45056
    buffer_load_dwordx4 v10, s[44:47], s65 offen sc1 lds
    s_waitcnt vmcnt(20)
    s_barrier
    s_add_u32 m0, s58, 40960
    s_add_u32 s65, s62, 51200
    buffer_load_dwordx4 v10, s[44:47], s65 offen sc1 lds
    s_add_u32 m0, s58, 41984
    s_add_u32 s65, s62, 52224
    buffer_load_dwordx4 v10, s[44:47], s65 offen sc1 lds
    s_add_u32 m0, s58, 43008
    s_add_u32 s65, s62, 53248
    buffer_load_dwordx4 v10, s[44:47], s65 offen sc1 lds
    s_add_u32 m0, s58, 44032
    s_add_u32 s65, s62, 54272
    buffer_load_dwordx4 v10, s[44:47], s65 offen sc1 lds
    s_add_u32 m0, s58, 45056
    s_add_u32 s65, s62, 55296
    buffer_load_dwordx4 v10, s[44:47], s65 offen sc1 lds
    s_waitcnt vmcnt(20)
    s_barrier
    s_add_u32 m0, s58, 51200
    s_add_u32 s65, s62, 61440
    buffer_load_dwordx4 v10, s[44:47], s65 offen sc1 lds
    s_add_u32 m0, s58, 52224
    s_add_u32 s65, s62, 62464
    buffer_load_dwordx4 v10, s[44:47], s65 offen sc1 lds
    s_add_u32 m0, s58, 53248
    s_add_u32 s65, s62, 63488
    buffer_load_dwordx4 v10, s[44:47], s65 offen sc1 lds
    s_add_u32 m0, s58, 54272
    s_add_u32 s65, s62, 64512
    buffer_load_dwordx4 v10, s[44:47], s65 offen sc1 lds
    s_add_u32 m0, s58, 55296
    s_add_u32 s65, s62, 65536
    buffer_load_dwordx4 v10, s[44:47], s65 offen sc1 lds
    s_waitcnt vmcnt(20)
    s_barrier
    s_add_u32 m0, s58, 61440
    s_add_u32 s65, s62, 71680
    buffer_load_dwordx4 v10, s[44:47], s65 offen sc1 lds
    s_add_u32 m0, s58, 62464
    s_add_u32 s65, s62, 72704
    buffer_load_dwordx4 v10, s[44:47], s65 offen sc1 lds
    s_add_u32 m0, s58, 63488
    s_add_u32 s65, s62, 73728
    buffer_load_dwordx4 v10, s[44:47], s65 offen sc1 lds
    s_add_u32 m0, s58, 64512
    s_add_u32 s65, s62, 74752
    buffer_load_dwordx4 v10, s[44:47], s65 offen sc1 lds
    s_add_u32 m0, s58, 65536
    s_add_u32 s65, s62, 75776
    buffer_load_dwordx4 v10, s[44:47], s65 offen sc1 lds
    s_waitcnt vmcnt(20)
    s_barrier
    s_add_u32 m0, s58, 0
    s_add_u32 s65, s62, 81920
    buffer_load_dwordx4 v10, s[44:47], s65 offen sc1 lds
    s_add_u32 m0, s58, 1024
    s_add_u32 s65, s62, 82944
    buffer_load_dwordx4 v10, s[44:47], s65 offen sc1 lds
    s_add_u32 m0, s58, 2048
    s_add_u32 s65, s62, 83968
    buffer_load_dwordx4 v10, s[44:47], s65 offen sc1 lds
    s_add_u32 m0, s58, 3072
    s_add_u32 s65, s62, 84992
    buffer_load_dwordx4 v10, s[44:47], s65 offen sc1 lds
    s_add_u32 m0, s58, 4096
    s_add_u32 s65, s62, 86016
    buffer_load_dwordx4 v10, s[44:47], s65 offen sc1 lds
    s_waitcnt vmcnt(20)
    s_barrier
    s_add_u32 m0, s58, 10240
    s_add_u32 s65, s62, 92160
    buffer_load_dwordx4 v10, s[44:47], s65 offen sc1 lds
    s_add_u32 m0, s58, 11264
    s_add_u32 s65, s62, 93184
    buffer_load_dwordx4 v10, s[44:47], s65 offen sc1 lds
    s_add_u32 m0, s58, 12288
    s_add_u32 s65, s62, 94208
    buffer_load_dwordx4 v10, s[44:47], s65 offen sc1 lds
    s_add_u32 m0, s58, 13312
    s_add_u32 s65, s62, 95232
    buffer_load_dwordx4 v10, s[44:47], s65 offen sc1 lds
    s_add_u32 m0, s58, 14336
    s_add_u32 s65, s62, 96256
    buffer_load_dwordx4 v10, s[44:47], s65 offen sc1 lds
    s_waitcnt vmcnt(20)
    s_barrier
    s_add_u32 m0, s58, 20480
    s_add_u32 s65, s62, 102400
    buffer_load_dwordx4 v10, s[44:47], s65 offen sc1 lds
    s_add_u32 m0, s58, 21504
    s_add_u32 s65, s62, 103424
    buffer_load_dwordx4 v10, s[44:47], s65 offen sc1 lds
    s_add_u32 m0, s58, 22528
    s_add_u32 s65, s62, 104448
    buffer_load_dwordx4 v10, s[44:47], s65 offen sc1 lds
    s_add_u32 m0, s58, 23552
    s_add_u32 s65, s62, 105472
    buffer_load_dwordx4 v10, s[44:47], s65 offen sc1 lds
    s_add_u32 m0, s58, 24576
    s_add_u32 s65, s62, 106496
    buffer_load_dwordx4 v10, s[44:47], s65 offen sc1 lds
    s_waitcnt vmcnt(20)
    s_barrier
    s_add_u32 m0, s58, 30720
    s_add_u32 s65, s62, 112640
    buffer_load_dwordx4 v10, s[44:47], s65 offen sc1 lds
    s_add_u32 m0, s58, 31744
    s_add_u32 s65, s62, 113664
    buffer_load_dwordx4 v10, s[44:47], s65 offen sc1 lds
    s_add_u32 m0, s58, 32768
    s_add_u32 s65, s62, 114688
    buffer_load_dwordx4 v10, s[44:47], s65 offen sc1 lds
    s_add_u32 m0, s58, 33792
    s_add_u32 s65, s62, 115712
    buffer_load_dwordx4 v10, s[44:47], s65 offen sc1 lds
    s_add_u32 m0, s58, 34816
    s_add_u32 s65, s62, 116736
    buffer_load_dwordx4 v10, s[44:47], s65 offen sc1 lds
    s_waitcnt vmcnt(20)
    s_barrier
    s_add_u32 m0, s58, 40960
    s_add_u32 s65, s62, 122880
    buffer_load_dwordx4 v10, s[44:47], s65 offen sc1 lds
    s_add_u32 m0, s58, 41984
    s_add_u32 s65, s62, 123904
    buffer_load_dwordx4 v10, s[44:47], s65 offen sc1 lds
    s_add_u32 m0, s58, 43008
    s_add_u32 s65, s62, 124928
    buffer_load_dwordx4 v10, s[44:47], s65 offen sc1 lds
    s_add_u32 m0, s58, 44032
    s_add_u32 s65, s62, 125952
    buffer_load_dwordx4 v10, s[44:47], s65 offen sc1 lds
    s_add_u32 m0, s58, 45056
    s_add_u32 s65, s62, 126976
    buffer_load_dwordx4 v10, s[44:47], s65 offen sc1 lds
    s_waitcnt vmcnt(20)
    s_barrier
    s_add_u32 m0, s58, 51200
    s_add_u32 s65, s62, 133120
    buffer_load_dwordx4 v10, s[44:47], s65 offen sc1 lds
    s_add_u32 m0, s58, 52224
    s_add_u32 s65, s62, 134144
    buffer_load_dwordx4 v10, s[44:47], s65 offen sc1 lds
    s_add_u32 m0, s58, 53248
    s_add_u32 s65, s62, 135168
    buffer_load_dwordx4 v10, s[44:47], s65 offen sc1 lds
    s_add_u32 m0, s58, 54272
    s_add_u32 s65, s62, 136192
    buffer_load_dwordx4 v10, s[44:47], s65 offen sc1 lds
    s_add_u32 m0, s58, 55296
    s_add_u32 s65, s62, 137216
    buffer_load_dwordx4 v10, s[44:47], s65 offen sc1 lds
    s_waitcnt vmcnt(20)
    s_barrier
    s_add_u32 m0, s58, 61440
    s_add_u32 s65, s62, 143360
    buffer_load_dwordx4 v10, s[44:47], s65 offen sc1 lds
    s_add_u32 m0, s58, 62464
    s_add_u32 s65, s62, 144384
    buffer_load_dwordx4 v10, s[44:47], s65 offen sc1 lds
    s_add_u32 m0, s58, 63488
    s_add_u32 s65, s62, 145408
    buffer_load_dwordx4 v10, s[44:47], s65 offen sc1 lds
    s_add_u32 m0, s58, 64512
    s_add_u32 s65, s62, 146432
    buffer_load_dwordx4 v10, s[44:47], s65 offen sc1 lds
    s_add_u32 m0, s58, 65536
    s_add_u32 s65, s62, 147456
    buffer_load_dwordx4 v10, s[44:47], s65 offen sc1 lds
    s_waitcnt vmcnt(20)
    s_barrier
    s_add_u32 m0, s58, 0
    s_add_u32 s65, s62, 153600
    buffer_load_dwordx4 v10, s[44:47], s65 offen sc1 lds
    s_add_u32 m0, s58, 1024
    s_add_u32 s65, s62, 154624
    buffer_load_dwordx4 v10, s[44:47], s65 offen sc1 lds
    s_add_u32 m0, s58, 2048
    s_add_u32 s65, s62, 155648
    buffer_load_dwordx4 v10, s[44:47], s65 offen sc1 lds
    s_add_u32 m0, s58, 3072
    s_add_u32 s65, s62, 156672
    buffer_load_dwordx4 v10, s[44:47], s65 offen sc1 lds
    s_add_u32 m0, s58, 4096
    s_add_u32 s65, s62, 157696
    buffer_load_dwordx4 v10, s[44:47], s65 offen sc1 lds
    s_waitcnt vmcnt(20)
    s_barrier
    s_add_u32 m0, s58, 10240
    s_add_u32 s65, s62, 163840
    buffer_load_dwordx4 v10, s[44:47], s65 offen sc1 lds
    s_add_u32 m0, s58, 11264
    s_add_u32 s65, s62, 164864
    buffer_load_dwordx4 v10, s[44:47], s65 offen sc1 lds
    s_add_u32 m0, s58, 12288
    s_add_u32 s65, s62, 165888
    buffer_load_dwordx4 v10, s[44:47], s65 offen sc1 lds
    s_add_u32 m0, s58, 13312
    s_add_u32 s65, s62, 166912
    buffer_load_dwordx4 v10, s[44:47], s65 offen sc1 lds
    s_add_u32 m0, s58, 14336
    s_add_u32 s65, s62, 167936
    buffer_load_dwordx4 v10, s[44:47], s65 offen sc1 lds
    s_waitcnt vmcnt(20)
    s_barrier
    s_add_u32 m0, s58, 20480
    s_add_u32 s65, s62, 174080
    buffer_load_dwordx4 v10, s[44:47], s65 offen sc1 lds
    s_add_u32 m0, s58, 21504
    s_add_u32 s65, s62, 175104
    buffer_load_dwordx4 v10, s[44:47], s65 offen sc1 lds
    s_add_u32 m0, s58, 22528
    s_add_u32 s65, s62, 176128
    buffer_load_dwordx4 v10, s[44:47], s65 offen sc1 lds
    s_add_u32 m0, s58, 23552
    s_add_u32 s65, s62, 177152
    buffer_load_dwordx4 v10, s[44:47], s65 offen sc1 lds
    s_add_u32 m0, s58, 24576
    s_add_u32 s65, s62, 178176
    buffer_load_dwordx4 v10, s[44:47], s65 offen sc1 lds
    s_waitcnt vmcnt(20)
    s_barrier
    s_add_u32 m0, s58, 30720
    s_add_u32 s65, s62, 184320
    buffer_load_dwordx4 v10, s[44:47], s65 offen sc1 lds
    s_add_u32 m0, s58, 31744
    s_add_u32 s65, s62, 185344
    buffer_load_dwordx4 v10, s[44:47], s65 offen sc1 lds
    s_add_u32 m0, s58, 32768
    s_add_u32 s65, s62, 186368
    buffer_load_dwordx4 v10, s[44:47], s65 offen sc1 lds
    s_add_u32 m0, s58, 33792
    s_add_u32 s65, s62, 187392
    buffer_load_dwordx4 v10, s[44:47], s65 offen sc1 lds
    s_add_u32 m0, s58, 34816
    s_add_u32 s65, s62, 188416
    buffer_load_dwordx4 v10, s[44:47], s65 offen sc1 lds
    s_waitcnt vmcnt(20)
    s_barrier
    s_add_u32 m0, s58, 40960
    s_add_u32 s65, s62, 194560
    buffer_load_dwordx4 v10, s[44:47], s65 offen sc1 lds
    s_add_u32 m0, s58, 41984
    s_add_u32 s65, s62, 195584
    buffer_load_dwordx4 v10, s[44:47], s65 offen sc1 lds
    s_add_u32 m0, s58, 43008
    s_add_u32 s65, s62, 196608
    buffer_load_dwordx4 v10, s[44:47], s65 offen sc1 lds
    s_add_u32 m0, s58, 44032
    s_add_u32 s65, s62, 197632
    buffer_load_dwordx4 v10, s[44:47], s65 offen sc1 lds
    s_add_u32 m0, s58, 45056
    s_add_u32 s65, s62, 198656
    buffer_load_dwordx4 v10, s[44:47], s65 offen sc1 lds
    s_waitcnt vmcnt(20)
    s_barrier
    s_waitcnt vmcnt(15)
    s_barrier
    s_waitcnt vmcnt(10)
    s_barrier
    s_waitcnt vmcnt(5)
    s_barrier
    s_waitcnt vmcnt(0)
    s_barrier
k1_end:
    s_endpgm
k1_codeend:
.section .rodata,"a"
.p2align 6
.amdhsa_kernel recurrent_scan__ssm_conv_s5__dense_activation_relu__prompt_kernel
  .amdhsa_next_free_vgpr 256
  .amdhsa_next_free_sgpr 102
  .amdhsa_accum_offset 256
  .amdhsa_group_segment_fixed_size 0
  .amdhsa_kernarg_size 120
  .amdhsa_user_sgpr_count 2
  .amdhsa_user_sgpr_kernarg_segment_ptr 1
  .amdhsa_system_sgpr_workgroup_id_x 1
.end_amdhsa_kernel
```
